```python
import torch

def _softmax(x, axis=-1):
    return torch.softmax(x, dim=axis)

def _gelu(x):
    return torch.nn.functional.gelu(x, approximate='tanh')

def _silu(x):
    return torch.nn.functional.silu(x)

def _sigmoid(x):
    return torch.sigmoid(x)

def _layernorm(x, axis=-1, eps=1e-05):
    m = x.mean(dim=axis, keepdim=True)
    v = x.var(dim=axis, keepdim=True, unbiased=False)
    return (x - m) / torch.sqrt(v + eps)

def _scatter_add(tgt, idx, src, axis=0):
    return tgt.clone().index_add_(axis, idx, src)

def _segment_sum(src, seg, n):
    out = torch.zeros((n,) + src.shape[1:], dtype=src.dtype)
    return out.index_add_(0, seg, src)

def _pad(x, pw):
    flat = tuple((v for pair in reversed(pw) for v in pair))
    return torch.nn.functional.pad(x, flat)
kernel_name = 'sequential_preLN__memory_aug_recurrent_mem_tr__mixer_gmlp__prompt'

def setup_inputs():

    _w = lambda a: (lambda t: t.to(torch.bfloat16) if t.is_floating_point() else t)(torch.as_tensor(a))

    def _A_setup():
        B, S, Dm = (1, 2048, 512)
        H, Dh = (32, 128)
        M, seg = (8, 32)
        seg = min(seg, S)
        S = S // seg * seg
        return {'x': _w((lambda *s: torch.randn(*s, dtype=torch.bfloat16) * 0.05)(B, S, Dm)), 'mem0': _w((lambda *s: torch.randn(*s, dtype=torch.bfloat16) * 0.2)(B, M, Dm)), 'Wq': _w((lambda *s: torch.randn(*s, dtype=torch.bfloat16) * 1.6)(Dm, H, Dh) * Dm ** (-0.5)), 'Wk': _w((lambda *s: torch.randn(*s, dtype=torch.bfloat16) * 1.6)(Dm, H, Dh) * Dm ** (-0.5)), 'Wv': _w((lambda *s: torch.randn(*s, dtype=torch.bfloat16) * 0.2)(Dm, H, Dh) * Dm ** (-0.5)), 'Wo': _w((lambda *s: torch.randn(*s, dtype=torch.bfloat16) * 0.2)(H, Dh, Dm) * (H * Dh) ** (-0.5)), 'seg_len': seg}
    _A_in = _A_setup()

    def _B_setup():
        B, S, D, F = (1, 2048, 512, 1376)
        Fh = F // 2
        return {'x': _w((lambda *s: torch.randn(*s, dtype=torch.bfloat16) * 0.05)(B, S, D)), 'w_in': _w((lambda *s: torch.randn(*s, dtype=torch.bfloat16) * 0.4)(D, 2 * Fh)), 'w_sp': _w(0.01 * (lambda *s: torch.randn(*s, dtype=torch.bfloat16) * 0.4)(S, S)), 'b_sp': _w(1.0 + 0.01 * (lambda *s: torch.randn(*s, dtype=torch.bfloat16) * 0.05)(S)), 'w_out': _w((lambda *s: torch.randn(*s, dtype=torch.bfloat16) * 0.05)(Fh, D))}
    _B_in = _B_setup()
    return {'A_x': _A_in['x'], 'A_mem0': _A_in['mem0'], 'A_Wq': _A_in['Wq'], 'A_Wk': _A_in['Wk'], 'A_Wv': _A_in['Wv'], 'A_Wo': _A_in['Wo'], 'A_seg_len': _A_in['seg_len'], 'B_x': _B_in['x'], 'B_w_in': _B_in['w_in'], 'B_w_sp': _B_in['w_sp'], 'B_b_sp': _B_in['b_sp'], 'B_w_out': _B_in['w_out']}

def reference(A_x, A_mem0, A_Wq, A_Wk, A_Wv, A_Wo, A_seg_len, B_x, B_w_in, B_w_sp, B_b_sp, B_w_out):

    def _A_ref(x, mem0, Wq, Wk, Wv, Wo, seg_len):
        B, S, Dm = x.shape
        H, Dh = (Wq.shape[1], Wq.shape[2])
        M = mem0.shape[1]
        scale = Dh ** (-0.5)
        n_seg = S // seg_len
        L = M + seg_len
        idx = torch.arange(L)
        mask = (idx[:, None] < M) | (idx[:, None] >= idx[None, :])
        mem = mem0
        outs = []
        for s in range(n_seg):
            xs = x[:, s * seg_len:(s + 1) * seg_len, :].clone()
            h = torch.concatenate([mem, xs], axis=1)
            q = torch.einsum('btd,dhe->bhte', h, Wq)
            k = torch.einsum('btd,dhe->bhte', h, Wk)
            v = torch.einsum('btd,dhe->bhte', h, Wv)
            scores = torch.einsum('bhqe,bhke->bhqk', q, k) * scale
            scores = torch.where(mask[None, None], scores, -1000000000.0)
            p = _softmax(scores, axis=-1)
            o = torch.einsum('bhqk,bhke->bhqe', p, v)
            o = torch.einsum('bhte,hed->btd', o, Wo)
            mem = o[:, :M, :].clone()
            outs.append(o[:, M:, :])
        return torch.concatenate(outs, axis=1)

    def _B_ref(x, w_in, w_sp, b_sp, w_out):
        B, S, D = x.shape
        F = w_in.shape[-1]
        Fh = F // 2
        z = _gelu(torch.einsum('bsd,df->bsf', x, w_in))
        z1 = z[..., :Fh].clone()
        z2 = _layernorm(z[..., Fh:], axis=-1)
        g = torch.einsum('ts,bsf->btf', w_sp, z2) + b_sp[None, :, None]
        return torch.einsum('bsf,fd->bsd', z1 * g, w_out)
    x = A_x
    h = x + _A_ref(_layernorm(x, axis=-1), A_mem0, A_Wq, A_Wk, A_Wv, A_Wo, A_seg_len)
    h2 = h + _B_ref(_layernorm(h, axis=-1), B_w_in, B_w_sp, B_b_sp, B_w_out)
    return h2
```

```asm
; @launch grid=(256,1,1) block=(256,1,1) lds=163840
.amdgcn_target "amdgcn-amd-amdhsa--gfx950"
.text
.globl sequential_preLN__memory_aug_recurrent_mem_tr__mixer_gmlp__prompt_kernel
.p2align 8
.type sequential_preLN__memory_aug_recurrent_mem_tr__mixer_gmlp__prompt_kernel,@function
sequential_preLN__memory_aug_recurrent_mem_tr__mixer_gmlp__prompt_kernel:
    s_cmp_ge_u32 s2, 256
    s_cbranch_scc1 K_exit
    s_mov_b32 s96, 0
    s_mov_b32 s97, 8192
    s_and_b32 s3, s2, 7
    s_cmp_lg_u32 s3, 0
    s_cbranch_scc1 K_work
    s_lshr_b32 s4, s2, 3
    v_lshrrev_b32 v12, 6, v0
    s_load_dwordx8 s[40:47], s[0:1], 16
    s_load_dwordx2 s[48:49], s[0:1], 8
    s_load_dwordx2 s[32:33], s[0:1], 104
    s_load_dwordx2 s[30:31], s[0:1], 112
    v_readfirstlane_b32 s3, v12
    v_and_b32 v16, 63, v0
    v_bfe_u32 v19, v16, 1, 2
    v_bfe_u32 v21, v16, 4, 2
    v_xor_b32 v19, v19, v21
    v_lshlrev_b32 v26, 5, v19
    v_bfe_u32 v20, v16, 0, 1
    v_lshl_add_u32 v26, v20, 4, v26
    v_bfe_u32 v20, v16, 5, 1
    v_lshlrev_b32 v19, 2, v20
    v_bfe_u32 v20, v16, 3, 1
    v_lshl_add_u32 v19, v20, 0, v19
    v_bfe_u32 v20, v16, 4, 1
    v_lshl_add_u32 v19, v20, 4, v19
    v_lshl_add_u32 v22, v19, 13, v26
    s_lshl_b32 s57, s3, 15
    s_add_u32 s57, s57, 32768
    s_mov_b32 s38, 0x400000
    s_mov_b32 s39, 0x20000
    s_lshl_b32 s60, s4, 8
    s_and_b32 s7, s3, 2
    s_lshl_b32 s7, s7, 6
    s_add_u32 s60, s60, s7
    s_and_b32 s7, s3, 1
    s_lshl_b32 s7, s7, 16
    s_add_u32 s60, s60, s7
    s_lshl_b32 s61, s4, 17
    s_lshl_b32 s7, s3, 8
    s_add_u32 s61, s61, s7
    s_and_b32 s63, s3, 2
    s_and_b32 s35, s3, 1
    s_lshl_b32 s35, s35, 13
    s_waitcnt lgkmcnt(0)
    s_or_b32 s7, s2, s3
    s_cbranch_scc1 T_nb_1
    s_getreg_b32 s7, hwreg(HW_REG_XCC_ID)
    s_and_b32 s7, s7, 7
    s_add_u32 s7, s7, 1
    v_mov_b32 v19, 192
    v_mov_b32 v20, s7
    global_store_dword v19, v20, s[32:33] sc1
T_nb_1:
    s_mov_b32 s36, s42
    s_and_b32 s37, s43, 0xffff
    s_xor_b32 s7, s63, 0
    s_lshl_b32 s7, s7, 18
    s_add_u32 s7, s7, s60
    s_add_u32 m0, s57, 0
    s_add_u32 s62, s7, 0
    buffer_load_dwordx4 v22, s[36:39], s62 offen lds
    s_add_u32 m0, s57, 1024
    s_add_u32 s62, s7, 16384
    buffer_load_dwordx4 v22, s[36:39], s62 offen lds
    s_add_u32 m0, s57, 2048
    s_add_u32 s62, s7, 1048576
    buffer_load_dwordx4 v22, s[36:39], s62 offen lds
    s_add_u32 m0, s57, 3072
    s_add_u32 s62, s7, 1064960
    buffer_load_dwordx4 v22, s[36:39], s62 offen lds
    s_xor_b32 s7, s63, 0
    s_lshl_b32 s7, s7, 18
    s_add_u32 s7, s7, s60
    s_add_u32 m0, s57, 4096
    s_add_u32 s62, s7, 2097152
    buffer_load_dwordx4 v22, s[36:39], s62 offen lds
    s_add_u32 m0, s57, 5120
    s_add_u32 s62, s7, 2113536
    buffer_load_dwordx4 v22, s[36:39], s62 offen lds
    s_add_u32 m0, s57, 6144
    s_add_u32 s62, s7, 3145728
    buffer_load_dwordx4 v22, s[36:39], s62 offen lds
    s_add_u32 m0, s57, 7168
    s_add_u32 s62, s7, 3162112
    buffer_load_dwordx4 v22, s[36:39], s62 offen lds
    s_xor_b32 s7, s63, 1
    s_lshl_b32 s7, s7, 18
    s_add_u32 s7, s7, s60
    s_add_u32 m0, s57, 8192
    s_add_u32 s62, s7, 0
    buffer_load_dwordx4 v22, s[36:39], s62 offen lds
    s_add_u32 m0, s57, 9216
    s_add_u32 s62, s7, 16384
    buffer_load_dwordx4 v22, s[36:39], s62 offen lds
    s_add_u32 m0, s57, 10240
    s_add_u32 s62, s7, 1048576
    buffer_load_dwordx4 v22, s[36:39], s62 offen lds
    s_add_u32 m0, s57, 11264
    s_add_u32 s62, s7, 1064960
    buffer_load_dwordx4 v22, s[36:39], s62 offen lds
    s_xor_b32 s7, s63, 1
    s_lshl_b32 s7, s7, 18
    s_add_u32 s7, s7, s60
    s_add_u32 m0, s57, 12288
    s_add_u32 s62, s7, 2097152
    buffer_load_dwordx4 v22, s[36:39], s62 offen lds
    s_add_u32 m0, s57, 13312
    s_add_u32 s62, s7, 2113536
    buffer_load_dwordx4 v22, s[36:39], s62 offen lds
    s_add_u32 m0, s57, 14336
    s_add_u32 s62, s7, 3145728
    buffer_load_dwordx4 v22, s[36:39], s62 offen lds
    s_add_u32 m0, s57, 15360
    s_add_u32 s62, s7, 3162112
    buffer_load_dwordx4 v22, s[36:39], s62 offen lds
    s_mov_b32 s36, s40
    s_and_b32 s37, s41, 0xffff
    s_xor_b32 s7, s63, 2
    s_lshl_b32 s7, s7, 18
    s_add_u32 s7, s7, s60
    s_add_u32 m0, s57, 16384
    s_add_u32 s62, s7, 0
    buffer_load_dwordx4 v22, s[36:39], s62 offen lds
    s_add_u32 m0, s57, 17408
    s_add_u32 s62, s7, 16384
    buffer_load_dwordx4 v22, s[36:39], s62 offen lds
    s_add_u32 m0, s57, 18432
    s_add_u32 s62, s7, 1048576
    buffer_load_dwordx4 v22, s[36:39], s62 offen lds
    s_add_u32 m0, s57, 19456
    s_add_u32 s62, s7, 1064960
    buffer_load_dwordx4 v22, s[36:39], s62 offen lds
    s_xor_b32 s7, s63, 2
    s_lshl_b32 s7, s7, 18
    s_add_u32 s7, s7, s60
    s_add_u32 m0, s57, 20480
    s_add_u32 s62, s7, 2097152
    buffer_load_dwordx4 v22, s[36:39], s62 offen lds
    s_add_u32 m0, s57, 21504
    s_add_u32 s62, s7, 2113536
    buffer_load_dwordx4 v22, s[36:39], s62 offen lds
    s_add_u32 m0, s57, 22528
    s_add_u32 s62, s7, 3145728
    buffer_load_dwordx4 v22, s[36:39], s62 offen lds
    s_add_u32 m0, s57, 23552
    s_add_u32 s62, s7, 3162112
    buffer_load_dwordx4 v22, s[36:39], s62 offen lds
    s_xor_b32 s7, s63, 3
    s_lshl_b32 s7, s7, 18
    s_add_u32 s7, s7, s60
    s_add_u32 m0, s57, 24576
    s_add_u32 s62, s7, 0
    buffer_load_dwordx4 v22, s[36:39], s62 offen lds
    s_add_u32 m0, s57, 25600
    s_add_u32 s62, s7, 16384
    buffer_load_dwordx4 v22, s[36:39], s62 offen lds
    s_add_u32 m0, s57, 26624
    s_add_u32 s62, s7, 1048576
    buffer_load_dwordx4 v22, s[36:39], s62 offen lds
    s_add_u32 m0, s57, 27648
    s_add_u32 s62, s7, 1064960
    buffer_load_dwordx4 v22, s[36:39], s62 offen lds
    s_xor_b32 s7, s63, 3
    s_lshl_b32 s7, s7, 18
    s_add_u32 s7, s7, s60
    s_add_u32 m0, s57, 28672
    s_add_u32 s62, s7, 2097152
    buffer_load_dwordx4 v22, s[36:39], s62 offen lds
    s_add_u32 m0, s57, 29696
    s_add_u32 s62, s7, 2113536
    buffer_load_dwordx4 v22, s[36:39], s62 offen lds
    s_add_u32 m0, s57, 30720
    s_add_u32 s62, s7, 3145728
    buffer_load_dwordx4 v22, s[36:39], s62 offen lds
    s_add_u32 m0, s57, 31744
    s_add_u32 s62, s7, 3162112
    buffer_load_dwordx4 v22, s[36:39], s62 offen lds
    v_lshlrev_b32 v0, 4, v16
    v_and_b32 v17, 15, v16
    v_cmp_lt_u32 s[10:11], 7, v17
    v_bfe_u32 v19, v16, 1, 1
    v_cmp_eq_u32 vcc, 1, v19
    v_mov_b32 v19, 0x44444444
    v_mov_b32 v20, 0xeeeeeeee
    v_cndmask_b32 v1, v19, v20, vcc
    v_bfe_u32 v20, v16, 3, 3
    v_lshlrev_b32 v2, 13, v20
    v_bfe_u32 v20, v16, 0, 3
    v_lshl_add_u32 v2, v20, 3, v2
    s_lshl_b32 s7, s3, 16
    v_add_u32 v2, s7, v2
    v_lshrrev_b32 v19, 12, v2
    v_add_u32 v19, s4, v19
    v_bfe_u32 v21, v19, 1, 4
    v_lshl_add_u32 v2, v21, 8, v2
    v_and_b32 v21, 1, v19
    v_lshl_add_u32 v2, v21, 6, v2
    v_bfe_u32 v20, v16, 4, 2
    v_lshlrev_b32 v27, 4, v20
    v_bfe_u32 v20, v16, 0, 2
    v_lshl_add_u32 v27, v20, 2, v27
    v_add_u32 v3, s57, v0
    v_mov_b32 v4, v0
    s_lshl_b32 s7, s3, 11
    v_add_u32 v4, s7, v4
    s_add_u32 s56, s7, 8192
    v_bfe_u32 v20, v16, 0, 4
    v_lshlrev_b32 v5, 4, v20
    v_bfe_u32 v20, v16, 4, 2
    v_lshl_add_u32 v5, v20, 2, v5
    s_lshl_b32 s7, s3, 9
    s_add_u32 s7, s7, 24576
    v_add_u32 v5, s7, v5
    v_bfe_u32 v20, v16, 5, 1
    v_lshlrev_b32 v6, 9, v20
    v_bfe_u32 v20, v16, 4, 1
    v_lshl_add_u32 v6, v20, 7, v6
    v_bfe_u32 v20, v16, 2, 2
    v_lshl_add_u32 v6, v20, 4, v6
    v_bfe_u32 v20, v16, 0, 1
    v_lshl_add_u32 v6, v20, 3, v6
    v_bfe_u32 v20, v16, 5, 1
    v_lshlrev_b32 v7, 10, v20
    v_bfe_u32 v20, v16, 0, 2
    v_lshl_add_u32 v7, v20, 7, v7
    v_bfe_u32 v20, v16, 1, 1
    v_lshl_add_u32 v7, v20, 5, v7
    v_bfe_u32 v20, v16, 4, 1
    v_lshl_add_u32 v7, v20, 6, v7
    v_bfe_u32 v20, v16, 2, 2
    v_lshl_add_u32 v7, v20, 3, v7
    v_bfe_u32 v20, v16, 5, 1
    v_lshlrev_b32 v8, 8, v20
    v_bfe_u32 v20, v16, 1, 2
    v_lshl_add_u32 v8, v20, 6, v8
    v_bfe_u32 v20, v16, 4, 1
    v_lshl_add_u32 v8, v20, 5, v8
    v_bfe_u32 v20, v16, 0, 1
    v_lshl_add_u32 v8, v20, 4, v8
    v_bfe_u32 v20, v16, 3, 1
    v_lshl_add_u32 v8, v20, 3, v8
    s_lshl_b32 s7, s3, 9
    v_add_u32 v8, s7, v8
    v_bfe_u32 v20, v16, 2, 1
    v_lshlrev_b32 v19, 4, v20
    v_mov_b32 v21, 0x3f80
    v_lshlrev_b32 v21, v19, v21
    v_bfe_u32 v20, v16, 0, 2
    v_lshlrev_b32 v19, 1, v20
    v_bfe_u32 v20, v16, 3, 1
    v_lshl_add_u32 v19, v20, 0, v19
    v_cmp_eq_u32 vcc, 0, v19
    s_nop 1
    v_cndmask_b32 v28, 0, v21, vcc
    v_cmp_eq_u32 vcc, 1, v19
    s_nop 1
    v_cndmask_b32 v29, 0, v21, vcc
    v_cmp_eq_u32 vcc, 2, v19
    s_nop 1
    v_cndmask_b32 v30, 0, v21, vcc
    v_cmp_eq_u32 vcc, 3, v19
    s_nop 1
    v_cndmask_b32 v31, 0, v21, vcc
    ds_write_b128 v0, v[28:31] offset:28672
    v_mov_b32 v40, 0x3f803f80
    v_mov_b32 v41, 0x3f803f80
    v_mov_b32 v42, 0x3f803f80
    v_mov_b32 v43, 0x3f803f80
    ds_write_b128 v0, v[40:43] offset:29696
    ds_write_b32 v0, v27 offset:30720
    v_mov_b32 v44, 0
    v_mov_b32 v45, 0
    v_mov_b32 v46, 0
    v_mov_b32 v47, 0
    ds_write_b128 v0, v[44:47] offset:31744
    s_mov_b32 s5, 0
    s_mov_b64 s[14:15], s[30:31]
    s_branch T_end
T_warm_back:
    v_bfe_u32 v20, v16, 5, 1
    v_lshlrev_b32 v19, 4, v20
    v_bfe_u32 v20, v16, 4, 1
    v_lshl_add_u32 v19, v20, 2, v19
    v_bfe_u32 v20, v16, 3, 1
    v_lshl_add_u32 v19, v20, 0, v19
    v_lshl_add_u32 v23, v19, 10, v26
    v_bfe_u32 v20, v16, 2, 3
    v_lshlrev_b32 v113, 7, v20
    v_bfe_u32 v20, v16, 3, 2
    v_lshl_add_u32 v113, v20, 5, v113
    v_bfe_u32 v20, v16, 0, 2
    v_lshl_add_u32 v113, v20, 3, v113
    v_mov_b32 v122, v113
    v_bfe_u32 v20, v16, 5, 1
    v_lshl_add_u32 v122, v20, 12, v122
    v_add_u32 v122, s57, v122
    v_xor_b32 v123, 32, v122
    v_xor_b32 v124, 64, v122
    v_xor_b32 v125, 96, v122
    s_lshr_b32 s7, s35, 7
    v_xor_b32 v114, s7, v113
    v_bfe_u32 v20, v16, 5, 1
    v_lshl_add_u32 v114, v20, 15, v114
    s_lshl_b32 s7, s63, 15
    s_add_u32 s7, s7, 32768
    v_add_u32 v114, s7, v114
    v_subrev_u32 v116, s35, v114
    v_add_u32 v114, s35, v114
    v_xor_b32 v115, 32, v114
    v_xor_b32 v117, 32, v116
    s_waitcnt lgkmcnt(0)
    s_mov_b32 s8, 4194304
    s_lshl_b32 s7, s4, 21
    s_add_u32 s8, s8, s7
    s_add_u32 s12, s30, s8
    s_addc_u32 s13, s31, 0
    s_mov_b32 s8, 2097152
    s_lshl_b32 s7, s4, 13
    s_add_u32 s8, s8, s7
    s_add_u32 s20, s30, s8
    s_addc_u32 s21, s31, 0
    s_mov_b32 s8, 2099200
    s_add_u32 s16, s30, s8
    s_addc_u32 s17, s31, 0
    s_lshr_b32 s95, s3, 1
    s_lshl_b32 s95, s95, 12
    s_and_b32 s7, s3, 1
    s_lshl_b32 s7, s7, 7
    s_add_u32 s95, s95, s7
    s_lshr_b32 s58, s4, 3
    s_and_b32 s59, s4, 1
    s_bfe_u32 s6, s4, 0x10002
    s_bfe_u32 s5, s4, 0x10001
    s_mov_b32 s8, 2621440
    s_lshl_b32 s7, s95, 0
    s_add_u32 s8, s8, s7
    s_lshl_b32 s7, s58, 10
    s_add_u32 s8, s8, s7
    s_lshl_b32 s7, s59, 9
    s_add_u32 s8, s8, s7
    s_lshl_b32 s7, s6, 8
    s_add_u32 s8, s8, s7
    s_lshl_b32 s7, s5, 6
    s_add_u32 s8, s8, s7
    s_add_u32 s24, s30, s8
    s_addc_u32 s25, s31, 0
    s_mov_b32 s8, 2621440
    s_add_u32 s22, s30, s8
    s_addc_u32 s23, s31, 0
    s_mov_b32 s8, 149848064
    s_lshl_b32 s7, s4, 8
    s_add_u32 s8, s8, s7
    s_add_u32 s26, s30, s8
    s_addc_u32 s27, s31, 0
    s_mov_b32 s8, 149864448
    s_lshl_b32 s7, s4, 8
    s_add_u32 s8, s8, s7
    s_add_u32 s28, s30, s8
    s_addc_u32 s29, s31, 0
    s_mov_b32 s9, 0x3e0293ee
    v_mov_b32 v28, -1
    v_mov_b32 v29, -1
    v_mov_b32 v30, -1
    v_mov_b32 v31, -1
    global_store_dwordx4 v4, v[28:31], s[20:21] offset:0 sc1
    global_store_dwordx4 v4, v[28:31], s[20:21] offset:1024 sc1
    v_add_u32 v19, 0, v27
    global_store_dword v19, v28, s[24:25] sc1
    v_add_u32 v19, 8192, v27
    global_store_dword v19, v28, s[24:25] sc1
    v_add_u32 v19, 16384, v27
    global_store_dword v19, v28, s[24:25] sc1
    v_add_u32 v19, 24576, v27
    global_store_dword v19, v28, s[24:25] sc1
    v_bfe_u32 v20, v16, 2, 2
    v_lshlrev_b32 v19, 11, v20
    v_bfe_u32 v20, v16, 0, 1
    v_lshl_add_u32 v19, v20, 10, v19
    v_bfe_u32 v20, v16, 5, 1
    v_lshl_add_u32 v19, v20, 8, v19
    v_bfe_u32 v20, v16, 4, 1
    v_lshl_add_u32 v19, v20, 4, v19
    v_bfe_u32 v20, v16, 1, 1
    v_lshl_add_u32 v19, v20, 5, v19
    s_lshl_b32 s7, s3, 6
    v_add_u32 v19, s7, v19
    global_load_dwordx4 v[32:35], v19, s[48:49] offset:0
    global_load_dwordx4 v[36:39], v19, s[48:49] offset:512
    v_mov_b32 v120, s9
    s_mov_b32 s5, 0
    s_waitcnt vmcnt(26)
    s_barrier
    ds_read_b64_tr_b16 v[128:129], v114 offset:0
    ds_read_b64_tr_b16 v[130:131], v114 offset:1024
    ds_read_b64_tr_b16 v[132:133], v114 offset:2048
    ds_read_b64_tr_b16 v[134:135], v114 offset:3072
    ds_read_b64_tr_b16 v[136:137], v115 offset:0
    ds_read_b64_tr_b16 v[138:139], v115 offset:1024
    ds_read_b64_tr_b16 v[140:141], v115 offset:2048
    ds_read_b64_tr_b16 v[142:143], v115 offset:3072
    ds_read_b64_tr_b16 v[144:145], v114 offset:4096
    ds_read_b64_tr_b16 v[146:147], v114 offset:5120
    ds_read_b64_tr_b16 v[148:149], v114 offset:6144
    ds_read_b64_tr_b16 v[150:151], v114 offset:7168
    ds_read_b64_tr_b16 v[152:153], v115 offset:4096
    ds_read_b64_tr_b16 v[154:155], v115 offset:5120
    ds_read_b64_tr_b16 v[156:157], v115 offset:6144
    ds_read_b64_tr_b16 v[158:159], v115 offset:7168
    ds_read_b64_tr_b16 v[160:161], v116 offset:8192
    ds_read_b64_tr_b16 v[162:163], v116 offset:9216
    ds_read_b64_tr_b16 v[164:165], v116 offset:10240
    ds_read_b64_tr_b16 v[166:167], v116 offset:11264
    ds_read_b64_tr_b16 v[168:169], v117 offset:8192
    ds_read_b64_tr_b16 v[170:171], v117 offset:9216
    ds_read_b64_tr_b16 v[172:173], v117 offset:10240
    ds_read_b64_tr_b16 v[174:175], v117 offset:11264
    ds_read_b64_tr_b16 v[176:177], v116 offset:12288
    ds_read_b64_tr_b16 v[178:179], v116 offset:13312
    ds_read_b64_tr_b16 v[180:181], v116 offset:14336
    ds_read_b64_tr_b16 v[182:183], v116 offset:15360
    ds_read_b64_tr_b16 v[184:185], v117 offset:12288
    ds_read_b64_tr_b16 v[186:187], v117 offset:13312
    ds_read_b64_tr_b16 v[188:189], v117 offset:14336
    ds_read_b64_tr_b16 v[190:191], v117 offset:15360
    s_waitcnt lgkmcnt(0)
    s_barrier
    s_mov_b32 s36, s44
    s_and_b32 s37, s45, 0xffff
    s_xor_b32 s7, s63, 0
    s_lshl_b32 s7, s7, 18
    s_add_u32 s7, s7, s60
    s_add_u32 m0, s57, 0
    s_add_u32 s62, s7, 0
    buffer_load_dwordx4 v22, s[36:39], s62 offen lds
    s_add_u32 m0, s57, 1024
    s_add_u32 s62, s7, 16384
    buffer_load_dwordx4 v22, s[36:39], s62 offen lds
    s_add_u32 m0, s57, 2048
    s_add_u32 s62, s7, 1048576
    buffer_load_dwordx4 v22, s[36:39], s62 offen lds
    s_add_u32 m0, s57, 3072
    s_add_u32 s62, s7, 1064960
    buffer_load_dwordx4 v22, s[36:39], s62 offen lds
    s_xor_b32 s7, s63, 0
    s_lshl_b32 s7, s7, 18
    s_add_u32 s7, s7, s60
    s_add_u32 m0, s57, 4096
    s_add_u32 s62, s7, 2097152
    buffer_load_dwordx4 v22, s[36:39], s62 offen lds
    s_add_u32 m0, s57, 5120
    s_add_u32 s62, s7, 2113536
    buffer_load_dwordx4 v22, s[36:39], s62 offen lds
    s_add_u32 m0, s57, 6144
    s_add_u32 s62, s7, 3145728
    buffer_load_dwordx4 v22, s[36:39], s62 offen lds
    s_add_u32 m0, s57, 7168
    s_add_u32 s62, s7, 3162112
    buffer_load_dwordx4 v22, s[36:39], s62 offen lds
    s_xor_b32 s7, s63, 1
    s_lshl_b32 s7, s7, 18
    s_add_u32 s7, s7, s60
    s_add_u32 m0, s57, 8192
    s_add_u32 s62, s7, 0
    buffer_load_dwordx4 v22, s[36:39], s62 offen lds
    s_add_u32 m0, s57, 9216
    s_add_u32 s62, s7, 16384
    buffer_load_dwordx4 v22, s[36:39], s62 offen lds
    s_add_u32 m0, s57, 10240
    s_add_u32 s62, s7, 1048576
    buffer_load_dwordx4 v22, s[36:39], s62 offen lds
    s_add_u32 m0, s57, 11264
    s_add_u32 s62, s7, 1064960
    buffer_load_dwordx4 v22, s[36:39], s62 offen lds
    s_xor_b32 s7, s63, 1
    s_lshl_b32 s7, s7, 18
    s_add_u32 s7, s7, s60
    s_add_u32 m0, s57, 12288
    s_add_u32 s62, s7, 2097152
    buffer_load_dwordx4 v22, s[36:39], s62 offen lds
    s_add_u32 m0, s57, 13312
    s_add_u32 s62, s7, 2113536
    buffer_load_dwordx4 v22, s[36:39], s62 offen lds
    s_add_u32 m0, s57, 14336
    s_add_u32 s62, s7, 3145728
    buffer_load_dwordx4 v22, s[36:39], s62 offen lds
    s_add_u32 m0, s57, 15360
    s_add_u32 s62, s7, 3162112
    buffer_load_dwordx4 v22, s[36:39], s62 offen lds
    s_waitcnt vmcnt(26)
    s_barrier
    ds_read_b64_tr_b16 v[48:49], v114 offset:16384
    ds_read_b64_tr_b16 v[50:51], v114 offset:17408
    ds_read_b64_tr_b16 v[52:53], v114 offset:18432
    ds_read_b64_tr_b16 v[54:55], v114 offset:19456
    ds_read_b64_tr_b16 v[56:57], v115 offset:16384
    ds_read_b64_tr_b16 v[58:59], v115 offset:17408
    ds_read_b64_tr_b16 v[60:61], v115 offset:18432
    ds_read_b64_tr_b16 v[62:63], v115 offset:19456
    ds_read_b64_tr_b16 v[64:65], v114 offset:20480
    ds_read_b64_tr_b16 v[66:67], v114 offset:21504
    ds_read_b64_tr_b16 v[68:69], v114 offset:22528
    ds_read_b64_tr_b16 v[70:71], v114 offset:23552
    ds_read_b64_tr_b16 v[72:73], v115 offset:20480
    ds_read_b64_tr_b16 v[74:75], v115 offset:21504
    ds_read_b64_tr_b16 v[76:77], v115 offset:22528
    ds_read_b64_tr_b16 v[78:79], v115 offset:23552
    ds_read_b64_tr_b16 v[80:81], v116 offset:24576
    ds_read_b64_tr_b16 v[82:83], v116 offset:25600
    ds_read_b64_tr_b16 v[84:85], v116 offset:26624
    ds_read_b64_tr_b16 v[86:87], v116 offset:27648
    ds_read_b64_tr_b16 v[88:89], v117 offset:24576
    ds_read_b64_tr_b16 v[90:91], v117 offset:25600
    ds_read_b64_tr_b16 v[92:93], v117 offset:26624
    ds_read_b64_tr_b16 v[94:95], v117 offset:27648
    ds_read_b64_tr_b16 v[96:97], v116 offset:28672
    ds_read_b64_tr_b16 v[98:99], v116 offset:29696
    ds_read_b64_tr_b16 v[100:101], v116 offset:30720
    ds_read_b64_tr_b16 v[102:103], v116 offset:31744
    ds_read_b64_tr_b16 v[104:105], v117 offset:28672
    ds_read_b64_tr_b16 v[106:107], v117 offset:29696
    ds_read_b64_tr_b16 v[108:109], v117 offset:30720
    ds_read_b64_tr_b16 v[110:111], v117 offset:31744
    s_waitcnt lgkmcnt(0)
    s_barrier
    s_mov_b32 s36, s42
    s_and_b32 s37, s43, 0xffff
    s_xor_b32 s7, s63, 2
    s_lshl_b32 s7, s7, 18
    s_add_u32 s7, s7, s60
    s_add_u32 m0, s57, 16384
    s_add_u32 s62, s7, 0
    buffer_load_dwordx4 v22, s[36:39], s62 offen lds
    s_add_u32 m0, s57, 17408
    s_add_u32 s62, s7, 16384
    buffer_load_dwordx4 v22, s[36:39], s62 offen lds
    s_add_u32 m0, s57, 18432
    s_add_u32 s62, s7, 1048576
    buffer_load_dwordx4 v22, s[36:39], s62 offen lds
    s_add_u32 m0, s57, 19456
    s_add_u32 s62, s7, 1064960
    buffer_load_dwordx4 v22, s[36:39], s62 offen lds
    s_xor_b32 s7, s63, 2
    s_lshl_b32 s7, s7, 18
    s_add_u32 s7, s7, s60
    s_add_u32 m0, s57, 20480
    s_add_u32 s62, s7, 2097152
    buffer_load_dwordx4 v22, s[36:39], s62 offen lds
    s_add_u32 m0, s57, 21504
    s_add_u32 s62, s7, 2113536
    buffer_load_dwordx4 v22, s[36:39], s62 offen lds
    s_add_u32 m0, s57, 22528
    s_add_u32 s62, s7, 3145728
    buffer_load_dwordx4 v22, s[36:39], s62 offen lds
    s_add_u32 m0, s57, 23552
    s_add_u32 s62, s7, 3162112
    buffer_load_dwordx4 v22, s[36:39], s62 offen lds
    s_xor_b32 s7, s63, 3
    s_lshl_b32 s7, s7, 18
    s_add_u32 s7, s7, s60
    s_add_u32 m0, s57, 24576
    s_add_u32 s62, s7, 0
    buffer_load_dwordx4 v22, s[36:39], s62 offen lds
    s_add_u32 m0, s57, 25600
    s_add_u32 s62, s7, 16384
    buffer_load_dwordx4 v22, s[36:39], s62 offen lds
    s_add_u32 m0, s57, 26624
    s_add_u32 s62, s7, 1048576
    buffer_load_dwordx4 v22, s[36:39], s62 offen lds
    s_add_u32 m0, s57, 27648
    s_add_u32 s62, s7, 1064960
    buffer_load_dwordx4 v22, s[36:39], s62 offen lds
    s_xor_b32 s7, s63, 3
    s_lshl_b32 s7, s7, 18
    s_add_u32 s7, s7, s60
    s_add_u32 m0, s57, 28672
    s_add_u32 s62, s7, 2097152
    buffer_load_dwordx4 v22, s[36:39], s62 offen lds
    s_add_u32 m0, s57, 29696
    s_add_u32 s62, s7, 2113536
    buffer_load_dwordx4 v22, s[36:39], s62 offen lds
    s_add_u32 m0, s57, 30720
    s_add_u32 s62, s7, 3145728
    buffer_load_dwordx4 v22, s[36:39], s62 offen lds
    s_add_u32 m0, s57, 31744
    s_add_u32 s62, s7, 3162112
    buffer_load_dwordx4 v22, s[36:39], s62 offen lds
    v_lshlrev_b32 v28, 16, v48
    v_and_b32 v29, 0xffff0000, v48
    v_lshlrev_b32 v30, 16, v49
    v_and_b32 v31, 0xffff0000, v49
    v_lshlrev_b32 v118, 16, v50
    v_and_b32 v119, 0xffff0000, v50
    v_lshlrev_b32 v126, 16, v51
    v_and_b32 v127, 0xffff0000, v51
    v_pk_mul_f32 v[28:29], v[28:29], v[120:121] op_sel_hi:[1,0]
    v_pk_mul_f32 v[30:31], v[30:31], v[120:121] op_sel_hi:[1,0]
    v_pk_mul_f32 v[118:119], v[118:119], v[120:121] op_sel_hi:[1,0]
    v_pk_mul_f32 v[126:127], v[126:127], v[120:121] op_sel_hi:[1,0]
    v_cvt_pk_bf16_f32 v48, v28, v29
    v_cvt_pk_bf16_f32 v49, v30, v31
    v_cvt_pk_bf16_f32 v50, v118, v119
    v_cvt_pk_bf16_f32 v51, v126, v127
    v_accvgpr_write_b32 a144, v48
    v_accvgpr_write_b32 a145, v49
    v_accvgpr_write_b32 a146, v50
    v_accvgpr_write_b32 a147, v51
    v_lshlrev_b32 v28, 16, v52
    v_and_b32 v29, 0xffff0000, v52
    v_lshlrev_b32 v30, 16, v53
    v_and_b32 v31, 0xffff0000, v53
    v_lshlrev_b32 v118, 16, v54
    v_and_b32 v119, 0xffff0000, v54
    v_lshlrev_b32 v126, 16, v55
    v_and_b32 v127, 0xffff0000, v55
    v_pk_mul_f32 v[28:29], v[28:29], v[120:121] op_sel_hi:[1,0]
    v_pk_mul_f32 v[30:31], v[30:31], v[120:121] op_sel_hi:[1,0]
    v_pk_mul_f32 v[118:119], v[118:119], v[120:121] op_sel_hi:[1,0]
    v_pk_mul_f32 v[126:127], v[126:127], v[120:121] op_sel_hi:[1,0]
    v_cvt_pk_bf16_f32 v52, v28, v29
    v_cvt_pk_bf16_f32 v53, v30, v31
    v_cvt_pk_bf16_f32 v54, v118, v119
    v_cvt_pk_bf16_f32 v55, v126, v127
    v_accvgpr_write_b32 a148, v52
    v_accvgpr_write_b32 a149, v53
    v_accvgpr_write_b32 a150, v54
    v_accvgpr_write_b32 a151, v55
    v_lshlrev_b32 v28, 16, v56
    v_and_b32 v29, 0xffff0000, v56
    v_lshlrev_b32 v30, 16, v57
    v_and_b32 v31, 0xffff0000, v57
    v_lshlrev_b32 v118, 16, v58
    v_and_b32 v119, 0xffff0000, v58
    v_lshlrev_b32 v126, 16, v59
    v_and_b32 v127, 0xffff0000, v59
    v_pk_mul_f32 v[28:29], v[28:29], v[120:121] op_sel_hi:[1,0]
    v_pk_mul_f32 v[30:31], v[30:31], v[120:121] op_sel_hi:[1,0]
    v_pk_mul_f32 v[118:119], v[118:119], v[120:121] op_sel_hi:[1,0]
    v_pk_mul_f32 v[126:127], v[126:127], v[120:121] op_sel_hi:[1,0]
    v_cvt_pk_bf16_f32 v56, v28, v29
    v_cvt_pk_bf16_f32 v57, v30, v31
    v_cvt_pk_bf16_f32 v58, v118, v119
    v_cvt_pk_bf16_f32 v59, v126, v127
    v_accvgpr_write_b32 a152, v56
    v_accvgpr_write_b32 a153, v57
    v_accvgpr_write_b32 a154, v58
    v_accvgpr_write_b32 a155, v59
    v_lshlrev_b32 v28, 16, v60
    v_and_b32 v29, 0xffff0000, v60
    v_lshlrev_b32 v30, 16, v61
    v_and_b32 v31, 0xffff0000, v61
    v_lshlrev_b32 v118, 16, v62
    v_and_b32 v119, 0xffff0000, v62
    v_lshlrev_b32 v126, 16, v63
    v_and_b32 v127, 0xffff0000, v63
    v_pk_mul_f32 v[28:29], v[28:29], v[120:121] op_sel_hi:[1,0]
    v_pk_mul_f32 v[30:31], v[30:31], v[120:121] op_sel_hi:[1,0]
    v_pk_mul_f32 v[118:119], v[118:119], v[120:121] op_sel_hi:[1,0]
    v_pk_mul_f32 v[126:127], v[126:127], v[120:121] op_sel_hi:[1,0]
    v_cvt_pk_bf16_f32 v60, v28, v29
    v_cvt_pk_bf16_f32 v61, v30, v31
    v_cvt_pk_bf16_f32 v62, v118, v119
    v_cvt_pk_bf16_f32 v63, v126, v127
    v_accvgpr_write_b32 a156, v60
    v_accvgpr_write_b32 a157, v61
    v_accvgpr_write_b32 a158, v62
    v_accvgpr_write_b32 a159, v63
    v_lshlrev_b32 v28, 16, v64
    v_and_b32 v29, 0xffff0000, v64
    v_lshlrev_b32 v30, 16, v65
    v_and_b32 v31, 0xffff0000, v65
    v_lshlrev_b32 v118, 16, v66
    v_and_b32 v119, 0xffff0000, v66
    v_lshlrev_b32 v126, 16, v67
    v_and_b32 v127, 0xffff0000, v67
    v_pk_mul_f32 v[28:29], v[28:29], v[120:121] op_sel_hi:[1,0]
    v_pk_mul_f32 v[30:31], v[30:31], v[120:121] op_sel_hi:[1,0]
    v_pk_mul_f32 v[118:119], v[118:119], v[120:121] op_sel_hi:[1,0]
    v_pk_mul_f32 v[126:127], v[126:127], v[120:121] op_sel_hi:[1,0]
    v_cvt_pk_bf16_f32 v64, v28, v29
    v_cvt_pk_bf16_f32 v65, v30, v31
    v_cvt_pk_bf16_f32 v66, v118, v119
    v_cvt_pk_bf16_f32 v67, v126, v127
    v_accvgpr_write_b32 a160, v64
    v_accvgpr_write_b32 a161, v65
    v_accvgpr_write_b32 a162, v66
    v_accvgpr_write_b32 a163, v67
    v_lshlrev_b32 v28, 16, v68
    v_and_b32 v29, 0xffff0000, v68
    v_lshlrev_b32 v30, 16, v69
    v_and_b32 v31, 0xffff0000, v69
    v_lshlrev_b32 v118, 16, v70
    v_and_b32 v119, 0xffff0000, v70
    v_lshlrev_b32 v126, 16, v71
    v_and_b32 v127, 0xffff0000, v71
    v_pk_mul_f32 v[28:29], v[28:29], v[120:121] op_sel_hi:[1,0]
    v_pk_mul_f32 v[30:31], v[30:31], v[120:121] op_sel_hi:[1,0]
    v_pk_mul_f32 v[118:119], v[118:119], v[120:121] op_sel_hi:[1,0]
    v_pk_mul_f32 v[126:127], v[126:127], v[120:121] op_sel_hi:[1,0]
    v_cvt_pk_bf16_f32 v68, v28, v29
    v_cvt_pk_bf16_f32 v69, v30, v31
    v_cvt_pk_bf16_f32 v70, v118, v119
    v_cvt_pk_bf16_f32 v71, v126, v127
    v_accvgpr_write_b32 a164, v68
    v_accvgpr_write_b32 a165, v69
    v_accvgpr_write_b32 a166, v70
    v_accvgpr_write_b32 a167, v71
    v_lshlrev_b32 v28, 16, v72
    v_and_b32 v29, 0xffff0000, v72
    v_lshlrev_b32 v30, 16, v73
    v_and_b32 v31, 0xffff0000, v73
    v_lshlrev_b32 v118, 16, v74
    v_and_b32 v119, 0xffff0000, v74
    v_lshlrev_b32 v126, 16, v75
    v_and_b32 v127, 0xffff0000, v75
    v_pk_mul_f32 v[28:29], v[28:29], v[120:121] op_sel_hi:[1,0]
    v_pk_mul_f32 v[30:31], v[30:31], v[120:121] op_sel_hi:[1,0]
    v_pk_mul_f32 v[118:119], v[118:119], v[120:121] op_sel_hi:[1,0]
    v_pk_mul_f32 v[126:127], v[126:127], v[120:121] op_sel_hi:[1,0]
    v_cvt_pk_bf16_f32 v72, v28, v29
    v_cvt_pk_bf16_f32 v73, v30, v31
    v_cvt_pk_bf16_f32 v74, v118, v119
    v_cvt_pk_bf16_f32 v75, v126, v127
    v_accvgpr_write_b32 a168, v72
    v_accvgpr_write_b32 a169, v73
    v_accvgpr_write_b32 a170, v74
    v_accvgpr_write_b32 a171, v75
    v_lshlrev_b32 v28, 16, v76
    v_and_b32 v29, 0xffff0000, v76
    v_lshlrev_b32 v30, 16, v77
    v_and_b32 v31, 0xffff0000, v77
    v_lshlrev_b32 v118, 16, v78
    v_and_b32 v119, 0xffff0000, v78
    v_lshlrev_b32 v126, 16, v79
    v_and_b32 v127, 0xffff0000, v79
    v_pk_mul_f32 v[28:29], v[28:29], v[120:121] op_sel_hi:[1,0]
    v_pk_mul_f32 v[30:31], v[30:31], v[120:121] op_sel_hi:[1,0]
    v_pk_mul_f32 v[118:119], v[118:119], v[120:121] op_sel_hi:[1,0]
    v_pk_mul_f32 v[126:127], v[126:127], v[120:121] op_sel_hi:[1,0]
    v_cvt_pk_bf16_f32 v76, v28, v29
    v_cvt_pk_bf16_f32 v77, v30, v31
    v_cvt_pk_bf16_f32 v78, v118, v119
    v_cvt_pk_bf16_f32 v79, v126, v127
    v_accvgpr_write_b32 a172, v76
    v_accvgpr_write_b32 a173, v77
    v_accvgpr_write_b32 a174, v78
    v_accvgpr_write_b32 a175, v79
    v_lshlrev_b32 v28, 16, v80
    v_and_b32 v29, 0xffff0000, v80
    v_lshlrev_b32 v30, 16, v81
    v_and_b32 v31, 0xffff0000, v81
    v_lshlrev_b32 v118, 16, v82
    v_and_b32 v119, 0xffff0000, v82
    v_lshlrev_b32 v126, 16, v83
    v_and_b32 v127, 0xffff0000, v83
    v_pk_mul_f32 v[28:29], v[28:29], v[120:121] op_sel_hi:[1,0]
    v_pk_mul_f32 v[30:31], v[30:31], v[120:121] op_sel_hi:[1,0]
    v_pk_mul_f32 v[118:119], v[118:119], v[120:121] op_sel_hi:[1,0]
    v_pk_mul_f32 v[126:127], v[126:127], v[120:121] op_sel_hi:[1,0]
    v_cvt_pk_bf16_f32 v80, v28, v29
    v_cvt_pk_bf16_f32 v81, v30, v31
    v_cvt_pk_bf16_f32 v82, v118, v119
    v_cvt_pk_bf16_f32 v83, v126, v127
    v_accvgpr_write_b32 a176, v80
    v_accvgpr_write_b32 a177, v81
    v_accvgpr_write_b32 a178, v82
    v_accvgpr_write_b32 a179, v83
    v_lshlrev_b32 v28, 16, v84
    v_and_b32 v29, 0xffff0000, v84
    v_lshlrev_b32 v30, 16, v85
    v_and_b32 v31, 0xffff0000, v85
    v_lshlrev_b32 v118, 16, v86
    v_and_b32 v119, 0xffff0000, v86
    v_lshlrev_b32 v126, 16, v87
    v_and_b32 v127, 0xffff0000, v87
    v_pk_mul_f32 v[28:29], v[28:29], v[120:121] op_sel_hi:[1,0]
    v_pk_mul_f32 v[30:31], v[30:31], v[120:121] op_sel_hi:[1,0]
    v_pk_mul_f32 v[118:119], v[118:119], v[120:121] op_sel_hi:[1,0]
    v_pk_mul_f32 v[126:127], v[126:127], v[120:121] op_sel_hi:[1,0]
    v_cvt_pk_bf16_f32 v84, v28, v29
    v_cvt_pk_bf16_f32 v85, v30, v31
    v_cvt_pk_bf16_f32 v86, v118, v119
    v_cvt_pk_bf16_f32 v87, v126, v127
    v_accvgpr_write_b32 a180, v84
    v_accvgpr_write_b32 a181, v85
    v_accvgpr_write_b32 a182, v86
    v_accvgpr_write_b32 a183, v87
    v_lshlrev_b32 v28, 16, v88
    v_and_b32 v29, 0xffff0000, v88
    v_lshlrev_b32 v30, 16, v89
    v_and_b32 v31, 0xffff0000, v89
    v_lshlrev_b32 v118, 16, v90
    v_and_b32 v119, 0xffff0000, v90
    v_lshlrev_b32 v126, 16, v91
    v_and_b32 v127, 0xffff0000, v91
    v_pk_mul_f32 v[28:29], v[28:29], v[120:121] op_sel_hi:[1,0]
    v_pk_mul_f32 v[30:31], v[30:31], v[120:121] op_sel_hi:[1,0]
    v_pk_mul_f32 v[118:119], v[118:119], v[120:121] op_sel_hi:[1,0]
    v_pk_mul_f32 v[126:127], v[126:127], v[120:121] op_sel_hi:[1,0]
    v_cvt_pk_bf16_f32 v88, v28, v29
    v_cvt_pk_bf16_f32 v89, v30, v31
    v_cvt_pk_bf16_f32 v90, v118, v119
    v_cvt_pk_bf16_f32 v91, v126, v127
    v_accvgpr_write_b32 a184, v88
    v_accvgpr_write_b32 a185, v89
    v_accvgpr_write_b32 a186, v90
    v_accvgpr_write_b32 a187, v91
    v_lshlrev_b32 v28, 16, v92
    v_and_b32 v29, 0xffff0000, v92
    v_lshlrev_b32 v30, 16, v93
    v_and_b32 v31, 0xffff0000, v93
    v_lshlrev_b32 v118, 16, v94
    v_and_b32 v119, 0xffff0000, v94
    v_lshlrev_b32 v126, 16, v95
    v_and_b32 v127, 0xffff0000, v95
    v_pk_mul_f32 v[28:29], v[28:29], v[120:121] op_sel_hi:[1,0]
    v_pk_mul_f32 v[30:31], v[30:31], v[120:121] op_sel_hi:[1,0]
    v_pk_mul_f32 v[118:119], v[118:119], v[120:121] op_sel_hi:[1,0]
    v_pk_mul_f32 v[126:127], v[126:127], v[120:121] op_sel_hi:[1,0]
    v_cvt_pk_bf16_f32 v92, v28, v29
    v_cvt_pk_bf16_f32 v93, v30, v31
    v_cvt_pk_bf16_f32 v94, v118, v119
    v_cvt_pk_bf16_f32 v95, v126, v127
    v_accvgpr_write_b32 a188, v92
    v_accvgpr_write_b32 a189, v93
    v_accvgpr_write_b32 a190, v94
    v_accvgpr_write_b32 a191, v95
    v_lshlrev_b32 v28, 16, v96
    v_and_b32 v29, 0xffff0000, v96
    v_lshlrev_b32 v30, 16, v97
    v_and_b32 v31, 0xffff0000, v97
    v_lshlrev_b32 v118, 16, v98
    v_and_b32 v119, 0xffff0000, v98
    v_lshlrev_b32 v126, 16, v99
    v_and_b32 v127, 0xffff0000, v99
    v_pk_mul_f32 v[28:29], v[28:29], v[120:121] op_sel_hi:[1,0]
    v_pk_mul_f32 v[30:31], v[30:31], v[120:121] op_sel_hi:[1,0]
    v_pk_mul_f32 v[118:119], v[118:119], v[120:121] op_sel_hi:[1,0]
    v_pk_mul_f32 v[126:127], v[126:127], v[120:121] op_sel_hi:[1,0]
    v_cvt_pk_bf16_f32 v96, v28, v29
    v_cvt_pk_bf16_f32 v97, v30, v31
    v_cvt_pk_bf16_f32 v98, v118, v119
    v_cvt_pk_bf16_f32 v99, v126, v127
    v_accvgpr_write_b32 a192, v96
    v_accvgpr_write_b32 a193, v97
    v_accvgpr_write_b32 a194, v98
    v_accvgpr_write_b32 a195, v99
    v_lshlrev_b32 v28, 16, v100
    v_and_b32 v29, 0xffff0000, v100
    v_lshlrev_b32 v30, 16, v101
    v_and_b32 v31, 0xffff0000, v101
    v_lshlrev_b32 v118, 16, v102
    v_and_b32 v119, 0xffff0000, v102
    v_lshlrev_b32 v126, 16, v103
    v_and_b32 v127, 0xffff0000, v103
    v_pk_mul_f32 v[28:29], v[28:29], v[120:121] op_sel_hi:[1,0]
    v_pk_mul_f32 v[30:31], v[30:31], v[120:121] op_sel_hi:[1,0]
    v_pk_mul_f32 v[118:119], v[118:119], v[120:121] op_sel_hi:[1,0]
    v_pk_mul_f32 v[126:127], v[126:127], v[120:121] op_sel_hi:[1,0]
    v_cvt_pk_bf16_f32 v100, v28, v29
    v_cvt_pk_bf16_f32 v101, v30, v31
    v_cvt_pk_bf16_f32 v102, v118, v119
    v_cvt_pk_bf16_f32 v103, v126, v127
    v_accvgpr_write_b32 a196, v100
    v_accvgpr_write_b32 a197, v101
    v_accvgpr_write_b32 a198, v102
    v_accvgpr_write_b32 a199, v103
    v_lshlrev_b32 v28, 16, v104
    v_and_b32 v29, 0xffff0000, v104
    v_lshlrev_b32 v30, 16, v105
    v_and_b32 v31, 0xffff0000, v105
    v_lshlrev_b32 v118, 16, v106
    v_and_b32 v119, 0xffff0000, v106
    v_lshlrev_b32 v126, 16, v107
    v_and_b32 v127, 0xffff0000, v107
    v_pk_mul_f32 v[28:29], v[28:29], v[120:121] op_sel_hi:[1,0]
    v_pk_mul_f32 v[30:31], v[30:31], v[120:121] op_sel_hi:[1,0]
    v_pk_mul_f32 v[118:119], v[118:119], v[120:121] op_sel_hi:[1,0]
    v_pk_mul_f32 v[126:127], v[126:127], v[120:121] op_sel_hi:[1,0]
    v_cvt_pk_bf16_f32 v104, v28, v29
    v_cvt_pk_bf16_f32 v105, v30, v31
    v_cvt_pk_bf16_f32 v106, v118, v119
    v_cvt_pk_bf16_f32 v107, v126, v127
    v_accvgpr_write_b32 a200, v104
    v_accvgpr_write_b32 a201, v105
    v_accvgpr_write_b32 a202, v106
    v_accvgpr_write_b32 a203, v107
    v_lshlrev_b32 v28, 16, v108
    v_and_b32 v29, 0xffff0000, v108
    v_lshlrev_b32 v30, 16, v109
    v_and_b32 v31, 0xffff0000, v109
    v_lshlrev_b32 v118, 16, v110
    v_and_b32 v119, 0xffff0000, v110
    v_lshlrev_b32 v126, 16, v111
    v_and_b32 v127, 0xffff0000, v111
    v_pk_mul_f32 v[28:29], v[28:29], v[120:121] op_sel_hi:[1,0]
    v_pk_mul_f32 v[30:31], v[30:31], v[120:121] op_sel_hi:[1,0]
    v_pk_mul_f32 v[118:119], v[118:119], v[120:121] op_sel_hi:[1,0]
    v_pk_mul_f32 v[126:127], v[126:127], v[120:121] op_sel_hi:[1,0]
    v_cvt_pk_bf16_f32 v108, v28, v29
    v_cvt_pk_bf16_f32 v109, v30, v31
    v_cvt_pk_bf16_f32 v110, v118, v119
    v_cvt_pk_bf16_f32 v111, v126, v127
    v_accvgpr_write_b32 a204, v108
    v_accvgpr_write_b32 a205, v109
    v_accvgpr_write_b32 a206, v110
    v_accvgpr_write_b32 a207, v111
    s_waitcnt vmcnt(16)
    s_barrier
    ds_read_b64_tr_b16 a[0:1], v114 offset:0
    ds_read_b64_tr_b16 a[2:3], v114 offset:1024
    ds_read_b64_tr_b16 a[4:5], v114 offset:2048
    ds_read_b64_tr_b16 a[6:7], v114 offset:3072
    ds_read_b64_tr_b16 a[8:9], v115 offset:0
    ds_read_b64_tr_b16 a[10:11], v115 offset:1024
    ds_read_b64_tr_b16 a[12:13], v115 offset:2048
    ds_read_b64_tr_b16 a[14:15], v115 offset:3072
    ds_read_b64_tr_b16 a[16:17], v114 offset:4096
    ds_read_b64_tr_b16 a[18:19], v114 offset:5120
    ds_read_b64_tr_b16 a[20:21], v114 offset:6144
    ds_read_b64_tr_b16 a[22:23], v114 offset:7168
    ds_read_b64_tr_b16 a[24:25], v115 offset:4096
    ds_read_b64_tr_b16 a[26:27], v115 offset:5120
    ds_read_b64_tr_b16 a[28:29], v115 offset:6144
    ds_read_b64_tr_b16 a[30:31], v115 offset:7168
    ds_read_b64_tr_b16 a[32:33], v116 offset:8192
    ds_read_b64_tr_b16 a[34:35], v116 offset:9216
    ds_read_b64_tr_b16 a[36:37], v116 offset:10240
    ds_read_b64_tr_b16 a[38:39], v116 offset:11264
    ds_read_b64_tr_b16 a[40:41], v117 offset:8192
    ds_read_b64_tr_b16 a[42:43], v117 offset:9216
    ds_read_b64_tr_b16 a[44:45], v117 offset:10240
    ds_read_b64_tr_b16 a[46:47], v117 offset:11264
    ds_read_b64_tr_b16 a[48:49], v116 offset:12288
    ds_read_b64_tr_b16 a[50:51], v116 offset:13312
    ds_read_b64_tr_b16 a[52:53], v116 offset:14336
    ds_read_b64_tr_b16 a[54:55], v116 offset:15360
    ds_read_b64_tr_b16 a[56:57], v117 offset:12288
    ds_read_b64_tr_b16 a[58:59], v117 offset:13312
    ds_read_b64_tr_b16 a[60:61], v117 offset:14336
    ds_read_b64_tr_b16 a[62:63], v117 offset:15360
    s_waitcnt lgkmcnt(0)
    s_barrier
    s_mov_b32 s36, s44
    s_and_b32 s37, s45, 0xffff
    s_xor_b32 s7, s63, 2
    s_lshl_b32 s7, s7, 18
    s_add_u32 s7, s7, s60
    s_add_u32 m0, s57, 0
    s_add_u32 s62, s7, 0
    buffer_load_dwordx4 v22, s[36:39], s62 offen lds
    s_add_u32 m0, s57, 1024
    s_add_u32 s62, s7, 16384
    buffer_load_dwordx4 v22, s[36:39], s62 offen lds
    s_add_u32 m0, s57, 2048
    s_add_u32 s62, s7, 1048576
    buffer_load_dwordx4 v22, s[36:39], s62 offen lds
    s_add_u32 m0, s57, 3072
    s_add_u32 s62, s7, 1064960
    buffer_load_dwordx4 v22, s[36:39], s62 offen lds
    s_xor_b32 s7, s63, 2
    s_lshl_b32 s7, s7, 18
    s_add_u32 s7, s7, s60
    s_add_u32 m0, s57, 4096
    s_add_u32 s62, s7, 2097152
    buffer_load_dwordx4 v22, s[36:39], s62 offen lds
    s_add_u32 m0, s57, 5120
    s_add_u32 s62, s7, 2113536
    buffer_load_dwordx4 v22, s[36:39], s62 offen lds
    s_add_u32 m0, s57, 6144
    s_add_u32 s62, s7, 3145728
    buffer_load_dwordx4 v22, s[36:39], s62 offen lds
    s_add_u32 m0, s57, 7168
    s_add_u32 s62, s7, 3162112
    buffer_load_dwordx4 v22, s[36:39], s62 offen lds
    s_xor_b32 s7, s63, 3
    s_lshl_b32 s7, s7, 18
    s_add_u32 s7, s7, s60
    s_add_u32 m0, s57, 8192
    s_add_u32 s62, s7, 0
    buffer_load_dwordx4 v22, s[36:39], s62 offen lds
    s_add_u32 m0, s57, 9216
    s_add_u32 s62, s7, 16384
    buffer_load_dwordx4 v22, s[36:39], s62 offen lds
    s_add_u32 m0, s57, 10240
    s_add_u32 s62, s7, 1048576
    buffer_load_dwordx4 v22, s[36:39], s62 offen lds
    s_add_u32 m0, s57, 11264
    s_add_u32 s62, s7, 1064960
    buffer_load_dwordx4 v22, s[36:39], s62 offen lds
    s_xor_b32 s7, s63, 3
    s_lshl_b32 s7, s7, 18
    s_add_u32 s7, s7, s60
    s_add_u32 m0, s57, 12288
    s_add_u32 s62, s7, 2097152
    buffer_load_dwordx4 v22, s[36:39], s62 offen lds
    s_add_u32 m0, s57, 13312
    s_add_u32 s62, s7, 2113536
    buffer_load_dwordx4 v22, s[36:39], s62 offen lds
    s_add_u32 m0, s57, 14336
    s_add_u32 s62, s7, 3145728
    buffer_load_dwordx4 v22, s[36:39], s62 offen lds
    s_add_u32 m0, s57, 15360
    s_add_u32 s62, s7, 3162112
    buffer_load_dwordx4 v22, s[36:39], s62 offen lds
    s_cmp_lg_u32 s3, 0
    s_cbranch_scc1 T_noarr_2
    s_getreg_b32 s7, hwreg(HW_REG_XCC_ID)
    s_and_b32 s7, s7, 7
    s_lshl_b32 s7, s7, 2
    v_mov_b32 v19, s7
    v_mov_b32 v20, 1
    s_mov_b64 exec, 1
    global_atomic_add v19, v20, s[32:33] sc1
    s_mov_b64 exec, -1
T_noarr_2:
    s_waitcnt vmcnt(16)
    s_barrier
    ds_read_b64_tr_b16 v[192:193], v114 offset:16384
    ds_read_b64_tr_b16 v[194:195], v114 offset:17408
    ds_read_b64_tr_b16 v[196:197], v114 offset:18432
    ds_read_b64_tr_b16 v[198:199], v114 offset:19456
    ds_read_b64_tr_b16 v[200:201], v115 offset:16384
    ds_read_b64_tr_b16 v[202:203], v115 offset:17408
    ds_read_b64_tr_b16 v[204:205], v115 offset:18432
    ds_read_b64_tr_b16 v[206:207], v115 offset:19456
    ds_read_b64_tr_b16 v[208:209], v114 offset:20480
    ds_read_b64_tr_b16 v[210:211], v114 offset:21504
    ds_read_b64_tr_b16 v[212:213], v114 offset:22528
    ds_read_b64_tr_b16 v[214:215], v114 offset:23552
    ds_read_b64_tr_b16 v[216:217], v115 offset:20480
    ds_read_b64_tr_b16 v[218:219], v115 offset:21504
    ds_read_b64_tr_b16 v[220:221], v115 offset:22528
    ds_read_b64_tr_b16 v[222:223], v115 offset:23552
    ds_read_b64_tr_b16 v[224:225], v116 offset:24576
    ds_read_b64_tr_b16 v[226:227], v116 offset:25600
    ds_read_b64_tr_b16 v[228:229], v116 offset:26624
    ds_read_b64_tr_b16 v[230:231], v116 offset:27648
    ds_read_b64_tr_b16 v[232:233], v117 offset:24576
    ds_read_b64_tr_b16 v[234:235], v117 offset:25600
    ds_read_b64_tr_b16 v[236:237], v117 offset:26624
    ds_read_b64_tr_b16 v[238:239], v117 offset:27648
    ds_read_b64_tr_b16 v[240:241], v116 offset:28672
    ds_read_b64_tr_b16 v[242:243], v116 offset:29696
    ds_read_b64_tr_b16 v[244:245], v116 offset:30720
    ds_read_b64_tr_b16 v[246:247], v116 offset:31744
    ds_read_b64_tr_b16 v[248:249], v117 offset:28672
    ds_read_b64_tr_b16 v[250:251], v117 offset:29696
    ds_read_b64_tr_b16 v[252:253], v117 offset:30720
    ds_read_b64_tr_b16 v[254:255], v117 offset:31744
    s_waitcnt lgkmcnt(0)
    s_barrier
    s_mov_b32 s36, s46
    s_and_b32 s37, s47, 0xffff
    s_add_u32 m0, s57, 16384
    s_add_u32 s62, s61, 0
    buffer_load_dwordx4 v23, s[36:39], s62 offen lds
    s_add_u32 m0, s57, 17408
    s_add_u32 s62, s61, 2048
    buffer_load_dwordx4 v23, s[36:39], s62 offen lds
    s_add_u32 m0, s57, 18432
    s_add_u32 s62, s61, 32768
    buffer_load_dwordx4 v23, s[36:39], s62 offen lds
    s_add_u32 m0, s57, 19456
    s_add_u32 s62, s61, 34816
    buffer_load_dwordx4 v23, s[36:39], s62 offen lds
    s_add_u32 m0, s57, 20480
    s_add_u32 s62, s61, 8192
    buffer_load_dwordx4 v23, s[36:39], s62 offen lds
    s_add_u32 m0, s57, 21504
    s_add_u32 s62, s61, 10240
    buffer_load_dwordx4 v23, s[36:39], s62 offen lds
    s_add_u32 m0, s57, 22528
    s_add_u32 s62, s61, 40960
    buffer_load_dwordx4 v23, s[36:39], s62 offen lds
    s_add_u32 m0, s57, 23552
    s_add_u32 s62, s61, 43008
    buffer_load_dwordx4 v23, s[36:39], s62 offen lds
    s_add_u32 m0, s57, 24576
    s_add_u32 s62, s61, 65536
    buffer_load_dwordx4 v23, s[36:39], s62 offen lds
    s_add_u32 m0, s57, 25600
    s_add_u32 s62, s61, 67584
    buffer_load_dwordx4 v23, s[36:39], s62 offen lds
    s_add_u32 m0, s57, 26624
    s_add_u32 s62, s61, 98304
    buffer_load_dwordx4 v23, s[36:39], s62 offen lds
    s_add_u32 m0, s57, 27648
    s_add_u32 s62, s61, 100352
    buffer_load_dwordx4 v23, s[36:39], s62 offen lds
    s_add_u32 m0, s57, 28672
    s_add_u32 s62, s61, 73728
    buffer_load_dwordx4 v23, s[36:39], s62 offen lds
    s_add_u32 m0, s57, 29696
    s_add_u32 s62, s61, 75776
    buffer_load_dwordx4 v23, s[36:39], s62 offen lds
    s_add_u32 m0, s57, 30720
    s_add_u32 s62, s61, 106496
    buffer_load_dwordx4 v23, s[36:39], s62 offen lds
    s_add_u32 m0, s57, 31744
    s_add_u32 s62, s61, 108544
    buffer_load_dwordx4 v23, s[36:39], s62 offen lds
    s_waitcnt vmcnt(16)
    s_barrier
    ds_read_b64_tr_b16 a[64:65], v114 offset:0
    ds_read_b64_tr_b16 a[66:67], v114 offset:1024
    ds_read_b64_tr_b16 a[68:69], v114 offset:2048
    ds_read_b64_tr_b16 a[70:71], v114 offset:3072
    ds_read_b64_tr_b16 a[72:73], v115 offset:0
    ds_read_b64_tr_b16 a[74:75], v115 offset:1024
    ds_read_b64_tr_b16 a[76:77], v115 offset:2048
    ds_read_b64_tr_b16 a[78:79], v115 offset:3072
    ds_read_b64_tr_b16 a[80:81], v114 offset:4096
    ds_read_b64_tr_b16 a[82:83], v114 offset:5120
    ds_read_b64_tr_b16 a[84:85], v114 offset:6144
    ds_read_b64_tr_b16 a[86:87], v114 offset:7168
    ds_read_b64_tr_b16 a[88:89], v115 offset:4096
    ds_read_b64_tr_b16 a[90:91], v115 offset:5120
    ds_read_b64_tr_b16 a[92:93], v115 offset:6144
    ds_read_b64_tr_b16 a[94:95], v115 offset:7168
    ds_read_b64_tr_b16 a[96:97], v116 offset:8192
    ds_read_b64_tr_b16 a[98:99], v116 offset:9216
    ds_read_b64_tr_b16 a[100:101], v116 offset:10240
    ds_read_b64_tr_b16 a[102:103], v116 offset:11264
    ds_read_b64_tr_b16 a[104:105], v117 offset:8192
    ds_read_b64_tr_b16 a[106:107], v117 offset:9216
    ds_read_b64_tr_b16 a[108:109], v117 offset:10240
    ds_read_b64_tr_b16 a[110:111], v117 offset:11264
    ds_read_b64_tr_b16 a[112:113], v116 offset:12288
    ds_read_b64_tr_b16 a[114:115], v116 offset:13312
    ds_read_b64_tr_b16 a[116:117], v116 offset:14336
    ds_read_b64_tr_b16 a[118:119], v116 offset:15360
    ds_read_b64_tr_b16 a[120:121], v117 offset:12288
    ds_read_b64_tr_b16 a[122:123], v117 offset:13312
    ds_read_b64_tr_b16 a[124:125], v117 offset:14336
    ds_read_b64_tr_b16 a[126:127], v117 offset:15360
    s_waitcnt lgkmcnt(0)
    s_barrier
    s_mov_b32 s36, s40
    s_and_b32 s37, s41, 0xffff
    s_xor_b32 s7, s63, 0
    s_lshl_b32 s7, s7, 18
    s_add_u32 s7, s7, s60
    s_add_u32 m0, s57, 0
    s_add_u32 s62, s7, 0
    buffer_load_dwordx4 v22, s[36:39], s62 offen lds
    s_add_u32 m0, s57, 1024
    s_add_u32 s62, s7, 16384
    buffer_load_dwordx4 v22, s[36:39], s62 offen lds
    s_add_u32 m0, s57, 2048
    s_add_u32 s62, s7, 1048576
    buffer_load_dwordx4 v22, s[36:39], s62 offen lds
    s_add_u32 m0, s57, 3072
    s_add_u32 s62, s7, 1064960
    buffer_load_dwordx4 v22, s[36:39], s62 offen lds
    s_xor_b32 s7, s63, 0
    s_lshl_b32 s7, s7, 18
    s_add_u32 s7, s7, s60
    s_add_u32 m0, s57, 4096
    s_add_u32 s62, s7, 2097152
    buffer_load_dwordx4 v22, s[36:39], s62 offen lds
    s_add_u32 m0, s57, 5120
    s_add_u32 s62, s7, 2113536
    buffer_load_dwordx4 v22, s[36:39], s62 offen lds
    s_add_u32 m0, s57, 6144
    s_add_u32 s62, s7, 3145728
    buffer_load_dwordx4 v22, s[36:39], s62 offen lds
    s_add_u32 m0, s57, 7168
    s_add_u32 s62, s7, 3162112
    buffer_load_dwordx4 v22, s[36:39], s62 offen lds
    s_xor_b32 s7, s63, 1
    s_lshl_b32 s7, s7, 18
    s_add_u32 s7, s7, s60
    s_add_u32 m0, s57, 8192
    s_add_u32 s62, s7, 0
    buffer_load_dwordx4 v22, s[36:39], s62 offen lds
    s_add_u32 m0, s57, 9216
    s_add_u32 s62, s7, 16384
    buffer_load_dwordx4 v22, s[36:39], s62 offen lds
    s_add_u32 m0, s57, 10240
    s_add_u32 s62, s7, 1048576
    buffer_load_dwordx4 v22, s[36:39], s62 offen lds
    s_add_u32 m0, s57, 11264
    s_add_u32 s62, s7, 1064960
    buffer_load_dwordx4 v22, s[36:39], s62 offen lds
    s_xor_b32 s7, s63, 1
    s_lshl_b32 s7, s7, 18
    s_add_u32 s7, s7, s60
    s_add_u32 m0, s57, 12288
    s_add_u32 s62, s7, 2097152
    buffer_load_dwordx4 v22, s[36:39], s62 offen lds
    s_add_u32 m0, s57, 13312
    s_add_u32 s62, s7, 2113536
    buffer_load_dwordx4 v22, s[36:39], s62 offen lds
    s_add_u32 m0, s57, 14336
    s_add_u32 s62, s7, 3145728
    buffer_load_dwordx4 v22, s[36:39], s62 offen lds
    s_add_u32 m0, s57, 15360
    s_add_u32 s62, s7, 3162112
    buffer_load_dwordx4 v22, s[36:39], s62 offen lds
    v_lshrrev_b32 v14, 2, v0
    v_and_b32 v14, 60, v14
    global_load_dword v44, v14, s[32:33] sc1
    s_waitcnt vmcnt(17)
    ds_read_b64_tr_b16 a[208:209], v122 offset:16384
    ds_read_b64_tr_b16 a[210:211], v122 offset:17408
    ds_read_b64_tr_b16 a[212:213], v122 offset:18432
    ds_read_b64_tr_b16 a[214:215], v122 offset:19456
    ds_read_b64_tr_b16 a[216:217], v123 offset:16384
    ds_read_b64_tr_b16 a[218:219], v123 offset:17408
    ds_read_b64_tr_b16 a[220:221], v123 offset:18432
    ds_read_b64_tr_b16 a[222:223], v123 offset:19456
    ds_read_b64_tr_b16 a[224:225], v124 offset:16384
    ds_read_b64_tr_b16 a[226:227], v124 offset:17408
    ds_read_b64_tr_b16 a[228:229], v124 offset:18432
    ds_read_b64_tr_b16 a[230:231], v124 offset:19456
    ds_read_b64_tr_b16 a[232:233], v125 offset:16384
    ds_read_b64_tr_b16 a[234:235], v125 offset:17408
    ds_read_b64_tr_b16 a[236:237], v125 offset:18432
    ds_read_b64_tr_b16 a[238:239], v125 offset:19456
    ds_read_b64_tr_b16 a[240:241], v122 offset:24576
    ds_read_b64_tr_b16 a[242:243], v122 offset:25600
    ds_read_b64_tr_b16 a[244:245], v122 offset:26624
    ds_read_b64_tr_b16 a[246:247], v122 offset:27648
    ds_read_b64_tr_b16 a[248:249], v123 offset:24576
    ds_read_b64_tr_b16 a[250:251], v123 offset:25600
    ds_read_b64_tr_b16 a[252:253], v123 offset:26624
    ds_read_b64_tr_b16 a[254:255], v123 offset:27648
    ds_read_b64_tr_b16 a[128:129], v124 offset:24576
    ds_read_b64_tr_b16 a[130:131], v124 offset:25600
    ds_read_b64_tr_b16 a[132:133], v124 offset:26624
    ds_read_b64_tr_b16 a[134:135], v124 offset:27648
    ds_read_b64_tr_b16 a[136:137], v125 offset:24576
    ds_read_b64_tr_b16 a[138:139], v125 offset:25600
    ds_read_b64_tr_b16 a[140:141], v125 offset:26624
    ds_read_b64_tr_b16 a[142:143], v125 offset:27648
    s_waitcnt lgkmcnt(0)
    s_mov_b32 s36, s46
    s_and_b32 s37, s47, 0xffff
    s_add_u32 m0, s57, 16384
    s_add_u32 s62, s61, 128
    buffer_load_dwordx4 v23, s[36:39], s62 offen lds
    s_add_u32 m0, s57, 17408
    s_add_u32 s62, s61, 2176
    buffer_load_dwordx4 v23, s[36:39], s62 offen lds
    s_add_u32 m0, s57, 18432
    s_add_u32 s62, s61, 32896
    buffer_load_dwordx4 v23, s[36:39], s62 offen lds
    s_add_u32 m0, s57, 19456
    s_add_u32 s62, s61, 34944
    buffer_load_dwordx4 v23, s[36:39], s62 offen lds
    s_add_u32 m0, s57, 20480
    s_add_u32 s62, s61, 8320
    buffer_load_dwordx4 v23, s[36:39], s62 offen lds
    s_add_u32 m0, s57, 21504
    s_add_u32 s62, s61, 10368
    buffer_load_dwordx4 v23, s[36:39], s62 offen lds
    s_add_u32 m0, s57, 22528
    s_add_u32 s62, s61, 41088
    buffer_load_dwordx4 v23, s[36:39], s62 offen lds
    s_add_u32 m0, s57, 23552
    s_add_u32 s62, s61, 43136
    buffer_load_dwordx4 v23, s[36:39], s62 offen lds
    s_add_u32 m0, s57, 24576
    s_add_u32 s62, s61, 65664
    buffer_load_dwordx4 v23, s[36:39], s62 offen lds
    s_add_u32 m0, s57, 25600
    s_add_u32 s62, s61, 67712
    buffer_load_dwordx4 v23, s[36:39], s62 offen lds
    s_add_u32 m0, s57, 26624
    s_add_u32 s62, s61, 98432
    buffer_load_dwordx4 v23, s[36:39], s62 offen lds
    s_add_u32 m0, s57, 27648
    s_add_u32 s62, s61, 100480
    buffer_load_dwordx4 v23, s[36:39], s62 offen lds
    s_add_u32 m0, s57, 28672
    s_add_u32 s62, s61, 73856
    buffer_load_dwordx4 v23, s[36:39], s62 offen lds
    s_add_u32 m0, s57, 29696
    s_add_u32 s62, s61, 75904
    buffer_load_dwordx4 v23, s[36:39], s62 offen lds
    s_add_u32 m0, s57, 30720
    s_add_u32 s62, s61, 106624
    buffer_load_dwordx4 v23, s[36:39], s62 offen lds
    s_add_u32 m0, s57, 31744
    s_add_u32 s62, s61, 108672
    buffer_load_dwordx4 v23, s[36:39], s62 offen lds
    s_waitcnt vmcnt(17)
    s_waitcnt vmcnt(16)
    v_cmp_eq_u32 s[54:55], 32, v44
    s_mov_b32 s7, 0
    v_readlane_b32 s8, v44, 0
    s_add_u32 s7, s7, s8
    v_readlane_b32 s8, v44, 1
    s_add_u32 s7, s7, s8
    v_readlane_b32 s8, v44, 2
    s_add_u32 s7, s7, s8
    v_readlane_b32 s8, v44, 3
    s_add_u32 s7, s7, s8
    v_readlane_b32 s8, v44, 4
    s_add_u32 s7, s7, s8
    v_readlane_b32 s8, v44, 5
    s_add_u32 s7, s7, s8
    v_readlane_b32 s8, v44, 6
    s_add_u32 s7, s7, s8
    v_readlane_b32 s8, v44, 7
    s_add_u32 s7, s7, s8
    s_and_b64 s[54:55], s[54:55], 0xff
    s_cmp_ge_u32 s7, 32
    s_cselect_b32 s34, 1, 0
    v_readlane_b32 s8, v44, 8
    s_cmp_ge_u32 s8, 128
    s_cselect_b32 s34, s34, 0
    v_readlane_b32 s97, v44, 9
    s_cmp_lg_u32 s97, 0
    s_cbranch_scc1 T_cal_3
    s_load_dwordx2 s[48:49], s[0:1], 104
    v_mov_b32 v12, 36
    s_mov_b32 s6, 800000
    s_waitcnt lgkmcnt(0)
I_w_4:
    global_load_dword v13, v12, s[48:49] sc1
    s_waitcnt vmcnt(0)
    v_cmp_le_u32 vcc, 1, v13
    s_cbranch_vccnz I_d_5
    s_sleep 4
    s_sub_u32 s6, s6, 1
    s_cbranch_scc0 I_w_4
I_d_5:
    v_readfirstlane_b32 s97, v13
T_cal_3:
    s_nop 3
    s_lshl_b32 s97, s97, 13
    s_and_b32 s97, s97, 0x2000
    s_xor_b32 s96, s97, 0x2000
    s_add_u32 s26, s26, s97
    s_addc_u32 s27, s27, 0
    s_add_u32 s28, s28, s97
    s_addc_u32 s29, s29, 0
    s_lshl_b32 s7, s4, 2
    s_add_u32 s7, s7, 149767808
    v_mov_b32 v46, s7
    global_load_dword v47, v46, s[30:31] sc1
    v_lshrrev_b32 v15, 2, v0
    global_load_dword v45, v15, s[26:27] sc1
    s_barrier
    ds_read_b64_tr_b16 v[48:49], v114 offset:0
    ds_read_b64_tr_b16 v[50:51], v114 offset:1024
    ds_read_b64_tr_b16 v[52:53], v114 offset:2048
    ds_read_b64_tr_b16 v[54:55], v114 offset:3072
    ds_read_b64_tr_b16 v[56:57], v115 offset:0
    ds_read_b64_tr_b16 v[58:59], v115 offset:1024
    ds_read_b64_tr_b16 v[60:61], v115 offset:2048
    ds_read_b64_tr_b16 v[62:63], v115 offset:3072
    ds_read_b64_tr_b16 v[64:65], v114 offset:4096
    ds_read_b64_tr_b16 v[66:67], v114 offset:5120
    ds_read_b64_tr_b16 v[68:69], v114 offset:6144
    ds_read_b64_tr_b16 v[70:71], v114 offset:7168
    ds_read_b64_tr_b16 v[72:73], v115 offset:4096
    ds_read_b64_tr_b16 v[74:75], v115 offset:5120
    ds_read_b64_tr_b16 v[76:77], v115 offset:6144
    ds_read_b64_tr_b16 v[78:79], v115 offset:7168
    ds_read_b64_tr_b16 v[80:81], v116 offset:8192
    ds_read_b64_tr_b16 v[82:83], v116 offset:9216
    ds_read_b64_tr_b16 v[84:85], v116 offset:10240
    ds_read_b64_tr_b16 v[86:87], v116 offset:11264
    ds_read_b64_tr_b16 v[88:89], v117 offset:8192
    ds_read_b64_tr_b16 v[90:91], v117 offset:9216
    ds_read_b64_tr_b16 v[92:93], v117 offset:10240
    ds_read_b64_tr_b16 v[94:95], v117 offset:11264
    ds_read_b64_tr_b16 v[96:97], v116 offset:12288
    ds_read_b64_tr_b16 v[98:99], v116 offset:13312
    ds_read_b64_tr_b16 v[100:101], v116 offset:14336
    ds_read_b64_tr_b16 v[102:103], v116 offset:15360
    ds_read_b64_tr_b16 v[104:105], v117 offset:12288
    ds_read_b64_tr_b16 v[106:107], v117 offset:13312
    ds_read_b64_tr_b16 v[108:109], v117 offset:14336
    ds_read_b64_tr_b16 v[110:111], v117 offset:15360
    s_waitcnt lgkmcnt(0)
    s_barrier
    ds_write_b128 v3, a[128:131] offset:12288
    ds_write_b128 v3, a[132:135] offset:13312
    ds_write_b128 v3, a[136:139] offset:14336
    ds_write_b128 v3, a[140:143] offset:15360
    s_waitcnt lgkmcnt(0)
    v_lshlrev_b32 v28, 16, v48
    v_and_b32 v29, 0xffff0000, v48
    v_lshlrev_b32 v30, 16, v49
    v_and_b32 v31, 0xffff0000, v49
    v_lshlrev_b32 v118, 16, v50
    v_and_b32 v119, 0xffff0000, v50
    v_lshlrev_b32 v126, 16, v51
    v_and_b32 v127, 0xffff0000, v51
    v_pk_mul_f32 v[28:29], v[28:29], v[120:121] op_sel_hi:[1,0]
    v_pk_mul_f32 v[30:31], v[30:31], v[120:121] op_sel_hi:[1,0]
    v_pk_mul_f32 v[118:119], v[118:119], v[120:121] op_sel_hi:[1,0]
    v_pk_mul_f32 v[126:127], v[126:127], v[120:121] op_sel_hi:[1,0]
    v_cvt_pk_bf16_f32 v48, v28, v29
    v_cvt_pk_bf16_f32 v49, v30, v31
    v_cvt_pk_bf16_f32 v50, v118, v119
    v_cvt_pk_bf16_f32 v51, v126, v127
    v_lshlrev_b32 v28, 16, v52
    v_and_b32 v29, 0xffff0000, v52
    v_lshlrev_b32 v30, 16, v53
    v_and_b32 v31, 0xffff0000, v53
    v_lshlrev_b32 v118, 16, v54
    v_and_b32 v119, 0xffff0000, v54
    v_lshlrev_b32 v126, 16, v55
    v_and_b32 v127, 0xffff0000, v55
    v_pk_mul_f32 v[28:29], v[28:29], v[120:121] op_sel_hi:[1,0]
    v_pk_mul_f32 v[30:31], v[30:31], v[120:121] op_sel_hi:[1,0]
    v_pk_mul_f32 v[118:119], v[118:119], v[120:121] op_sel_hi:[1,0]
    v_pk_mul_f32 v[126:127], v[126:127], v[120:121] op_sel_hi:[1,0]
    v_cvt_pk_bf16_f32 v52, v28, v29
    v_cvt_pk_bf16_f32 v53, v30, v31
    v_cvt_pk_bf16_f32 v54, v118, v119
    v_cvt_pk_bf16_f32 v55, v126, v127
    v_lshlrev_b32 v28, 16, v56
    v_and_b32 v29, 0xffff0000, v56
    v_lshlrev_b32 v30, 16, v57
    v_and_b32 v31, 0xffff0000, v57
    v_lshlrev_b32 v118, 16, v58
    v_and_b32 v119, 0xffff0000, v58
    v_lshlrev_b32 v126, 16, v59
    v_and_b32 v127, 0xffff0000, v59
    v_pk_mul_f32 v[28:29], v[28:29], v[120:121] op_sel_hi:[1,0]
    v_pk_mul_f32 v[30:31], v[30:31], v[120:121] op_sel_hi:[1,0]
    v_pk_mul_f32 v[118:119], v[118:119], v[120:121] op_sel_hi:[1,0]
    v_pk_mul_f32 v[126:127], v[126:127], v[120:121] op_sel_hi:[1,0]
    v_cvt_pk_bf16_f32 v56, v28, v29
    v_cvt_pk_bf16_f32 v57, v30, v31
    v_cvt_pk_bf16_f32 v58, v118, v119
    v_cvt_pk_bf16_f32 v59, v126, v127
    v_lshlrev_b32 v28, 16, v60
    v_and_b32 v29, 0xffff0000, v60
    v_lshlrev_b32 v30, 16, v61
    v_and_b32 v31, 0xffff0000, v61
    v_lshlrev_b32 v118, 16, v62
    v_and_b32 v119, 0xffff0000, v62
    v_lshlrev_b32 v126, 16, v63
    v_and_b32 v127, 0xffff0000, v63
    v_pk_mul_f32 v[28:29], v[28:29], v[120:121] op_sel_hi:[1,0]
    v_pk_mul_f32 v[30:31], v[30:31], v[120:121] op_sel_hi:[1,0]
    v_pk_mul_f32 v[118:119], v[118:119], v[120:121] op_sel_hi:[1,0]
    v_pk_mul_f32 v[126:127], v[126:127], v[120:121] op_sel_hi:[1,0]
    v_cvt_pk_bf16_f32 v60, v28, v29
    v_cvt_pk_bf16_f32 v61, v30, v31
    v_cvt_pk_bf16_f32 v62, v118, v119
    v_cvt_pk_bf16_f32 v63, v126, v127
    v_lshlrev_b32 v28, 16, v64
    v_and_b32 v29, 0xffff0000, v64
    v_lshlrev_b32 v30, 16, v65
    v_and_b32 v31, 0xffff0000, v65
    v_lshlrev_b32 v118, 16, v66
    v_and_b32 v119, 0xffff0000, v66
    v_lshlrev_b32 v126, 16, v67
    v_and_b32 v127, 0xffff0000, v67
    v_pk_mul_f32 v[28:29], v[28:29], v[120:121] op_sel_hi:[1,0]
    v_pk_mul_f32 v[30:31], v[30:31], v[120:121] op_sel_hi:[1,0]
    v_pk_mul_f32 v[118:119], v[118:119], v[120:121] op_sel_hi:[1,0]
    v_pk_mul_f32 v[126:127], v[126:127], v[120:121] op_sel_hi:[1,0]
    v_cvt_pk_bf16_f32 v64, v28, v29
    v_cvt_pk_bf16_f32 v65, v30, v31
    v_cvt_pk_bf16_f32 v66, v118, v119
    v_cvt_pk_bf16_f32 v67, v126, v127
    v_lshlrev_b32 v28, 16, v68
    v_and_b32 v29, 0xffff0000, v68
    v_lshlrev_b32 v30, 16, v69
    v_and_b32 v31, 0xffff0000, v69
    v_lshlrev_b32 v118, 16, v70
    v_and_b32 v119, 0xffff0000, v70
    v_lshlrev_b32 v126, 16, v71
    v_and_b32 v127, 0xffff0000, v71
    v_pk_mul_f32 v[28:29], v[28:29], v[120:121] op_sel_hi:[1,0]
    v_pk_mul_f32 v[30:31], v[30:31], v[120:121] op_sel_hi:[1,0]
    v_pk_mul_f32 v[118:119], v[118:119], v[120:121] op_sel_hi:[1,0]
    v_pk_mul_f32 v[126:127], v[126:127], v[120:121] op_sel_hi:[1,0]
    v_cvt_pk_bf16_f32 v68, v28, v29
    v_cvt_pk_bf16_f32 v69, v30, v31
    v_cvt_pk_bf16_f32 v70, v118, v119
    v_cvt_pk_bf16_f32 v71, v126, v127
    v_lshlrev_b32 v28, 16, v72
    v_and_b32 v29, 0xffff0000, v72
    v_lshlrev_b32 v30, 16, v73
    v_and_b32 v31, 0xffff0000, v73
    v_lshlrev_b32 v118, 16, v74
    v_and_b32 v119, 0xffff0000, v74
    v_lshlrev_b32 v126, 16, v75
    v_and_b32 v127, 0xffff0000, v75
    v_pk_mul_f32 v[28:29], v[28:29], v[120:121] op_sel_hi:[1,0]
    v_pk_mul_f32 v[30:31], v[30:31], v[120:121] op_sel_hi:[1,0]
    v_pk_mul_f32 v[118:119], v[118:119], v[120:121] op_sel_hi:[1,0]
    v_pk_mul_f32 v[126:127], v[126:127], v[120:121] op_sel_hi:[1,0]
    v_cvt_pk_bf16_f32 v72, v28, v29
    v_cvt_pk_bf16_f32 v73, v30, v31
    v_cvt_pk_bf16_f32 v74, v118, v119
    v_cvt_pk_bf16_f32 v75, v126, v127
    v_lshlrev_b32 v28, 16, v76
    v_and_b32 v29, 0xffff0000, v76
    v_lshlrev_b32 v30, 16, v77
    v_and_b32 v31, 0xffff0000, v77
    v_lshlrev_b32 v118, 16, v78
    v_and_b32 v119, 0xffff0000, v78
    v_lshlrev_b32 v126, 16, v79
    v_and_b32 v127, 0xffff0000, v79
    v_pk_mul_f32 v[28:29], v[28:29], v[120:121] op_sel_hi:[1,0]
    v_pk_mul_f32 v[30:31], v[30:31], v[120:121] op_sel_hi:[1,0]
    v_pk_mul_f32 v[118:119], v[118:119], v[120:121] op_sel_hi:[1,0]
    v_pk_mul_f32 v[126:127], v[126:127], v[120:121] op_sel_hi:[1,0]
    v_cvt_pk_bf16_f32 v76, v28, v29
    v_cvt_pk_bf16_f32 v77, v30, v31
    v_cvt_pk_bf16_f32 v78, v118, v119
    v_cvt_pk_bf16_f32 v79, v126, v127
    v_lshlrev_b32 v28, 16, v80
    v_and_b32 v29, 0xffff0000, v80
    v_lshlrev_b32 v30, 16, v81
    v_and_b32 v31, 0xffff0000, v81
    v_lshlrev_b32 v118, 16, v82
    v_and_b32 v119, 0xffff0000, v82
    v_lshlrev_b32 v126, 16, v83
    v_and_b32 v127, 0xffff0000, v83
    v_pk_mul_f32 v[28:29], v[28:29], v[120:121] op_sel_hi:[1,0]
    v_pk_mul_f32 v[30:31], v[30:31], v[120:121] op_sel_hi:[1,0]
    v_pk_mul_f32 v[118:119], v[118:119], v[120:121] op_sel_hi:[1,0]
    v_pk_mul_f32 v[126:127], v[126:127], v[120:121] op_sel_hi:[1,0]
    v_cvt_pk_bf16_f32 v80, v28, v29
    v_cvt_pk_bf16_f32 v81, v30, v31
    v_cvt_pk_bf16_f32 v82, v118, v119
    v_cvt_pk_bf16_f32 v83, v126, v127
    v_lshlrev_b32 v28, 16, v84
    v_and_b32 v29, 0xffff0000, v84
    v_lshlrev_b32 v30, 16, v85
    v_and_b32 v31, 0xffff0000, v85
    v_lshlrev_b32 v118, 16, v86
    v_and_b32 v119, 0xffff0000, v86
    v_lshlrev_b32 v126, 16, v87
    v_and_b32 v127, 0xffff0000, v87
    v_pk_mul_f32 v[28:29], v[28:29], v[120:121] op_sel_hi:[1,0]
    v_pk_mul_f32 v[30:31], v[30:31], v[120:121] op_sel_hi:[1,0]
    v_pk_mul_f32 v[118:119], v[118:119], v[120:121] op_sel_hi:[1,0]
    v_pk_mul_f32 v[126:127], v[126:127], v[120:121] op_sel_hi:[1,0]
    v_cvt_pk_bf16_f32 v84, v28, v29
    v_cvt_pk_bf16_f32 v85, v30, v31
    v_cvt_pk_bf16_f32 v86, v118, v119
    v_cvt_pk_bf16_f32 v87, v126, v127
    v_lshlrev_b32 v28, 16, v88
    v_and_b32 v29, 0xffff0000, v88
    v_lshlrev_b32 v30, 16, v89
    v_and_b32 v31, 0xffff0000, v89
    v_lshlrev_b32 v118, 16, v90
    v_and_b32 v119, 0xffff0000, v90
    v_lshlrev_b32 v126, 16, v91
    v_and_b32 v127, 0xffff0000, v91
    v_pk_mul_f32 v[28:29], v[28:29], v[120:121] op_sel_hi:[1,0]
    v_pk_mul_f32 v[30:31], v[30:31], v[120:121] op_sel_hi:[1,0]
    v_pk_mul_f32 v[118:119], v[118:119], v[120:121] op_sel_hi:[1,0]
    v_pk_mul_f32 v[126:127], v[126:127], v[120:121] op_sel_hi:[1,0]
    v_cvt_pk_bf16_f32 v88, v28, v29
    v_cvt_pk_bf16_f32 v89, v30, v31
    v_cvt_pk_bf16_f32 v90, v118, v119
    v_cvt_pk_bf16_f32 v91, v126, v127
    v_lshlrev_b32 v28, 16, v92
    v_and_b32 v29, 0xffff0000, v92
    v_lshlrev_b32 v30, 16, v93
    v_and_b32 v31, 0xffff0000, v93
    v_lshlrev_b32 v118, 16, v94
    v_and_b32 v119, 0xffff0000, v94
    v_lshlrev_b32 v126, 16, v95
    v_and_b32 v127, 0xffff0000, v95
    v_pk_mul_f32 v[28:29], v[28:29], v[120:121] op_sel_hi:[1,0]
    v_pk_mul_f32 v[30:31], v[30:31], v[120:121] op_sel_hi:[1,0]
    v_pk_mul_f32 v[118:119], v[118:119], v[120:121] op_sel_hi:[1,0]
    v_pk_mul_f32 v[126:127], v[126:127], v[120:121] op_sel_hi:[1,0]
    v_cvt_pk_bf16_f32 v92, v28, v29
    v_cvt_pk_bf16_f32 v93, v30, v31
    v_cvt_pk_bf16_f32 v94, v118, v119
    v_cvt_pk_bf16_f32 v95, v126, v127
    s_waitcnt vmcnt(0)
    v_cmp_ne_u32 s[52:53], 0, v45
    s_cmp_lg_u32 s34, 0
    s_cbranch_scc1 T_go_7
    s_mov_b32 s6, 100000
T_bar_8:
    global_load_dword v44, v14, s[32:33] sc1
    s_waitcnt vmcnt(0)
    v_cmp_eq_u32 s[54:55], 32, v44
    s_mov_b32 s7, 0
    v_readlane_b32 s8, v44, 0
    s_add_u32 s7, s7, s8
    v_readlane_b32 s8, v44, 1
    s_add_u32 s7, s7, s8
    v_readlane_b32 s8, v44, 2
    s_add_u32 s7, s7, s8
    v_readlane_b32 s8, v44, 3
    s_add_u32 s7, s7, s8
    v_readlane_b32 s8, v44, 4
    s_add_u32 s7, s7, s8
    v_readlane_b32 s8, v44, 5
    s_add_u32 s7, s7, s8
    v_readlane_b32 s8, v44, 6
    s_add_u32 s7, s7, s8
    v_readlane_b32 s8, v44, 7
    s_add_u32 s7, s7, s8
    s_and_b64 s[54:55], s[54:55], 0xff
    s_cmp_ge_u32 s7, 32
    s_cbranch_scc1 T_bard_9
    s_sub_u32 s6, s6, 1
    s_cbranch_scc0 T_bar_8
T_bard_9:
    s_load_dwordx2 s[48:49], s[0:1], 104
    v_mov_b32 v12, 32
    s_mov_b32 s6, 800000
    s_waitcnt lgkmcnt(0)
I_w_10:
    global_load_dword v13, v12, s[48:49] sc1
    s_waitcnt vmcnt(0)
    v_cmp_le_u32 vcc, 128, v13
    s_cbranch_vccnz I_d_11
    s_sleep 4
    s_sub_u32 s6, s6, 1
    s_cbranch_scc0 I_w_10
I_d_11:
    s_mov_b64 s[52:53], 0
    v_mov_b32 v47, 0
T_go_7:
    v_cmp_ne_u32 vcc, 0, v47
    s_cbranch_vccnz T_hc_12
    s_mov_b32 s6, 800000
I_w_13:
    global_load_dword v47, v46, s[30:31] sc1
    s_waitcnt vmcnt(0)
    v_cmp_ne_u32 vcc, 0, v47
    s_cbranch_vccnz I_d_14
    s_sleep 2
    s_sub_u32 s6, s6, 1
    s_cbranch_scc0 I_w_13
I_d_14:
T_hc_12:
    v_readfirstlane_b32 s7, v47
    s_nop 3
    s_lshl_b32 s7, s7, 12
    s_and_b32 s7, s7, 0x2000
    s_add_u32 s12, s12, s7
    s_addc_u32 s13, s13, 0
    s_mov_b64 s[14:15], s[12:13]
    s_add_u32 s7, s5, 0
    s_min_u32 s7, s7, 63
    s_bitcmp1_b64 s[52:53], s7
    s_cbranch_scc1 T_fd_16
    s_mov_b32 s6, 400000
    v_lshrrev_b32 v12, 2, v0
T_fw_15:
    global_load_dword v13, v12, s[26:27] sc1
    s_waitcnt vmcnt(0)
    v_cmp_ne_u32 s[52:53], 0, v13
    s_nop 3
    s_bitcmp1_b64 s[52:53], s7
    s_cbranch_scc1 T_fd_16
    s_sub_u32 s6, s6, 1
    s_cmp_lg_u32 s6, 0
    s_cbranch_scc1 T_fw_15
T_fd_16:
    s_add_u32 s7, s5, 1
    s_min_u32 s7, s7, 63
    s_bitcmp1_b64 s[52:53], s7
    s_cbranch_scc1 T_fd_18
    s_mov_b32 s6, 400000
    v_lshrrev_b32 v12, 2, v0
T_fw_17:
    global_load_dword v13, v12, s[26:27] sc1
    s_waitcnt vmcnt(0)
    v_cmp_ne_u32 s[52:53], 0, v13
    s_nop 3
    s_bitcmp1_b64 s[52:53], s7
    s_cbranch_scc1 T_fd_18
    s_sub_u32 s6, s6, 1
    s_cmp_lg_u32 s6, 0
    s_cbranch_scc1 T_fw_17
T_fd_18:
    s_add_u32 s40, s12, 16384
    s_addc_u32 s41, s13, 0
    s_mov_b32 m0, s56
    s_nop 0
    global_load_lds_dwordx4 v4, s[12:13] sc1
    global_load_lds_dwordx4 v4, s[12:13] offset:1024 sc1
    s_add_u32 m0, s56, 8192
    s_nop 0
    global_load_lds_dwordx4 v4, s[40:41] sc1
    global_load_lds_dwordx4 v4, s[40:41] offset:1024 sc1
    v_add_u32 v12, 0, v4
    global_load_dwordx4 v[40:43], v12, s[22:23] offset:0 sc1
    global_load_dwordx4 v[40:43], v12, s[22:23] offset:1024 sc1
    v_add_u32 v12, 8192, v4
    global_load_dwordx4 v[40:43], v12, s[22:23] offset:0 sc1
    global_load_dwordx4 v[40:43], v12, s[22:23] offset:1024 sc1
    v_add_u32 v12, 16384, v4
    global_load_dwordx4 v[40:43], v12, s[22:23] offset:0 sc1
    global_load_dwordx4 v[40:43], v12, s[22:23] offset:1024 sc1
    v_add_u32 v12, 24576, v4
    global_load_dwordx4 v[40:43], v12, s[22:23] offset:0 sc1
    global_load_dwordx4 v[40:43], v12, s[22:23] offset:1024 sc1
    global_load_dwordx4 v[40:43], v4, s[20:21] offset:0 sc1
    global_load_dwordx4 v[40:43], v4, s[20:21] offset:1024 sc1
    v_lshlrev_b32 v28, 16, v96
    v_and_b32 v29, 0xffff0000, v96
    v_lshlrev_b32 v30, 16, v97
    v_and_b32 v31, 0xffff0000, v97
    v_lshlrev_b32 v118, 16, v98
    v_and_b32 v119, 0xffff0000, v98
    v_lshlrev_b32 v126, 16, v99
    v_and_b32 v127, 0xffff0000, v99
    v_pk_mul_f32 v[28:29], v[28:29], v[120:121] op_sel_hi:[1,0]
    v_pk_mul_f32 v[30:31], v[30:31], v[120:121] op_sel_hi:[1,0]
    v_pk_mul_f32 v[118:119], v[118:119], v[120:121] op_sel_hi:[1,0]
    v_pk_mul_f32 v[126:127], v[126:127], v[120:121] op_sel_hi:[1,0]
    v_cvt_pk_bf16_f32 v96, v28, v29
    v_cvt_pk_bf16_f32 v97, v30, v31
    v_cvt_pk_bf16_f32 v98, v118, v119
    v_cvt_pk_bf16_f32 v99, v126, v127
    v_accvgpr_write_b32 a128, v96
    v_accvgpr_write_b32 a129, v97
    v_accvgpr_write_b32 a130, v98
    v_accvgpr_write_b32 a131, v99
    v_lshlrev_b32 v28, 16, v100
    v_and_b32 v29, 0xffff0000, v100
    v_lshlrev_b32 v30, 16, v101
    v_and_b32 v31, 0xffff0000, v101
    v_lshlrev_b32 v118, 16, v102
    v_and_b32 v119, 0xffff0000, v102
    v_lshlrev_b32 v126, 16, v103
    v_and_b32 v127, 0xffff0000, v103
    v_pk_mul_f32 v[28:29], v[28:29], v[120:121] op_sel_hi:[1,0]
    v_pk_mul_f32 v[30:31], v[30:31], v[120:121] op_sel_hi:[1,0]
    v_pk_mul_f32 v[118:119], v[118:119], v[120:121] op_sel_hi:[1,0]
    v_pk_mul_f32 v[126:127], v[126:127], v[120:121] op_sel_hi:[1,0]
    v_cvt_pk_bf16_f32 v100, v28, v29
    v_cvt_pk_bf16_f32 v101, v30, v31
    v_cvt_pk_bf16_f32 v102, v118, v119
    v_cvt_pk_bf16_f32 v103, v126, v127
    v_accvgpr_write_b32 a132, v100
    v_accvgpr_write_b32 a133, v101
    v_accvgpr_write_b32 a134, v102
    v_accvgpr_write_b32 a135, v103
    v_lshlrev_b32 v28, 16, v104
    v_and_b32 v29, 0xffff0000, v104
    v_lshlrev_b32 v30, 16, v105
    v_and_b32 v31, 0xffff0000, v105
    v_lshlrev_b32 v118, 16, v106
    v_and_b32 v119, 0xffff0000, v106
    v_lshlrev_b32 v126, 16, v107
    v_and_b32 v127, 0xffff0000, v107
    v_pk_mul_f32 v[28:29], v[28:29], v[120:121] op_sel_hi:[1,0]
    v_pk_mul_f32 v[30:31], v[30:31], v[120:121] op_sel_hi:[1,0]
    v_pk_mul_f32 v[118:119], v[118:119], v[120:121] op_sel_hi:[1,0]
    v_pk_mul_f32 v[126:127], v[126:127], v[120:121] op_sel_hi:[1,0]
    v_cvt_pk_bf16_f32 v104, v28, v29
    v_cvt_pk_bf16_f32 v105, v30, v31
    v_cvt_pk_bf16_f32 v106, v118, v119
    v_cvt_pk_bf16_f32 v107, v126, v127
    v_accvgpr_write_b32 a136, v104
    v_accvgpr_write_b32 a137, v105
    v_accvgpr_write_b32 a138, v106
    v_accvgpr_write_b32 a139, v107
    v_lshlrev_b32 v28, 16, v108
    v_and_b32 v29, 0xffff0000, v108
    v_lshlrev_b32 v30, 16, v109
    v_and_b32 v31, 0xffff0000, v109
    v_lshlrev_b32 v118, 16, v110
    v_and_b32 v119, 0xffff0000, v110
    v_lshlrev_b32 v126, 16, v111
    v_and_b32 v127, 0xffff0000, v111
    v_pk_mul_f32 v[28:29], v[28:29], v[120:121] op_sel_hi:[1,0]
    v_pk_mul_f32 v[30:31], v[30:31], v[120:121] op_sel_hi:[1,0]
    v_pk_mul_f32 v[118:119], v[118:119], v[120:121] op_sel_hi:[1,0]
    v_pk_mul_f32 v[126:127], v[126:127], v[120:121] op_sel_hi:[1,0]
    v_cvt_pk_bf16_f32 v108, v28, v29
    v_cvt_pk_bf16_f32 v109, v30, v31
    v_cvt_pk_bf16_f32 v110, v118, v119
    v_cvt_pk_bf16_f32 v111, v126, v127
    v_accvgpr_write_b32 a140, v108
    v_accvgpr_write_b32 a141, v109
    v_accvgpr_write_b32 a142, v110
    v_accvgpr_write_b32 a143, v111
    ds_write_b128 v3, v[48:51] offset:0
    ds_write_b128 v3, v[52:55] offset:1024
    ds_write_b128 v3, v[56:59] offset:2048
    ds_write_b128 v3, v[60:63] offset:3072
    ds_write_b128 v3, v[64:67] offset:4096
    ds_write_b128 v3, v[68:71] offset:5120
    ds_write_b128 v3, v[72:75] offset:6144
    ds_write_b128 v3, v[76:79] offset:7168
    ds_write_b128 v3, v[80:83] offset:8192
    ds_write_b128 v3, v[84:87] offset:9216
    ds_write_b128 v3, v[88:91] offset:10240
    ds_write_b128 v3, v[92:95] offset:11264
    s_waitcnt lgkmcnt(0)
    ds_read_b64_tr_b16 v[48:49], v122 offset:16384
    ds_read_b64_tr_b16 v[50:51], v122 offset:17408
    ds_read_b64_tr_b16 v[52:53], v122 offset:18432
    ds_read_b64_tr_b16 v[54:55], v122 offset:19456
    ds_read_b64_tr_b16 v[56:57], v123 offset:16384
    ds_read_b64_tr_b16 v[58:59], v123 offset:17408
    ds_read_b64_tr_b16 v[60:61], v123 offset:18432
    ds_read_b64_tr_b16 v[62:63], v123 offset:19456
    ds_read_b64_tr_b16 v[64:65], v124 offset:16384
    ds_read_b64_tr_b16 v[66:67], v124 offset:17408
    ds_read_b64_tr_b16 v[68:69], v124 offset:18432
    ds_read_b64_tr_b16 v[70:71], v124 offset:19456
    ds_read_b64_tr_b16 v[72:73], v125 offset:16384
    ds_read_b64_tr_b16 v[74:75], v125 offset:17408
    ds_read_b64_tr_b16 v[76:77], v125 offset:18432
    ds_read_b64_tr_b16 v[78:79], v125 offset:19456
    ds_read_b64_tr_b16 v[80:81], v122 offset:24576
    ds_read_b64_tr_b16 v[82:83], v122 offset:25600
    ds_read_b64_tr_b16 v[84:85], v122 offset:26624
    ds_read_b64_tr_b16 v[86:87], v122 offset:27648
    ds_read_b64_tr_b16 v[88:89], v123 offset:24576
    ds_read_b64_tr_b16 v[90:91], v123 offset:25600
    ds_read_b64_tr_b16 v[92:93], v123 offset:26624
    ds_read_b64_tr_b16 v[94:95], v123 offset:27648
    ds_read_b64_tr_b16 v[96:97], v124 offset:24576
    ds_read_b64_tr_b16 v[98:99], v124 offset:25600
    ds_read_b64_tr_b16 v[100:101], v124 offset:26624
    ds_read_b64_tr_b16 v[102:103], v124 offset:27648
    ds_read_b64_tr_b16 v[104:105], v125 offset:24576
    ds_read_b64_tr_b16 v[106:107], v125 offset:25600
    ds_read_b64_tr_b16 v[108:109], v125 offset:26624
    ds_read_b64_tr_b16 v[110:111], v125 offset:27648
    s_waitcnt lgkmcnt(0)
    ds_write_b128 v3, v[48:51] offset:16384
    ds_write_b128 v3, v[52:55] offset:17408
    ds_write_b128 v3, v[56:59] offset:18432
    ds_write_b128 v3, v[60:63] offset:19456
    ds_write_b128 v3, v[64:67] offset:20480
    ds_write_b128 v3, v[68:71] offset:21504
    ds_write_b128 v3, v[72:75] offset:22528
    ds_write_b128 v3, v[76:79] offset:23552
    ds_write_b128 v3, v[80:83] offset:24576
    ds_write_b128 v3, v[84:87] offset:25600
    ds_write_b128 v3, v[88:91] offset:26624
    ds_write_b128 v3, v[92:95] offset:27648
    ds_write_b128 v3, v[96:99] offset:28672
    ds_write_b128 v3, v[100:103] offset:29696
    ds_write_b128 v3, v[104:107] offset:30720
    ds_write_b128 v3, v[108:111] offset:31744
    s_waitcnt lgkmcnt(0)
    v_mov_b32 v16, v32
    v_mov_b32 v17, v33
    v_mov_b32 v18, v34
    v_mov_b32 v19, v35
    v_mov_b32 v20, v36
    v_mov_b32 v21, v37
    v_mov_b32 v22, v38
    v_mov_b32 v23, v39
    s_add_u32 s12, s12, 32768
    s_addc_u32 s13, s13, 0
    s_add_u32 s40, s40, 32768
    s_addc_u32 s41, s41, 0
    s_mov_b32 s34, 0
    s_add_u32 s20, s20, s95
    s_addc_u32 s21, s21, 0
    s_add_u32 s42, s22, s95
    s_addc_u32 s43, s23, 0
    s_mov_b32 s36, s28
    s_and_b32 s37, s29, 0xffff
    s_cmp_eq_u32 s3, 0
    s_cselect_b32 s38, 4, 0
    s_cselect_b32 s46, 256, 0
    s_mov_b32 s44, s26
    s_and_b32 s45, s27, 0xffff
    s_mov_b32 s47, 0x20000
    s_mov_b32 s18, 0x30800000
    s_mov_b32 s19, 0x1e000000
    s_mov_b32 s49, 0
    ds_read_b128 v[64:67], v3 offset:0
    ds_read_b128 v[68:71], v3 offset:1024
    ds_read_b128 v[72:75], v3 offset:2048
    ds_read_b128 v[76:79], v3 offset:3072
    ds_read_b128 v[80:83], v3 offset:4096
    ds_read_b128 v[84:87], v3 offset:5120
    ds_read_b128 v[88:91], v3 offset:6144
    ds_read_b128 v[92:95], v3 offset:7168
    ds_read_b128 v[48:51], v3 offset:8192
    ds_read_b128 v[52:55], v3 offset:9216
    ds_read_b128 v[56:59], v3 offset:10240
    ds_read_b128 v[60:63], v3 offset:11264
    v_mov_b64 v[96:97], 0
    v_mov_b64 v[98:99], 0
    v_mov_b64 v[100:101], 0
    v_mov_b64 v[102:103], 0
    v_mov_b64 v[104:105], 0
    v_mov_b64 v[106:107], 0
    v_mov_b64 v[108:109], 0
    v_mov_b64 v[110:111], 0
    v_mov_b64 v[112:113], 0
    v_mov_b64 v[114:115], 0
    v_mov_b64 v[116:117], 0
    v_mov_b64 v[118:119], 0
    ds_read_b32 v10, v0 offset:30720
    s_waitcnt lgkmcnt(0)
    v_xor_b32 v28, 2048, v4
    v_xor_b32 v36, 4096, v4
    v_xor_b32 v14, 6144, v4
    v_mov_b32 v33, s5
    s_xor_b32 s7, s49, 0x4000
    v_add_u32 v38, s7, v10
    v_lshrrev_b32 v10, 2, v0
    v_mov_b64 v[34:35], -1
    s_waitcnt vmcnt(0) lgkmcnt(0)
    s_mov_b64 vcc, 0
    v_mov_b32 v11, v4
    s_cmp_lg_u64 s[54:55], 0
    s_cbranch_scc1 T_entry_F
    s_branch T_entry_S
.p2align 6
T_r2_F:
    s_mov_b64 exec, vcc
    global_load_dwordx4 v[16:19], v11, s[22:23] sc1
    global_load_dwordx4 v[20:23], v11, s[22:23] offset:2048 sc1
    s_mov_b64 exec, -1
    s_sub_u32 s6, s6, 1
    s_nop 1
    v_mov_b64 v[96:97], 0
    v_mov_b64 v[98:99], 0
    v_mov_b64 v[100:101], 0
    v_mov_b64 v[102:103], 0
    s_mov_b64 vcc, 0
    s_cbranch_scc1 T_entry_F
T_hpf_F:
    s_waitcnt vmcnt(3)
    v_max3_u32 v24, v16, v17, v18
    v_max_u32 v24, v24, v19
    s_waitcnt vmcnt(2)
    v_max3_u32 v24, v24, v20, v21
    v_max3_u32 v24, v24, v22, v23
    v_cmp_eq_u32 vcc, -1, v24
T_entry_F:
    v_smfmac_f32_16x16x64_bf16 v[96:99], v[16:19], v[64:71], v1
    ds_write_b128 v4, v[16:19]
    ds_write_b128 v4, v[20:23] offset:1024
    v_smfmac_f32_16x16x64_bf16 v[100:103], v[16:19], v[72:79], v1
    s_cbranch_vccnz T_r2_F
    v_smfmac_f32_16x16x64_bf16 v[96:99], v[20:23], v[80:87], v1
    v_smfmac_f32_16x16x64_bf16 v[100:103], v[20:23], v[88:95], v1
    v_smfmac_f32_16x16x64_bf16 v[104:107], v[16:19], v[128:135], v1
    v_smfmac_f32_16x16x64_bf16 v[108:111], v[16:19], v[136:143], v1
    s_waitcnt lgkmcnt(0)
    s_barrier
    ds_read_b128 v[24:27], v28
    v_smfmac_f32_16x16x64_bf16 v[104:107], v[20:23], v[144:151], v1
    ds_read_b128 v[28:31], v28 offset:1024
    global_store_dword v38, v34, s[24:25]
    v_smfmac_f32_16x16x64_bf16 v[108:111], v[20:23], v[152:159], v1
    buffer_store_dword v33, off, s[36:39], 0 sc1
    ds_read_b128 v[32:35], v36
    v_smfmac_f32_16x16x64_bf16 v[112:115], v[16:19], a[0:7], v1
    ds_read_b128 v[36:39], v36 offset:1024
    v_smfmac_f32_16x16x64_bf16 v[116:119], v[16:19], a[8:15], v1
    ds_read_b128 v[40:43], v14
    v_smfmac_f32_16x16x64_bf16 v[112:115], v[20:23], a[16:23], v1
    ds_read_b128 v[44:47], v14 offset:1024
    s_cmp_eq_u32 s5, 63
    v_smfmac_f32_16x16x64_bf16 v[116:119], v[20:23], a[24:31], v1
    s_cbranch_scc1 T_end
    ds_read_b128 v[120:123], v4 offset:16384
    s_waitcnt lgkmcnt(6)
    v_smfmac_f32_16x16x64_bf16 v[96:99], v[24:27], v[48:55], v1
    ds_read_b128 v[124:127], v4 offset:17408
    v_smfmac_f32_16x16x64_bf16 v[100:103], v[24:27], v[56:63], v1
    buffer_load_dword v9, v10, s[44:47], 0 offen sc1
    s_waitcnt lgkmcnt(6)
    v_smfmac_f32_16x16x64_bf16 v[96:99], v[28:31], a[128:135], v1
    ds_read_b128 v[64:67], v0 offset:8192
    v_lshrrev_b32 v10, 1, v4
    v_smfmac_f32_16x16x64_bf16 v[100:103], v[28:31], a[136:143], v1
    ds_read_b128 v[68:71], v0 offset:9216
    s_waitcnt lgkmcnt(6)
    v_smfmac_f32_16x16x64_bf16 v[96:99], v[32:35], a[144:151], v1
    ds_read_b128 v[72:75], v0 offset:10240
    v_bfe_u32 v11, v0, 9, 1
    v_smfmac_f32_16x16x64_bf16 v[96:99], v[36:39], a[160:167], v1
    s_waitcnt lgkmcnt(3)
    ds_read_b128 v[76:79], v0 offset:11264
    v_smfmac_f32_16x16x64_bf16 v[96:99], v[40:43], a[176:183], v1
    ds_read_b128 v[80:83], v0 offset:12288
    v_lshl_add_u32 v11, v11, 5, v10
    v_smfmac_f32_16x16x64_bf16 v[96:99], v[44:47], a[192:199], v1
    s_add_u32 m0, s56, 8192
    v_smfmac_f32_16x16x64_bf16 v[100:103], v[32:35], a[152:159], v1
    ds_read_b128 v[84:87], v0 offset:13312
    v_smfmac_f32_16x16x64_bf16 v[100:103], v[36:39], a[168:175], v1
    ds_read_b128 v[88:91], v0 offset:14336
    v_add_f32 v96, v96, v98
    v_smfmac_f32_16x16x64_bf16 v[100:103], v[40:43], a[184:191], v1
    ds_read_b128 v[92:95], v0 offset:15360
    v_add_f32 v97, v97, v99
    v_smfmac_f32_16x16x64_bf16 v[100:103], v[44:47], a[200:207], v1
    global_load_lds_dwordx4 v4, s[40:41] sc1
    v_cvt_pk_bf16_f32 v12, v96, v97
    v_smfmac_f32_16x16x64_bf16 v[104:107], v[24:27], v[160:167], v1
    global_load_lds_dwordx4 v4, s[40:41] offset:1024 sc1
    v_smfmac_f32_16x16x64_bf16 v[104:107], v[28:31], v[176:183], v1
    v_add_f32 v100, v100, v102
    v_smfmac_f32_16x16x64_bf16 v[104:107], v[32:35], v[192:199], v1
    v_add_f32 v101, v101, v103
    v_smfmac_f32_16x16x64_bf16 v[104:107], v[36:39], v[208:215], v1
    v_cvt_pk_bf16_f32 v13, v100, v101
    v_smfmac_f32_16x16x64_bf16 v[104:107], v[40:43], v[224:231], v1
    ds_write2st64_b32 v5, v12, v13 offset1:1
    v_smfmac_f32_16x16x64_bf16 v[104:107], v[44:47], v[240:247], v1
    v_smfmac_f32_16x16x64_bf16 v[108:111], v[24:27], v[168:175], v1
    v_smfmac_f32_16x16x64_bf16 v[108:111], v[28:31], v[184:191], v1
    s_mov_b32 m0, s56
    v_add_f32 v104, v104, v106
    v_smfmac_f32_16x16x64_bf16 v[108:111], v[32:35], v[200:207], v1
    s_waitcnt lgkmcnt(0)
    s_barrier
    v_smfmac_f32_16x16x64_bf16 v[108:111], v[36:39], v[216:223], v1
    ds_read_b64_tr_b16 v[48:49], v6 offset:24576
    ds_read_b64_tr_b16 v[50:51], v6 offset:24640
    v_smfmac_f32_16x16x64_bf16 v[108:111], v[40:43], v[232:239], v1
    ds_read_b64_tr_b16 v[52:53], v6 offset:24832
    v_add_f32 v105, v105, v107
    v_smfmac_f32_16x16x64_bf16 v[108:111], v[44:47], v[248:255], v1
    ds_read_b64_tr_b16 v[54:55], v6 offset:24896
    v_cvt_pk_bf16_f32 v14, v104, v105
    v_smfmac_f32_16x16x64_bf16 v[112:115], v[24:27], a[32:39], v1
    ds_read_b64_tr_b16 v[56:57], v6 offset:25600
    v_smfmac_f32_16x16x64_bf16 v[112:115], v[28:31], a[48:55], v1
    ds_read_b64_tr_b16 v[58:59], v6 offset:25664
    v_add_f32 v108, v108, v110
    s_waitcnt lgkmcnt(4)
    v_mfma_f32_16x16x32_bf16 v[96:99], v[64:67], v[48:51], 0
    ds_read_b64_tr_b16 v[60:61], v6 offset:25856
    v_add_f32 v109, v109, v111
    s_waitcnt lgkmcnt(3)
    v_mfma_f32_16x16x32_bf16 v[96:99], v[68:71], v[52:55], v[96:99]
    ds_read_b64_tr_b16 v[62:63], v6 offset:25920
    v_cvt_pk_bf16_f32 v15, v108, v109
    v_smfmac_f32_16x16x64_bf16 v[112:115], v[32:35], a[64:71], v1
    ds_write_b64 v11, v[14:15] offset:0
    s_waitcnt lgkmcnt(3)
    v_mfma_f32_16x16x32_bf16 v[96:99], v[72:75], v[56:59], v[96:99]
    global_store_dwordx2 v10, v[14:15], s[14:15] sc1
    s_waitcnt lgkmcnt(1)
    v_mfma_f32_16x16x32_bf16 v[96:99], v[76:79], v[60:63], v[96:99]
    global_load_lds_dwordx4 v4, s[12:13] sc1
    v_mfma_f32_16x16x32_bf16 v[100:103], v[80:83], v[48:51], 0
    global_load_lds_dwordx4 v4, s[12:13] offset:1024 sc1
    v_mfma_f32_16x16x32_bf16 v[100:103], v[84:87], v[52:55], v[100:103]
    v_exp_f32 v12, v96
    v_smfmac_f32_16x16x64_bf16 v[112:115], v[36:39], a[80:87], v1
    s_waitcnt lgkmcnt(0)
    s_barrier
    v_mfma_f32_16x16x32_bf16 v[100:103], v[88:91], v[56:59], v[100:103]
    ds_read_b64_tr_b16 v[104:105], v7 offset:0
    ds_read_b64_tr_b16 v[106:107], v7 offset:32
    v_mfma_f32_16x16x32_bf16 v[100:103], v[92:95], v[60:63], v[100:103]
    ds_read_b64_tr_b16 v[108:109], v7 offset:2048
    ds_read_b64_tr_b16 v[110:111], v7 offset:2080
    v_smfmac_f32_16x16x64_bf16 v[112:115], v[40:43], a[96:103], v1
    ds_read_b128 v[72:75], v0 offset:29696
    v_exp_f32 v13, v97
    v_smfmac_f32_16x16x64_bf16 v[112:115], v[44:47], a[112:119], v1
    ds_read_b128 v[76:79], v0 offset:31744
    v_cvt_pk_bf16_f32 v80, v12, v13
    s_waitcnt lgkmcnt(4)
    v_mfma_f32_16x16x32_bf16 v[64:67], v[104:107], v[48:51], 0
    v_exp_f32 v14, v98
    v_mfma_f32_16x16x32_bf16 v[68:71], v[104:107], v[52:55], 0
    v_exp_f32 v15, v99
    s_waitcnt lgkmcnt(2)
    v_mfma_f32_16x16x32_bf16 v[64:67], v[108:111], v[56:59], v[64:67]
    v_exp_f32 v12, v100
    v_mfma_f32_16x16x32_bf16 v[68:71], v[108:111], v[60:63], v[68:71]
    v_exp_f32 v13, v101
    v_smfmac_f32_16x16x64_bf16 v[116:119], v[24:27], a[40:47], v1
    ds_read_b128 v[48:51], v3 offset:12288
    v_cvt_pk_bf16_f32 v81, v14, v15
    v_smfmac_f32_16x16x64_bf16 v[116:119], v[28:31], a[56:63], v1
    ds_read_b128 v[52:55], v3 offset:13312
    v_cvt_pk_bf16_f32 v82, v12, v13
    v_smfmac_f32_16x16x64_bf16 v[116:119], v[32:35], a[72:79], v1
    ds_read_b128 v[56:59], v3 offset:14336
    v_add_f32 v10, v64, v70
    v_add_f32 v11, v65, v71
    v_smfmac_f32_16x16x64_bf16 v[116:119], v[36:39], a[88:95], v1
    ds_read_b128 v[60:63], v3 offset:15360
    ds_read_b128 v[88:91], v3 offset:22528
    v_exp_f32 v14, v102
    v_smfmac_f32_16x16x64_bf16 v[116:119], v[40:43], a[104:111], v1
    s_waitcnt vmcnt(8)
    ds_read_b128 v[16:19], v3 offset:16384
    v_exp_f32 v15, v103
    v_smfmac_f32_16x16x64_bf16 v[116:119], v[44:47], a[120:127], v1
    ds_read_b128 v[20:23], v3 offset:17408
    ds_read_b128 v[92:95], v3 offset:23552
    v_cvt_pk_bf16_f32 v83, v14, v15
    v_exp_f32 v12, v10
    v_exp_f32 v13, v11
    s_waitcnt lgkmcnt(8)
    v_mfma_f32_16x16x32_bf16 v[84:87], v[72:75], v[80:83], 0
    v_cvt_pk_bf16_f32 v76, v12, v13
    v_add_f32 v112, v112, v114
    v_mfma_f32_16x16x32_bf16 v[104:107], v[120:123], v[80:83], 0
    v_add_f32 v113, v113, v115
    v_add_f32 v116, v116, v118
    v_mfma_f32_16x16x16_bf16 v[84:87], v[72:73], v[76:77], v[84:87]
    v_add_f32 v117, v117, v119
    v_cvt_pk_bf16_f32 v114, v112, v113
    v_mfma_f32_16x16x32_bf16 v[108:111], v[124:127], v[80:83], 0
    v_cvt_pk_bf16_f32 v115, v116, v117
    v_cvt_pk_bf16_f32 v79, v12, v13
    v_lshrrev_b32 v14, 1, v4
    v_mfma_f32_16x16x16_bf16 v[104:107], v[114:115], v[76:77], v[104:107]
    ds_read_b128 v[24:27], v3 offset:18432
    v_subrev_u32 v13, s18, v84
    v_mfma_f32_16x16x16_bf16 v[108:111], v[114:115], v[78:79], v[108:111]
    global_store_dwordx2 v14, v[114:115], s[14:15] offset:512 sc1
    ds_read_b128 v[28:31], v3 offset:19456
    v_cmp_lt_u32 vcc, s19, v13
    v_rcp_f32 v12, v84
    s_nop 3
T_back_F:
    v_cndmask_b32 v104, v104, v108, s[10:11]
    v_cndmask_b32 v105, v105, v109, s[10:11]
    v_cndmask_b32 v106, v106, v110, s[10:11]
    v_cndmask_b32 v107, v107, v111, s[10:11]
    v_pk_mul_f32 v[104:105], v[104:105], v[12:13] op_sel_hi:[1,0]
    v_pk_mul_f32 v[106:107], v[106:107], v[12:13] op_sel_hi:[1,0]
    v_cvt_pk_bf16_f32 v14, v104, v105
    v_cvt_pk_bf16_f32 v15, v106, v107
    s_cbranch_vccnz T_fb_F
    ds_write_b64 v8, v[14:15] offset:26624
    v_and_b32 v11, 0x380, v0
    v_add_u32 v11, v11, v0
    v_mov_b64 v[96:97], 0
    v_mov_b64 v[98:99], 0
    v_mov_b64 v[100:101], 0
    v_mov_b64 v[102:103], 0
    v_mov_b64 v[104:105], 0
    v_mov_b64 v[106:107], 0
    v_mov_b64 v[108:109], 0
    s_waitcnt lgkmcnt(0)
    s_barrier
    ds_read_b128 v[120:123], v0 offset:26624
    ds_read_b128 v[124:127], v0 offset:27648
    v_mov_b64 v[110:111], 0
    v_mov_b64 v[112:113], 0
    v_mov_b64 v[114:115], 0
    v_mov_b64 v[116:117], 0
    v_mov_b64 v[118:119], 0
T_ot_F:
    s_waitcnt lgkmcnt(1)
    v_smfmac_f32_16x16x64_bf16 v[96:99], v[120:123], a[208:215], v1
    s_waitcnt lgkmcnt(0)
    ds_read_b128 v[32:35], v3 offset:24576
    v_smfmac_f32_16x16x64_bf16 v[96:99], v[124:127], a[240:247], v1
    ds_read_b128 v[36:39], v3 offset:25600
    ds_read_b128 v[40:43], v3 offset:26624
    v_smfmac_f32_16x16x64_bf16 v[100:103], v[120:123], a[216:223], v1
    ds_read_b128 v[44:47], v3 offset:27648
    v_smfmac_f32_16x16x64_bf16 v[100:103], v[124:127], a[248:255], v1
    ds_read_b128 v[80:83], v3 offset:20480
    v_add_f32 v96, v96, v98
    v_smfmac_f32_16x16x64_bf16 v[104:107], v[120:123], a[224:231], v1
T_ot_Fg:
    ds_read_b128 v[84:87], v3 offset:21504
    v_add_f32 v97, v97, v99
    v_cvt_pk_bf16_f32 v12, v96, v97
    v_smfmac_f32_16x16x64_bf16 v[104:107], v[124:127], v[48:55], v1
    ds_read_b128 v[64:67], v3 offset:28672
    v_and_or_b32 v12, v12, -2, s34
    v_add_f32 v100, v100, v102
    v_smfmac_f32_16x16x64_bf16 v[108:111], v[120:123], a[232:239], v1
    ds_read_b128 v[48:51], v0 offset:31744
    v_add_f32 v101, v101, v103
    v_cvt_pk_bf16_f32 v13, v100, v101
    v_smfmac_f32_16x16x64_bf16 v[108:111], v[124:127], v[56:63], v1
    global_store_dwordx2 v2, v[12:13], s[16:17] offset:-2048
    ds_read_b128 v[68:71], v3 offset:29696
    v_add_f32 v104, v104, v106
    v_smfmac_f32_16x16x64_bf16 v[112:115], v[120:123], v[16:23], v1
    ds_read_b128 v[52:55], v0 offset:31744
    v_add_f32 v105, v105, v107
    v_cvt_pk_bf16_f32 v14, v104, v105
    s_waitcnt lgkmcnt(8)
    v_smfmac_f32_16x16x64_bf16 v[112:115], v[124:127], v[32:39], v1
    ds_read_b128 v[72:75], v3 offset:30720
    v_and_or_b32 v14, v14, -2, s34
    v_add_f32 v108, v108, v110
    v_smfmac_f32_16x16x64_bf16 v[116:119], v[120:123], v[24:31], v1
    ds_read_b128 v[76:79], v3 offset:31744
    v_add_f32 v109, v109, v111
    v_cvt_pk_bf16_f32 v15, v108, v109
    s_waitcnt lgkmcnt(8)
    v_smfmac_f32_16x16x64_bf16 v[116:119], v[124:127], v[40:47], v1
    global_store_dwordx2 v2, v[14:15], s[16:17] offset:-1920
    s_waitcnt lgkmcnt(3)
    v_add_f32 v112, v112, v114
    v_smfmac_f32_16x16x64_bf16 v[48:51], v[120:123], v[80:87], v1
    v_add_f32 v113, v113, v115
    v_cvt_pk_bf16_f32 v12, v112, v113
    v_smfmac_f32_16x16x64_bf16 v[48:51], v[124:127], v[64:71], v1
    s_waitcnt lgkmcnt(2)
    v_and_or_b32 v12, v12, -2, s34
    v_add_f32 v116, v116, v118
    v_smfmac_f32_16x16x64_bf16 v[52:55], v[120:123], v[88:95], v1
    s_waitcnt lgkmcnt(0)
    v_add_f32 v117, v117, v119
    v_cvt_pk_bf16_f32 v13, v116, v117
    v_smfmac_f32_16x16x64_bf16 v[52:55], v[124:127], v[72:79], v1
    global_store_dwordx2 v2, v[12:13], s[16:17] offset:2048
    v_add_f32 v48, v48, v50
    v_add_f32 v49, v49, v51
    v_cvt_pk_bf16_f32 v14, v48, v49
    v_and_or_b32 v14, v14, -2, s34
    s_nop 2
    v_pk_add_f32 v[52:53], v[52:53], v[54:55]
    v_cvt_pk_bf16_f32 v15, v52, v53
    global_store_dwordx2 v2, v[14:15], s[16:17] offset:2176
    s_cmp_lt_u32 s3, 2
    s_cbranch_scc0 T_h2_F
    s_cmp_eq_u32 s3, 1
    s_cbranch_scc1 T_h1_F
    ds_read_b128 v[120:123], v0 offset:28672
    ds_read_b32 v10, v0 offset:30720
    v_mov_b64 v[96:97], 0
    v_mov_b64 v[98:99], 0
    v_mov_b64 v[100:101], 0
    v_mov_b64 v[102:103], 0
    v_mov_b64 v[104:105], 0
    v_mov_b64 v[106:107], 0
    s_add_u32 s5, s5, 1
    global_load_dwordx4 v[40:43], v11, s[20:21] sc1
    global_load_dwordx4 v[44:47], v11, s[20:21] offset:2048 sc1
    s_add_u32 s49, s49, 0x2000
    s_and_b32 s49, s49, 0x6000
    s_add_u32 s12, s12, 0x8000
    s_addc_u32 s13, s13, 0
    v_mov_b64 v[108:109], 0
    v_mov_b64 v[110:111], 0
    v_mov_b64 v[112:113], 0
    v_mov_b64 v[114:115], 0
    v_mov_b64 v[116:117], 0
    v_mov_b64 v[118:119], 0
    s_add_u32 s40, s40, 0x8000
    s_addc_u32 s41, s41, 0
    s_add_u32 s14, s14, 0x8000
    s_addc_u32 s15, s15, 0
    s_mov_b32 s6, 100000
    s_waitcnt lgkmcnt(0)
    v_add_u32 v15, s49, v10
    s_add_u32 s22, s42, s49
    s_addc_u32 s23, s43, 0
    ds_read_b128 v[64:67], v3 offset:0
    ds_read_b128 v[68:71], v3 offset:1024
    v_xor_b32 v28, 2048, v4
    v_xor_b32 v36, 4096, v4
    v_xor_b32 v14, 6144, v4
    v_mov_b32 v33, s5
    s_xor_b32 s7, s49, 0x4000
    v_add_u32 v38, s7, v10
    v_lshrrev_b32 v10, 2, v0
    global_load_dwordx4 v[40:43], v11, s[20:21] sc1
    global_load_dwordx4 v[44:47], v11, s[20:21] offset:2048 sc1
    v_mov_b64 v[34:35], -1
T_rp0_F:
    s_waitcnt vmcnt(3)
    v_bitop3_b32 v12, v40, v42, s34 bitop3:0x7e
    v_mfma_f32_16x16x32_bf16 v[124:127], v[120:123], v[40:43], 0
    s_waitcnt vmcnt(2)
    v_bitop3_b32 v13, v44, v46, s34 bitop3:0x7e
    v_mfma_f32_16x16x32_bf16 v[124:127], v[120:123], v[44:47], v[124:127]
    v_bitop3_b32 v12, v12, v13, 1 bitop3:0xa8
    v_cmp_ne_u32 vcc, 0, v12
T_rp0_Fq:
    s_nop 5
    v_add_f32_dpp v124, v124, v124 row_ror:4 row_mask:0xf bank_mask:0xf
    v_add_f32_dpp v125, v125, v125 row_ror:4 row_mask:0xf bank_mask:0xf
    s_cbranch_vccnz T_rf0_F
T_rok0_F:
    v_add_f32_dpp v124, v124, v124 row_ror:8 row_mask:0xf bank_mask:0xf
    v_add_f32_dpp v125, v125, v125 row_ror:8 row_mask:0xf bank_mask:0xf
    v_cvt_pk_bf16_f32 v126, v124, v125
    global_store_dword v15, v126, s[24:25]
    s_cmp_eq_u32 s5, 63
    s_cbranch_scc1 T_e620_F
T_e62b0_F:
    s_xor_b32 s34, s34, 1
    v_cmp_ne_u32 s[52:53], 0, v9
    s_nop 3
    s_add_u32 s7, s5, 1
    s_min_u32 s7, s7, 63
    s_bitcmp1_b64 s[52:53], s7
    s_cbranch_scc1 T_fd_20
    s_mov_b32 s6, 400000
    v_lshrrev_b32 v12, 2, v0
T_fw_19:
    global_load_dword v13, v12, s[26:27] sc1
    s_waitcnt vmcnt(0)
    v_cmp_ne_u32 s[52:53], 0, v13
    s_nop 3
    s_bitcmp1_b64 s[52:53], s7
    s_cbranch_scc1 T_fd_20
    s_sub_u32 s6, s6, 1
    s_cmp_lg_u32 s6, 0
    s_cbranch_scc1 T_fw_19
T_fd_20:
    s_mov_b32 s6, 100000
    ds_read_b128 v[72:75], v3 offset:2048
    ds_read_b128 v[76:79], v3 offset:3072
    ds_read_b128 v[80:83], v3 offset:4096
    ds_read_b128 v[84:87], v3 offset:5120
    ds_read_b128 v[88:91], v3 offset:6144
    s_nop 1
    global_load_dwordx4 v[16:19], v11, s[22:23] sc1
    global_load_dwordx4 v[20:23], v11, s[22:23] offset:2048 sc1
    ds_read_b128 v[92:95], v3 offset:7168
    ds_read_b128 v[48:51], v3 offset:8192
    ds_read_b128 v[52:55], v3 offset:9216
    ds_read_b128 v[56:59], v3 offset:10240
    ds_read_b128 v[60:63], v3 offset:11264
    s_waitcnt lgkmcnt(0)
    s_nop 15
    global_load_dwordx4 v[16:19], v11, s[22:23] sc1
    global_load_dwordx4 v[20:23], v11, s[22:23] offset:2048 sc1
    s_branch T_hpf_F
T_e620_F:
    s_barrier
    buffer_store_dword v33, off, s[36:39], 0 sc1
    s_branch T_e62b0_F
T_rf0_F:
    s_mov_b64 exec, vcc
    global_load_dwordx4 v[40:43], v11, s[20:21] sc1
    global_load_dwordx4 v[44:47], v11, s[20:21] offset:2048 sc1
    s_mov_b64 exec, -1
    s_sub_u32 s6, s6, 1
    s_cbranch_scc0 T_rp0_F
    s_branch T_rok0_F
T_h1_F:
    ds_read_b128 v[120:123], v0 offset:28672
    ds_read_b32 v10, v0 offset:30720
    v_mov_b64 v[96:97], 0
    v_mov_b64 v[98:99], 0
    v_mov_b64 v[100:101], 0
    v_mov_b64 v[102:103], 0
    v_mov_b64 v[104:105], 0
    v_mov_b64 v[106:107], 0
    s_add_u32 s5, s5, 1
    s_add_u32 s49, s49, 0x2000
    s_and_b32 s49, s49, 0x6000
    s_add_u32 s12, s12, 0x8000
    s_addc_u32 s13, s13, 0
    v_mov_b64 v[108:109], 0
    v_mov_b64 v[110:111], 0
    global_load_dwordx4 v[40:43], v11, s[20:21] sc1
    global_load_dwordx4 v[44:47], v11, s[20:21] offset:2048 sc1
    v_mov_b64 v[112:113], 0
    v_mov_b64 v[114:115], 0
    v_mov_b64 v[116:117], 0
    v_mov_b64 v[118:119], 0
    s_add_u32 s40, s40, 0x8000
    s_addc_u32 s41, s41, 0
    s_add_u32 s14, s14, 0x8000
    s_addc_u32 s15, s15, 0
    s_mov_b32 s6, 100000
    s_waitcnt lgkmcnt(0)
    v_add_u32 v15, s49, v10
    s_add_u32 s22, s42, s49
    s_addc_u32 s23, s43, 0
    ds_read_b128 v[64:67], v3 offset:0
    ds_read_b128 v[68:71], v3 offset:1024
    v_xor_b32 v28, 2048, v4
    v_xor_b32 v36, 4096, v4
    v_xor_b32 v14, 6144, v4
    v_mov_b32 v33, s5
    s_xor_b32 s7, s49, 0x4000
    v_add_u32 v38, s7, v10
    v_lshrrev_b32 v10, 2, v0
    v_mov_b64 v[34:35], -1
    s_nop 15
    s_nop 3
    global_load_dwordx4 v[40:43], v11, s[20:21] sc1
    global_load_dwordx4 v[44:47], v11, s[20:21] offset:2048 sc1
T_rp1_F:
    s_waitcnt vmcnt(3)
    v_bitop3_b32 v12, v40, v42, s34 bitop3:0x7e
    v_mfma_f32_16x16x32_bf16 v[124:127], v[120:123], v[40:43], 0
    s_waitcnt vmcnt(2)
    v_bitop3_b32 v13, v44, v46, s34 bitop3:0x7e
    v_mfma_f32_16x16x32_bf16 v[124:127], v[120:123], v[44:47], v[124:127]
    v_bitop3_b32 v12, v12, v13, 1 bitop3:0xa8
    v_cmp_ne_u32 vcc, 0, v12
T_rp1_Fq:
    s_nop 5
    v_add_f32_dpp v124, v124, v124 row_ror:4 row_mask:0xf bank_mask:0xf
    v_add_f32_dpp v125, v125, v125 row_ror:4 row_mask:0xf bank_mask:0xf
    s_cbranch_vccnz T_rf1_F
T_rok1_F:
    v_add_f32_dpp v124, v124, v124 row_ror:8 row_mask:0xf bank_mask:0xf
    v_add_f32_dpp v125, v125, v125 row_ror:8 row_mask:0xf bank_mask:0xf
    v_cvt_pk_bf16_f32 v126, v124, v125
    global_store_dword v15, v126, s[24:25]
    s_cmp_eq_u32 s5, 63
    s_cbranch_scc1 T_e621_F
T_e62b1_F:
    s_xor_b32 s34, s34, 1
    s_mov_b32 s6, 100000
    ds_read_b128 v[72:75], v3 offset:2048
    ds_read_b128 v[76:79], v3 offset:3072
    ds_read_b128 v[80:83], v3 offset:4096
    ds_read_b128 v[84:87], v3 offset:5120
    ds_read_b128 v[88:91], v3 offset:6144
    ds_read_b128 v[92:95], v3 offset:7168
    ds_read_b128 v[48:51], v3 offset:8192
    ds_read_b128 v[52:55], v3 offset:9216
    ds_read_b128 v[56:59], v3 offset:10240
    ds_read_b128 v[60:63], v3 offset:11264
    s_waitcnt lgkmcnt(0)
    s_nop 0
    global_load_dwordx4 v[16:19], v11, s[22:23] sc1
    global_load_dwordx4 v[20:23], v11, s[22:23] offset:2048 sc1
    s_nop 15
    s_nop 15
    global_load_dwordx4 v[16:19], v11, s[22:23] sc1
    global_load_dwordx4 v[20:23], v11, s[22:23] offset:2048 sc1
    s_branch T_hpf_F
T_e621_F:
    s_barrier
    s_branch T_e62b1_F
T_rf1_F:
    s_mov_b64 exec, vcc
    global_load_dwordx4 v[40:43], v11, s[20:21] sc1
    global_load_dwordx4 v[44:47], v11, s[20:21] offset:2048 sc1
    s_mov_b64 exec, -1
    s_sub_u32 s6, s6, 1
    s_cbranch_scc0 T_rp1_F
    s_branch T_rok1_F
T_h2_F:
    s_cmp_eq_u32 s3, 3
    s_cbranch_scc1 T_h3_F
    ds_read_b128 v[120:123], v0 offset:28672
    ds_read_b32 v10, v0 offset:30720
    v_mov_b64 v[96:97], 0
    v_mov_b64 v[98:99], 0
    v_mov_b64 v[100:101], 0
    v_mov_b64 v[102:103], 0
    v_mov_b64 v[104:105], 0
    v_mov_b64 v[106:107], 0
    s_add_u32 s5, s5, 1
    s_add_u32 s49, s49, 0x2000
    s_and_b32 s49, s49, 0x6000
    s_add_u32 s12, s12, 0x8000
    s_addc_u32 s13, s13, 0
    v_mov_b64 v[108:109], 0
    v_mov_b64 v[110:111], 0
    v_mov_b64 v[112:113], 0
    v_mov_b64 v[114:115], 0
    v_mov_b64 v[116:117], 0
    v_mov_b64 v[118:119], 0
    s_add_u32 s40, s40, 0x8000
    s_addc_u32 s41, s41, 0
    s_add_u32 s14, s14, 0x8000
    s_addc_u32 s15, s15, 0
    s_mov_b32 s6, 100000
    s_waitcnt lgkmcnt(0)
    v_add_u32 v15, s49, v10
    s_add_u32 s22, s42, s49
    s_addc_u32 s23, s43, 0
    global_load_dwordx4 v[40:43], v11, s[20:21] sc1
    global_load_dwordx4 v[44:47], v11, s[20:21] offset:2048 sc1
    ds_read_b128 v[64:67], v3 offset:0
    ds_read_b128 v[68:71], v3 offset:1024
    v_xor_b32 v28, 2048, v4
    v_xor_b32 v36, 4096, v4
    v_xor_b32 v14, 6144, v4
    v_mov_b32 v33, s5
    s_xor_b32 s7, s49, 0x4000
    v_add_u32 v38, s7, v10
    v_lshrrev_b32 v10, 2, v0
    v_mov_b64 v[34:35], -1
    s_nop 15
    s_nop 11
    global_load_dwordx4 v[40:43], v11, s[20:21] sc1
    global_load_dwordx4 v[44:47], v11, s[20:21] offset:2048 sc1
T_rp2_F:
    s_waitcnt vmcnt(3)
    v_bitop3_b32 v12, v40, v42, s34 bitop3:0x7e
    v_mfma_f32_16x16x32_bf16 v[124:127], v[120:123], v[40:43], 0
    s_waitcnt vmcnt(2)
    v_bitop3_b32 v13, v44, v46, s34 bitop3:0x7e
    v_mfma_f32_16x16x32_bf16 v[124:127], v[120:123], v[44:47], v[124:127]
    v_bitop3_b32 v12, v12, v13, 1 bitop3:0xa8
    v_cmp_ne_u32 vcc, 0, v12
T_rp2_Fq:
    s_nop 5
    v_add_f32_dpp v124, v124, v124 row_ror:4 row_mask:0xf bank_mask:0xf
    v_add_f32_dpp v125, v125, v125 row_ror:4 row_mask:0xf bank_mask:0xf
    s_cbranch_vccnz T_rf2_F
T_rok2_F:
    v_add_f32_dpp v124, v124, v124 row_ror:8 row_mask:0xf bank_mask:0xf
    v_add_f32_dpp v125, v125, v125 row_ror:8 row_mask:0xf bank_mask:0xf
    v_cvt_pk_bf16_f32 v126, v124, v125
    global_store_dword v15, v126, s[24:25]
    s_cmp_eq_u32 s5, 63
    s_cbranch_scc1 T_e622_F
T_e62b2_F:
    s_xor_b32 s34, s34, 1
    s_mov_b32 s6, 100000
    ds_read_b128 v[72:75], v3 offset:2048
    ds_read_b128 v[76:79], v3 offset:3072
    ds_read_b128 v[80:83], v3 offset:4096
    ds_read_b128 v[84:87], v3 offset:5120
    ds_read_b128 v[88:91], v3 offset:6144
    ds_read_b128 v[92:95], v3 offset:7168
    ds_read_b128 v[48:51], v3 offset:8192
    ds_read_b128 v[52:55], v3 offset:9216
    ds_read_b128 v[56:59], v3 offset:10240
    ds_read_b128 v[60:63], v3 offset:11264
    s_waitcnt lgkmcnt(0)
    s_nop 0
    global_load_dwordx4 v[16:19], v11, s[22:23] sc1
    global_load_dwordx4 v[20:23], v11, s[22:23] offset:2048 sc1
    s_nop 15
    s_nop 15
    global_load_dwordx4 v[16:19], v11, s[22:23] sc1
    global_load_dwordx4 v[20:23], v11, s[22:23] offset:2048 sc1
    s_branch T_hpf_F
T_e622_F:
    s_barrier
    s_branch T_e62b2_F
T_rf2_F:
    s_mov_b64 exec, vcc
    global_load_dwordx4 v[40:43], v11, s[20:21] sc1
    global_load_dwordx4 v[44:47], v11, s[20:21] offset:2048 sc1
    s_mov_b64 exec, -1
    s_sub_u32 s6, s6, 1
    s_cbranch_scc0 T_rp2_F
    s_branch T_rok2_F
T_h3_F:
    ds_read_b128 v[120:123], v0 offset:28672
    ds_read_b32 v10, v0 offset:30720
    v_mov_b64 v[96:97], 0
    v_mov_b64 v[98:99], 0
    v_mov_b64 v[100:101], 0
    v_mov_b64 v[102:103], 0
    v_mov_b64 v[104:105], 0
    v_mov_b64 v[106:107], 0
    s_add_u32 s5, s5, 1
    s_add_u32 s49, s49, 0x2000
    s_and_b32 s49, s49, 0x6000
    s_add_u32 s12, s12, 0x8000
    s_addc_u32 s13, s13, 0
    v_mov_b64 v[108:109], 0
    v_mov_b64 v[110:111], 0
    v_mov_b64 v[112:113], 0
    v_mov_b64 v[114:115], 0
    v_mov_b64 v[116:117], 0
    v_mov_b64 v[118:119], 0
    s_add_u32 s40, s40, 0x8000
    s_addc_u32 s41, s41, 0
    s_add_u32 s14, s14, 0x8000
    s_addc_u32 s15, s15, 0
    s_mov_b32 s6, 100000
    s_waitcnt lgkmcnt(0)
    v_add_u32 v15, s49, v10
    s_add_u32 s22, s42, s49
    s_addc_u32 s23, s43, 0
    ds_read_b128 v[64:67], v3 offset:0
    ds_read_b128 v[68:71], v3 offset:1024
    v_xor_b32 v28, 2048, v4
    v_xor_b32 v36, 4096, v4
    v_xor_b32 v14, 6144, v4
    v_mov_b32 v33, s5
    global_load_dwordx4 v[40:43], v11, s[20:21] sc1
    global_load_dwordx4 v[44:47], v11, s[20:21] offset:2048 sc1
    s_xor_b32 s7, s49, 0x4000
    v_add_u32 v38, s7, v10
    v_lshrrev_b32 v10, 2, v0
    v_mov_b64 v[34:35], -1
    s_nop 15
    s_nop 11
    global_load_dwordx4 v[40:43], v11, s[20:21] sc1
    global_load_dwordx4 v[44:47], v11, s[20:21] offset:2048 sc1
T_rp3_F:
    s_waitcnt vmcnt(3)
    v_bitop3_b32 v12, v40, v42, s34 bitop3:0x7e
    v_mfma_f32_16x16x32_bf16 v[124:127], v[120:123], v[40:43], 0
    s_waitcnt vmcnt(2)
    v_bitop3_b32 v13, v44, v46, s34 bitop3:0x7e
    v_mfma_f32_16x16x32_bf16 v[124:127], v[120:123], v[44:47], v[124:127]
    v_bitop3_b32 v12, v12, v13, 1 bitop3:0xa8
    v_cmp_ne_u32 vcc, 0, v12
T_rp3_Fq:
    s_nop 5
    v_add_f32_dpp v124, v124, v124 row_ror:4 row_mask:0xf bank_mask:0xf
    v_add_f32_dpp v125, v125, v125 row_ror:4 row_mask:0xf bank_mask:0xf
    s_cbranch_vccnz T_rf3_F
T_rok3_F:
    v_add_f32_dpp v124, v124, v124 row_ror:8 row_mask:0xf bank_mask:0xf
    v_add_f32_dpp v125, v125, v125 row_ror:8 row_mask:0xf bank_mask:0xf
    v_cvt_pk_bf16_f32 v126, v124, v125
    global_store_dword v15, v126, s[24:25]
    s_cmp_eq_u32 s5, 63
    s_cbranch_scc1 T_e623_F
T_e62b3_F:
    s_xor_b32 s34, s34, 1
    s_mov_b32 s6, 100000
    ds_read_b128 v[72:75], v3 offset:2048
    ds_read_b128 v[76:79], v3 offset:3072
    ds_read_b128 v[80:83], v3 offset:4096
    ds_read_b128 v[84:87], v3 offset:5120
    ds_read_b128 v[88:91], v3 offset:6144
    ds_read_b128 v[92:95], v3 offset:7168
    ds_read_b128 v[48:51], v3 offset:8192
    ds_read_b128 v[52:55], v3 offset:9216
    ds_read_b128 v[56:59], v3 offset:10240
    ds_read_b128 v[60:63], v3 offset:11264
    s_waitcnt lgkmcnt(0)
    s_nop 0
    global_load_dwordx4 v[16:19], v11, s[22:23] sc1
    global_load_dwordx4 v[20:23], v11, s[22:23] offset:2048 sc1
    s_nop 15
    s_nop 15
    global_load_dwordx4 v[16:19], v11, s[22:23] sc1
    global_load_dwordx4 v[20:23], v11, s[22:23] offset:2048 sc1
    s_branch T_hpf_F
T_e623_F:
    s_barrier
    s_branch T_e62b3_F
T_rf3_F:
    s_mov_b64 exec, vcc
    global_load_dwordx4 v[40:43], v11, s[20:21] sc1
    global_load_dwordx4 v[44:47], v11, s[20:21] offset:2048 sc1
    s_mov_b64 exec, -1
    s_sub_u32 s6, s6, 1
    s_cbranch_scc0 T_rp3_F
    s_branch T_rok3_F
T_fb_F:
    s_nop 7
    v_max3_f32 v12, v96, v97, v98
    v_max3_f32 v12, v12, v99, v100
    v_max3_f32 v12, v12, v101, v102
    v_max3_f32 v12, v12, v103, v10
    v_max_f32 v12, v12, v11
    v_mov_b32 v13, v12
    s_nop 1
    v_permlane32_swap_b32 v12, v13
    v_max_f32 v12, v12, v13
    v_mov_b32 v13, v12
    s_nop 1
    v_permlane16_swap_b32 v12, v13
    v_max_f32 v12, v12, v13
    v_sub_f32 v96, v96, v12
    v_sub_f32 v97, v97, v12
    v_sub_f32 v98, v98, v12
    v_sub_f32 v99, v99, v12
    v_sub_f32 v100, v100, v12
    v_sub_f32 v101, v101, v12
    v_sub_f32 v102, v102, v12
    v_sub_f32 v103, v103, v12
    v_sub_f32 v10, v10, v12
    v_sub_f32 v11, v11, v12
    v_exp_f32 v96, v96
    v_exp_f32 v97, v97
    v_exp_f32 v98, v98
    v_exp_f32 v99, v99
    v_exp_f32 v100, v100
    v_exp_f32 v101, v101
    v_exp_f32 v102, v102
    v_exp_f32 v103, v103
    v_exp_f32 v10, v10
    v_exp_f32 v11, v11
    v_cvt_pk_bf16_f32 v80, v96, v97
    v_cvt_pk_bf16_f32 v81, v98, v99
    v_cvt_pk_bf16_f32 v82, v100, v101
    v_cvt_pk_bf16_f32 v83, v102, v103
    v_cvt_pk_bf16_f32 v76, v10, v11
    v_cvt_pk_bf16_f32 v79, v10, v11
    s_nop 1
    v_mfma_f32_16x16x32_bf16 v[84:87], v[72:75], v[80:83], 0
    v_mfma_f32_16x16x32_bf16 v[104:107], v[120:123], v[80:83], 0
    v_mfma_f32_16x16x16_bf16 v[84:87], v[72:73], v[76:77], v[84:87]
    v_mfma_f32_16x16x32_bf16 v[108:111], v[124:127], v[80:83], 0
    v_mfma_f32_16x16x16_bf16 v[104:107], v[114:115], v[76:77], v[104:107]
    v_mfma_f32_16x16x16_bf16 v[108:111], v[114:115], v[78:79], v[108:111]
    s_nop 7
    v_rcp_f32 v12, v84
    s_mov_b64 vcc, 0
    s_branch T_back_F
.p2align 6
T_r2_S:
    s_mov_b64 exec, vcc
    global_load_dwordx4 v[16:19], v11, s[22:23] sc1
    global_load_dwordx4 v[20:23], v11, s[22:23] offset:2048 sc1
    s_mov_b64 exec, -1
    s_sub_u32 s6, s6, 1
    s_nop 1
    v_mov_b64 v[96:97], 0
    v_mov_b64 v[98:99], 0
    v_mov_b64 v[100:101], 0
    v_mov_b64 v[102:103], 0
    s_mov_b64 vcc, 0
    s_cbranch_scc1 T_entry_S
T_hpf_S:
    s_waitcnt vmcnt(3)
    v_max3_u32 v24, v16, v17, v18
    v_max_u32 v24, v24, v19
    s_waitcnt vmcnt(2)
    v_max3_u32 v24, v24, v20, v21
    v_max3_u32 v24, v24, v22, v23
    v_cmp_eq_u32 vcc, -1, v24
T_entry_S:
    v_smfmac_f32_16x16x64_bf16 v[96:99], v[16:19], v[64:71], v1
    ds_write_b128 v4, v[16:19]
    ds_write_b128 v4, v[20:23] offset:1024
    v_smfmac_f32_16x16x64_bf16 v[100:103], v[16:19], v[72:79], v1
    s_cbranch_vccnz T_r2_S
    v_smfmac_f32_16x16x64_bf16 v[96:99], v[20:23], v[80:87], v1
    v_smfmac_f32_16x16x64_bf16 v[100:103], v[20:23], v[88:95], v1
    v_smfmac_f32_16x16x64_bf16 v[104:107], v[16:19], v[128:135], v1
    v_smfmac_f32_16x16x64_bf16 v[108:111], v[16:19], v[136:143], v1
    s_waitcnt lgkmcnt(0)
    s_barrier
    ds_read_b128 v[24:27], v28
    v_smfmac_f32_16x16x64_bf16 v[104:107], v[20:23], v[144:151], v1
    ds_read_b128 v[28:31], v28 offset:1024
    global_store_dword v38, v34, s[24:25] sc1
    v_smfmac_f32_16x16x64_bf16 v[108:111], v[20:23], v[152:159], v1
    buffer_store_dword v33, off, s[36:39], 0 sc1
    ds_read_b128 v[32:35], v36
    v_smfmac_f32_16x16x64_bf16 v[112:115], v[16:19], a[0:7], v1
    ds_read_b128 v[36:39], v36 offset:1024
    v_smfmac_f32_16x16x64_bf16 v[116:119], v[16:19], a[8:15], v1
    ds_read_b128 v[40:43], v14
    v_smfmac_f32_16x16x64_bf16 v[112:115], v[20:23], a[16:23], v1
    ds_read_b128 v[44:47], v14 offset:1024
    s_cmp_eq_u32 s5, 63
    v_smfmac_f32_16x16x64_bf16 v[116:119], v[20:23], a[24:31], v1
    s_cbranch_scc1 T_end
    ds_read_b128 v[120:123], v4 offset:16384
    s_waitcnt lgkmcnt(6)
    v_smfmac_f32_16x16x64_bf16 v[96:99], v[24:27], v[48:55], v1
    ds_read_b128 v[124:127], v4 offset:17408
    v_smfmac_f32_16x16x64_bf16 v[100:103], v[24:27], v[56:63], v1
    buffer_load_dword v9, v10, s[44:47], 0 offen sc1
    s_waitcnt lgkmcnt(6)
    v_smfmac_f32_16x16x64_bf16 v[96:99], v[28:31], a[128:135], v1
    ds_read_b128 v[64:67], v0 offset:8192
    v_lshrrev_b32 v10, 1, v4
    v_smfmac_f32_16x16x64_bf16 v[100:103], v[28:31], a[136:143], v1
    ds_read_b128 v[68:71], v0 offset:9216
    s_waitcnt lgkmcnt(6)
    v_smfmac_f32_16x16x64_bf16 v[96:99], v[32:35], a[144:151], v1
    ds_read_b128 v[72:75], v0 offset:10240
    v_bfe_u32 v11, v0, 9, 1
    v_smfmac_f32_16x16x64_bf16 v[96:99], v[36:39], a[160:167], v1
    s_waitcnt lgkmcnt(3)
    ds_read_b128 v[76:79], v0 offset:11264
    v_smfmac_f32_16x16x64_bf16 v[96:99], v[40:43], a[176:183], v1
    ds_read_b128 v[80:83], v0 offset:12288
    v_lshl_add_u32 v11, v11, 5, v10
    v_smfmac_f32_16x16x64_bf16 v[96:99], v[44:47], a[192:199], v1
    s_add_u32 m0, s56, 8192
    v_smfmac_f32_16x16x64_bf16 v[100:103], v[32:35], a[152:159], v1
    ds_read_b128 v[84:87], v0 offset:13312
    v_smfmac_f32_16x16x64_bf16 v[100:103], v[36:39], a[168:175], v1
    ds_read_b128 v[88:91], v0 offset:14336
    v_add_f32 v96, v96, v98
    v_smfmac_f32_16x16x64_bf16 v[100:103], v[40:43], a[184:191], v1
    ds_read_b128 v[92:95], v0 offset:15360
    v_add_f32 v97, v97, v99
    v_smfmac_f32_16x16x64_bf16 v[100:103], v[44:47], a[200:207], v1
    global_load_lds_dwordx4 v4, s[40:41] sc1
    v_cvt_pk_bf16_f32 v12, v96, v97
    v_smfmac_f32_16x16x64_bf16 v[104:107], v[24:27], v[160:167], v1
    global_load_lds_dwordx4 v4, s[40:41] offset:1024 sc1
    v_smfmac_f32_16x16x64_bf16 v[104:107], v[28:31], v[176:183], v1
    v_add_f32 v100, v100, v102
    v_smfmac_f32_16x16x64_bf16 v[104:107], v[32:35], v[192:199], v1
    v_add_f32 v101, v101, v103
    v_smfmac_f32_16x16x64_bf16 v[104:107], v[36:39], v[208:215], v1
    v_cvt_pk_bf16_f32 v13, v100, v101
    v_smfmac_f32_16x16x64_bf16 v[104:107], v[40:43], v[224:231], v1
    ds_write2st64_b32 v5, v12, v13 offset1:1
    v_smfmac_f32_16x16x64_bf16 v[104:107], v[44:47], v[240:247], v1
    v_smfmac_f32_16x16x64_bf16 v[108:111], v[24:27], v[168:175], v1
    v_smfmac_f32_16x16x64_bf16 v[108:111], v[28:31], v[184:191], v1
    s_mov_b32 m0, s56
    v_add_f32 v104, v104, v106
    v_smfmac_f32_16x16x64_bf16 v[108:111], v[32:35], v[200:207], v1
    s_waitcnt lgkmcnt(0)
    s_barrier
    v_smfmac_f32_16x16x64_bf16 v[108:111], v[36:39], v[216:223], v1
    ds_read_b64_tr_b16 v[48:49], v6 offset:24576
    ds_read_b64_tr_b16 v[50:51], v6 offset:24640
    v_smfmac_f32_16x16x64_bf16 v[108:111], v[40:43], v[232:239], v1
    ds_read_b64_tr_b16 v[52:53], v6 offset:24832
    v_add_f32 v105, v105, v107
    v_smfmac_f32_16x16x64_bf16 v[108:111], v[44:47], v[248:255], v1
    ds_read_b64_tr_b16 v[54:55], v6 offset:24896
    v_cvt_pk_bf16_f32 v14, v104, v105
    v_smfmac_f32_16x16x64_bf16 v[112:115], v[24:27], a[32:39], v1
    ds_read_b64_tr_b16 v[56:57], v6 offset:25600
    v_smfmac_f32_16x16x64_bf16 v[112:115], v[28:31], a[48:55], v1
    ds_read_b64_tr_b16 v[58:59], v6 offset:25664
    v_add_f32 v108, v108, v110
    s_waitcnt lgkmcnt(4)
    v_mfma_f32_16x16x32_bf16 v[96:99], v[64:67], v[48:51], 0
    ds_read_b64_tr_b16 v[60:61], v6 offset:25856
    v_add_f32 v109, v109, v111
    s_waitcnt lgkmcnt(3)
    v_mfma_f32_16x16x32_bf16 v[96:99], v[68:71], v[52:55], v[96:99]
    ds_read_b64_tr_b16 v[62:63], v6 offset:25920
    v_cvt_pk_bf16_f32 v15, v108, v109
    v_smfmac_f32_16x16x64_bf16 v[112:115], v[32:35], a[64:71], v1
    ds_write_b64 v11, v[14:15] offset:0
    s_waitcnt lgkmcnt(3)
    v_mfma_f32_16x16x32_bf16 v[96:99], v[72:75], v[56:59], v[96:99]
    global_store_dwordx2 v10, v[14:15], s[14:15] sc1
    s_waitcnt lgkmcnt(1)
    v_mfma_f32_16x16x32_bf16 v[96:99], v[76:79], v[60:63], v[96:99]
    global_load_lds_dwordx4 v4, s[12:13] sc1
    v_mfma_f32_16x16x32_bf16 v[100:103], v[80:83], v[48:51], 0
    global_load_lds_dwordx4 v4, s[12:13] offset:1024 sc1
    v_mfma_f32_16x16x32_bf16 v[100:103], v[84:87], v[52:55], v[100:103]
    v_exp_f32 v12, v96
    v_smfmac_f32_16x16x64_bf16 v[112:115], v[36:39], a[80:87], v1
    s_waitcnt lgkmcnt(0)
    s_barrier
    v_mfma_f32_16x16x32_bf16 v[100:103], v[88:91], v[56:59], v[100:103]
    ds_read_b64_tr_b16 v[104:105], v7 offset:0
    ds_read_b64_tr_b16 v[106:107], v7 offset:32
    v_mfma_f32_16x16x32_bf16 v[100:103], v[92:95], v[60:63], v[100:103]
    ds_read_b64_tr_b16 v[108:109], v7 offset:2048
    ds_read_b64_tr_b16 v[110:111], v7 offset:2080
    v_smfmac_f32_16x16x64_bf16 v[112:115], v[40:43], a[96:103], v1
    ds_read_b128 v[72:75], v0 offset:29696
    v_exp_f32 v13, v97
    v_smfmac_f32_16x16x64_bf16 v[112:115], v[44:47], a[112:119], v1
    ds_read_b128 v[76:79], v0 offset:31744
    v_cvt_pk_bf16_f32 v80, v12, v13
    s_waitcnt lgkmcnt(4)
    v_mfma_f32_16x16x32_bf16 v[64:67], v[104:107], v[48:51], 0
    v_exp_f32 v14, v98
    v_mfma_f32_16x16x32_bf16 v[68:71], v[104:107], v[52:55], 0
    v_exp_f32 v15, v99
    s_waitcnt lgkmcnt(2)
    v_mfma_f32_16x16x32_bf16 v[64:67], v[108:111], v[56:59], v[64:67]
    v_exp_f32 v12, v100
    v_mfma_f32_16x16x32_bf16 v[68:71], v[108:111], v[60:63], v[68:71]
    v_exp_f32 v13, v101
    v_smfmac_f32_16x16x64_bf16 v[116:119], v[24:27], a[40:47], v1
    ds_read_b128 v[48:51], v3 offset:12288
    v_cvt_pk_bf16_f32 v81, v14, v15
    v_smfmac_f32_16x16x64_bf16 v[116:119], v[28:31], a[56:63], v1
    ds_read_b128 v[52:55], v3 offset:13312
    v_cvt_pk_bf16_f32 v82, v12, v13
    v_smfmac_f32_16x16x64_bf16 v[116:119], v[32:35], a[72:79], v1
    ds_read_b128 v[56:59], v3 offset:14336
    v_add_f32 v10, v64, v70
    v_add_f32 v11, v65, v71
    v_smfmac_f32_16x16x64_bf16 v[116:119], v[36:39], a[88:95], v1
    ds_read_b128 v[60:63], v3 offset:15360
    ds_read_b128 v[88:91], v3 offset:22528
    v_exp_f32 v14, v102
    v_smfmac_f32_16x16x64_bf16 v[116:119], v[40:43], a[104:111], v1
    s_waitcnt vmcnt(8)
    ds_read_b128 v[16:19], v3 offset:16384
    v_exp_f32 v15, v103
    v_smfmac_f32_16x16x64_bf16 v[116:119], v[44:47], a[120:127], v1
    ds_read_b128 v[20:23], v3 offset:17408
    ds_read_b128 v[92:95], v3 offset:23552
    v_cvt_pk_bf16_f32 v83, v14, v15
    v_exp_f32 v12, v10
    v_exp_f32 v13, v11
    s_waitcnt lgkmcnt(8)
    v_mfma_f32_16x16x32_bf16 v[84:87], v[72:75], v[80:83], 0
    v_cvt_pk_bf16_f32 v76, v12, v13
    v_add_f32 v112, v112, v114
    v_mfma_f32_16x16x32_bf16 v[104:107], v[120:123], v[80:83], 0
    v_add_f32 v113, v113, v115
    v_add_f32 v116, v116, v118
    v_mfma_f32_16x16x16_bf16 v[84:87], v[72:73], v[76:77], v[84:87]
    v_add_f32 v117, v117, v119
    v_cvt_pk_bf16_f32 v114, v112, v113
    v_mfma_f32_16x16x32_bf16 v[108:111], v[124:127], v[80:83], 0
    v_cvt_pk_bf16_f32 v115, v116, v117
    v_cvt_pk_bf16_f32 v79, v12, v13
    v_lshrrev_b32 v14, 1, v4
    v_mfma_f32_16x16x16_bf16 v[104:107], v[114:115], v[76:77], v[104:107]
    ds_read_b128 v[24:27], v3 offset:18432
    v_subrev_u32 v13, s18, v84
    v_mfma_f32_16x16x16_bf16 v[108:111], v[114:115], v[78:79], v[108:111]
    global_store_dwordx2 v14, v[114:115], s[14:15] offset:512 sc1
    ds_read_b128 v[28:31], v3 offset:19456
    v_cmp_lt_u32 vcc, s19, v13
    v_rcp_f32 v12, v84
    s_nop 3
T_back_S:
    v_cndmask_b32 v104, v104, v108, s[10:11]
    v_cndmask_b32 v105, v105, v109, s[10:11]
    v_cndmask_b32 v106, v106, v110, s[10:11]
    v_cndmask_b32 v107, v107, v111, s[10:11]
    v_pk_mul_f32 v[104:105], v[104:105], v[12:13] op_sel_hi:[1,0]
    v_pk_mul_f32 v[106:107], v[106:107], v[12:13] op_sel_hi:[1,0]
    v_cvt_pk_bf16_f32 v14, v104, v105
    v_cvt_pk_bf16_f32 v15, v106, v107
    s_cbranch_vccnz T_fb_S
    ds_write_b64 v8, v[14:15] offset:26624
    v_and_b32 v11, 0x380, v0
    v_add_u32 v11, v11, v0
    v_mov_b64 v[96:97], 0
    v_mov_b64 v[98:99], 0
    v_mov_b64 v[100:101], 0
    v_mov_b64 v[102:103], 0
    v_mov_b64 v[104:105], 0
    v_mov_b64 v[106:107], 0
    v_mov_b64 v[108:109], 0
    s_waitcnt lgkmcnt(0)
    s_barrier
    ds_read_b128 v[120:123], v0 offset:26624
    ds_read_b128 v[124:127], v0 offset:27648
    v_mov_b64 v[110:111], 0
    v_mov_b64 v[112:113], 0
    v_mov_b64 v[114:115], 0
    v_mov_b64 v[116:117], 0
    v_mov_b64 v[118:119], 0
T_ot_S:
    s_waitcnt lgkmcnt(1)
    v_smfmac_f32_16x16x64_bf16 v[96:99], v[120:123], a[208:215], v1
    s_waitcnt lgkmcnt(0)
    ds_read_b128 v[32:35], v3 offset:24576
    v_smfmac_f32_16x16x64_bf16 v[96:99], v[124:127], a[240:247], v1
    ds_read_b128 v[36:39], v3 offset:25600
    ds_read_b128 v[40:43], v3 offset:26624
    v_smfmac_f32_16x16x64_bf16 v[100:103], v[120:123], a[216:223], v1
    ds_read_b128 v[44:47], v3 offset:27648
    v_smfmac_f32_16x16x64_bf16 v[100:103], v[124:127], a[248:255], v1
    ds_read_b128 v[80:83], v3 offset:20480
    v_add_f32 v96, v96, v98
    v_smfmac_f32_16x16x64_bf16 v[104:107], v[120:123], a[224:231], v1
T_ot_Sg:
    ds_read_b128 v[84:87], v3 offset:21504
    v_add_f32 v97, v97, v99
    v_cvt_pk_bf16_f32 v12, v96, v97
    v_smfmac_f32_16x16x64_bf16 v[104:107], v[124:127], v[48:55], v1
    ds_read_b128 v[64:67], v3 offset:28672
    v_and_or_b32 v12, v12, -2, s34
    v_add_f32 v100, v100, v102
    v_smfmac_f32_16x16x64_bf16 v[108:111], v[120:123], a[232:239], v1
    ds_read_b128 v[48:51], v0 offset:31744
    v_add_f32 v101, v101, v103
    v_cvt_pk_bf16_f32 v13, v100, v101
    v_smfmac_f32_16x16x64_bf16 v[108:111], v[124:127], v[56:63], v1
    global_store_dwordx2 v2, v[12:13], s[16:17] offset:-2048 sc1
    ds_read_b128 v[68:71], v3 offset:29696
    v_add_f32 v104, v104, v106
    v_smfmac_f32_16x16x64_bf16 v[112:115], v[120:123], v[16:23], v1
    ds_read_b128 v[52:55], v0 offset:31744
    v_add_f32 v105, v105, v107
    v_cvt_pk_bf16_f32 v14, v104, v105
    s_waitcnt lgkmcnt(8)
    v_smfmac_f32_16x16x64_bf16 v[112:115], v[124:127], v[32:39], v1
    ds_read_b128 v[72:75], v3 offset:30720
    v_and_or_b32 v14, v14, -2, s34
    v_add_f32 v108, v108, v110
    v_smfmac_f32_16x16x64_bf16 v[116:119], v[120:123], v[24:31], v1
    ds_read_b128 v[76:79], v3 offset:31744
    v_add_f32 v109, v109, v111
    v_cvt_pk_bf16_f32 v15, v108, v109
    s_waitcnt lgkmcnt(8)
    v_smfmac_f32_16x16x64_bf16 v[116:119], v[124:127], v[40:47], v1
    global_store_dwordx2 v2, v[14:15], s[16:17] offset:-1920 sc1
    s_waitcnt lgkmcnt(3)
    v_add_f32 v112, v112, v114
    v_smfmac_f32_16x16x64_bf16 v[48:51], v[120:123], v[80:87], v1
    v_add_f32 v113, v113, v115
    v_cvt_pk_bf16_f32 v12, v112, v113
    v_smfmac_f32_16x16x64_bf16 v[48:51], v[124:127], v[64:71], v1
    s_waitcnt lgkmcnt(2)
    v_and_or_b32 v12, v12, -2, s34
    v_add_f32 v116, v116, v118
    v_smfmac_f32_16x16x64_bf16 v[52:55], v[120:123], v[88:95], v1
    s_waitcnt lgkmcnt(0)
    v_add_f32 v117, v117, v119
    v_cvt_pk_bf16_f32 v13, v116, v117
    v_smfmac_f32_16x16x64_bf16 v[52:55], v[124:127], v[72:79], v1
    global_store_dwordx2 v2, v[12:13], s[16:17] offset:2048 sc1
    v_add_f32 v48, v48, v50
    v_add_f32 v49, v49, v51
    v_cvt_pk_bf16_f32 v14, v48, v49
    v_and_or_b32 v14, v14, -2, s34
    s_nop 2
    v_pk_add_f32 v[52:53], v[52:53], v[54:55]
    v_cvt_pk_bf16_f32 v15, v52, v53
    global_store_dwordx2 v2, v[14:15], s[16:17] offset:2176 sc1
    s_cmp_lt_u32 s3, 2
    s_cbranch_scc0 T_h2_S
    s_cmp_eq_u32 s3, 1
    s_cbranch_scc1 T_h1_S
    ds_read_b128 v[120:123], v0 offset:28672
    ds_read_b32 v10, v0 offset:30720
    v_mov_b64 v[96:97], 0
    v_mov_b64 v[98:99], 0
    v_mov_b64 v[100:101], 0
    v_mov_b64 v[102:103], 0
    v_mov_b64 v[104:105], 0
    v_mov_b64 v[106:107], 0
    s_add_u32 s5, s5, 1
    global_load_dwordx4 v[40:43], v11, s[20:21] sc1
    global_load_dwordx4 v[44:47], v11, s[20:21] offset:2048 sc1
    s_add_u32 s49, s49, 0x2000
    s_and_b32 s49, s49, 0x6000
    s_add_u32 s12, s12, 0x8000
    s_addc_u32 s13, s13, 0
    v_mov_b64 v[108:109], 0
    v_mov_b64 v[110:111], 0
    v_mov_b64 v[112:113], 0
    v_mov_b64 v[114:115], 0
    v_mov_b64 v[116:117], 0
    v_mov_b64 v[118:119], 0
    s_add_u32 s40, s40, 0x8000
    s_addc_u32 s41, s41, 0
    s_add_u32 s14, s14, 0x8000
    s_addc_u32 s15, s15, 0
    s_mov_b32 s6, 100000
    s_waitcnt lgkmcnt(0)
    v_add_u32 v15, s49, v10
    s_add_u32 s22, s42, s49
    s_addc_u32 s23, s43, 0
    ds_read_b128 v[64:67], v3 offset:0
    ds_read_b128 v[68:71], v3 offset:1024
    v_xor_b32 v28, 2048, v4
    v_xor_b32 v36, 4096, v4
    v_xor_b32 v14, 6144, v4
    v_mov_b32 v33, s5
    s_xor_b32 s7, s49, 0x4000
    v_add_u32 v38, s7, v10
    v_lshrrev_b32 v10, 2, v0
    global_load_dwordx4 v[40:43], v11, s[20:21] sc1
    global_load_dwordx4 v[44:47], v11, s[20:21] offset:2048 sc1
    v_mov_b64 v[34:35], -1
T_rp0_S:
    s_waitcnt vmcnt(3)
    v_bitop3_b32 v12, v40, v42, s34 bitop3:0x7e
    v_mfma_f32_16x16x32_bf16 v[124:127], v[120:123], v[40:43], 0
    s_waitcnt vmcnt(2)
    v_bitop3_b32 v13, v44, v46, s34 bitop3:0x7e
    v_mfma_f32_16x16x32_bf16 v[124:127], v[120:123], v[44:47], v[124:127]
    v_bitop3_b32 v12, v12, v13, 1 bitop3:0xa8
    v_cmp_ne_u32 vcc, 0, v12
T_rp0_Sq:
    s_nop 5
    v_add_f32_dpp v124, v124, v124 row_ror:4 row_mask:0xf bank_mask:0xf
    v_add_f32_dpp v125, v125, v125 row_ror:4 row_mask:0xf bank_mask:0xf
    s_cbranch_vccnz T_rf0_S
T_rok0_S:
    v_add_f32_dpp v124, v124, v124 row_ror:8 row_mask:0xf bank_mask:0xf
    v_add_f32_dpp v125, v125, v125 row_ror:8 row_mask:0xf bank_mask:0xf
    v_cvt_pk_bf16_f32 v126, v124, v125
    global_store_dword v15, v126, s[24:25] sc1
    s_cmp_eq_u32 s5, 63
    s_cbranch_scc1 T_e620_S
T_e62b0_S:
    s_xor_b32 s34, s34, 1
    v_cmp_ne_u32 s[52:53], 0, v9
    s_nop 3
    s_add_u32 s7, s5, 1
    s_min_u32 s7, s7, 63
    s_bitcmp1_b64 s[52:53], s7
    s_cbranch_scc1 T_fd_22
    s_mov_b32 s6, 400000
    v_lshrrev_b32 v12, 2, v0
T_fw_21:
    global_load_dword v13, v12, s[26:27] sc1
    s_waitcnt vmcnt(0)
    v_cmp_ne_u32 s[52:53], 0, v13
    s_nop 3
    s_bitcmp1_b64 s[52:53], s7
    s_cbranch_scc1 T_fd_22
    s_sub_u32 s6, s6, 1
    s_cmp_lg_u32 s6, 0
    s_cbranch_scc1 T_fw_21
T_fd_22:
    s_mov_b32 s6, 100000
    ds_read_b128 v[72:75], v3 offset:2048
    ds_read_b128 v[76:79], v3 offset:3072
    ds_read_b128 v[80:83], v3 offset:4096
    ds_read_b128 v[84:87], v3 offset:5120
    ds_read_b128 v[88:91], v3 offset:6144
    s_nop 1
    global_load_dwordx4 v[16:19], v11, s[22:23] sc1
    global_load_dwordx4 v[20:23], v11, s[22:23] offset:2048 sc1
    ds_read_b128 v[92:95], v3 offset:7168
    ds_read_b128 v[48:51], v3 offset:8192
    ds_read_b128 v[52:55], v3 offset:9216
    ds_read_b128 v[56:59], v3 offset:10240
    ds_read_b128 v[60:63], v3 offset:11264
    s_waitcnt lgkmcnt(0)
    s_nop 15
    global_load_dwordx4 v[16:19], v11, s[22:23] sc1
    global_load_dwordx4 v[20:23], v11, s[22:23] offset:2048 sc1
    s_branch T_hpf_S
T_e620_S:
    s_barrier
    buffer_store_dword v33, off, s[36:39], 0 sc1
    s_branch T_e62b0_S
T_rf0_S:
    s_mov_b64 exec, vcc
    global_load_dwordx4 v[40:43], v11, s[20:21] sc1
    global_load_dwordx4 v[44:47], v11, s[20:21] offset:2048 sc1
    s_mov_b64 exec, -1
    s_sub_u32 s6, s6, 1
    s_cbranch_scc0 T_rp0_S
    s_branch T_rok0_S
T_h1_S:
    ds_read_b128 v[120:123], v0 offset:28672
    ds_read_b32 v10, v0 offset:30720
    v_mov_b64 v[96:97], 0
    v_mov_b64 v[98:99], 0
    v_mov_b64 v[100:101], 0
    v_mov_b64 v[102:103], 0
    v_mov_b64 v[104:105], 0
    v_mov_b64 v[106:107], 0
    s_add_u32 s5, s5, 1
    s_add_u32 s49, s49, 0x2000
    s_and_b32 s49, s49, 0x6000
    s_add_u32 s12, s12, 0x8000
    s_addc_u32 s13, s13, 0
    v_mov_b64 v[108:109], 0
    v_mov_b64 v[110:111], 0
    global_load_dwordx4 v[40:43], v11, s[20:21] sc1
    global_load_dwordx4 v[44:47], v11, s[20:21] offset:2048 sc1
    v_mov_b64 v[112:113], 0
    v_mov_b64 v[114:115], 0
    v_mov_b64 v[116:117], 0
    v_mov_b64 v[118:119], 0
    s_add_u32 s40, s40, 0x8000
    s_addc_u32 s41, s41, 0
    s_add_u32 s14, s14, 0x8000
    s_addc_u32 s15, s15, 0
    s_mov_b32 s6, 100000
    s_waitcnt lgkmcnt(0)
    v_add_u32 v15, s49, v10
    s_add_u32 s22, s42, s49
    s_addc_u32 s23, s43, 0
    ds_read_b128 v[64:67], v3 offset:0
    ds_read_b128 v[68:71], v3 offset:1024
    v_xor_b32 v28, 2048, v4
    v_xor_b32 v36, 4096, v4
    v_xor_b32 v14, 6144, v4
    v_mov_b32 v33, s5
    s_xor_b32 s7, s49, 0x4000
    v_add_u32 v38, s7, v10
    v_lshrrev_b32 v10, 2, v0
    v_mov_b64 v[34:35], -1
    s_nop 15
    s_nop 3
    global_load_dwordx4 v[40:43], v11, s[20:21] sc1
    global_load_dwordx4 v[44:47], v11, s[20:21] offset:2048 sc1
T_rp1_S:
    s_waitcnt vmcnt(3)
    v_bitop3_b32 v12, v40, v42, s34 bitop3:0x7e
    v_mfma_f32_16x16x32_bf16 v[124:127], v[120:123], v[40:43], 0
    s_waitcnt vmcnt(2)
    v_bitop3_b32 v13, v44, v46, s34 bitop3:0x7e
    v_mfma_f32_16x16x32_bf16 v[124:127], v[120:123], v[44:47], v[124:127]
    v_bitop3_b32 v12, v12, v13, 1 bitop3:0xa8
    v_cmp_ne_u32 vcc, 0, v12
T_rp1_Sq:
    s_nop 5
    v_add_f32_dpp v124, v124, v124 row_ror:4 row_mask:0xf bank_mask:0xf
    v_add_f32_dpp v125, v125, v125 row_ror:4 row_mask:0xf bank_mask:0xf
    s_cbranch_vccnz T_rf1_S
T_rok1_S:
    v_add_f32_dpp v124, v124, v124 row_ror:8 row_mask:0xf bank_mask:0xf
    v_add_f32_dpp v125, v125, v125 row_ror:8 row_mask:0xf bank_mask:0xf
    v_cvt_pk_bf16_f32 v126, v124, v125
    global_store_dword v15, v126, s[24:25] sc1
    s_cmp_eq_u32 s5, 63
    s_cbranch_scc1 T_e621_S
T_e62b1_S:
    s_xor_b32 s34, s34, 1
    s_mov_b32 s6, 100000
    ds_read_b128 v[72:75], v3 offset:2048
    ds_read_b128 v[76:79], v3 offset:3072
    ds_read_b128 v[80:83], v3 offset:4096
    ds_read_b128 v[84:87], v3 offset:5120
    ds_read_b128 v[88:91], v3 offset:6144
    ds_read_b128 v[92:95], v3 offset:7168
    ds_read_b128 v[48:51], v3 offset:8192
    ds_read_b128 v[52:55], v3 offset:9216
    ds_read_b128 v[56:59], v3 offset:10240
    ds_read_b128 v[60:63], v3 offset:11264
    s_waitcnt lgkmcnt(0)
    s_nop 0
    global_load_dwordx4 v[16:19], v11, s[22:23] sc1
    global_load_dwordx4 v[20:23], v11, s[22:23] offset:2048 sc1
    s_nop 15
    s_nop 15
    global_load_dwordx4 v[16:19], v11, s[22:23] sc1
    global_load_dwordx4 v[20:23], v11, s[22:23] offset:2048 sc1
    s_branch T_hpf_S
T_e621_S:
    s_barrier
    s_branch T_e62b1_S
T_rf1_S:
    s_mov_b64 exec, vcc
    global_load_dwordx4 v[40:43], v11, s[20:21] sc1
    global_load_dwordx4 v[44:47], v11, s[20:21] offset:2048 sc1
    s_mov_b64 exec, -1
    s_sub_u32 s6, s6, 1
    s_cbranch_scc0 T_rp1_S
    s_branch T_rok1_S
T_h2_S:
    s_cmp_eq_u32 s3, 3
    s_cbranch_scc1 T_h3_S
    ds_read_b128 v[120:123], v0 offset:28672
    ds_read_b32 v10, v0 offset:30720
    v_mov_b64 v[96:97], 0
    v_mov_b64 v[98:99], 0
    v_mov_b64 v[100:101], 0
    v_mov_b64 v[102:103], 0
    v_mov_b64 v[104:105], 0
    v_mov_b64 v[106:107], 0
    s_add_u32 s5, s5, 1
    s_add_u32 s49, s49, 0x2000
    s_and_b32 s49, s49, 0x6000
    s_add_u32 s12, s12, 0x8000
    s_addc_u32 s13, s13, 0
    v_mov_b64 v[108:109], 0
    v_mov_b64 v[110:111], 0
    v_mov_b64 v[112:113], 0
    v_mov_b64 v[114:115], 0
    v_mov_b64 v[116:117], 0
    v_mov_b64 v[118:119], 0
    s_add_u32 s40, s40, 0x8000
    s_addc_u32 s41, s41, 0
    s_add_u32 s14, s14, 0x8000
    s_addc_u32 s15, s15, 0
    s_mov_b32 s6, 100000
    s_waitcnt lgkmcnt(0)
    v_add_u32 v15, s49, v10
    s_add_u32 s22, s42, s49
    s_addc_u32 s23, s43, 0
    global_load_dwordx4 v[40:43], v11, s[20:21] sc1
    global_load_dwordx4 v[44:47], v11, s[20:21] offset:2048 sc1
    ds_read_b128 v[64:67], v3 offset:0
    ds_read_b128 v[68:71], v3 offset:1024
    v_xor_b32 v28, 2048, v4
    v_xor_b32 v36, 4096, v4
    v_xor_b32 v14, 6144, v4
    v_mov_b32 v33, s5
    s_xor_b32 s7, s49, 0x4000
    v_add_u32 v38, s7, v10
    v_lshrrev_b32 v10, 2, v0
    v_mov_b64 v[34:35], -1
    s_nop 15
    s_nop 11
    global_load_dwordx4 v[40:43], v11, s[20:21] sc1
    global_load_dwordx4 v[44:47], v11, s[20:21] offset:2048 sc1
T_rp2_S:
    s_waitcnt vmcnt(3)
    v_bitop3_b32 v12, v40, v42, s34 bitop3:0x7e
    v_mfma_f32_16x16x32_bf16 v[124:127], v[120:123], v[40:43], 0
    s_waitcnt vmcnt(2)
    v_bitop3_b32 v13, v44, v46, s34 bitop3:0x7e
    v_mfma_f32_16x16x32_bf16 v[124:127], v[120:123], v[44:47], v[124:127]
    v_bitop3_b32 v12, v12, v13, 1 bitop3:0xa8
    v_cmp_ne_u32 vcc, 0, v12
T_rp2_Sq:
    s_nop 5
    v_add_f32_dpp v124, v124, v124 row_ror:4 row_mask:0xf bank_mask:0xf
    v_add_f32_dpp v125, v125, v125 row_ror:4 row_mask:0xf bank_mask:0xf
    s_cbranch_vccnz T_rf2_S
T_rok2_S:
    v_add_f32_dpp v124, v124, v124 row_ror:8 row_mask:0xf bank_mask:0xf
    v_add_f32_dpp v125, v125, v125 row_ror:8 row_mask:0xf bank_mask:0xf
    v_cvt_pk_bf16_f32 v126, v124, v125
    global_store_dword v15, v126, s[24:25] sc1
    s_cmp_eq_u32 s5, 63
    s_cbranch_scc1 T_e622_S
T_e62b2_S:
    s_xor_b32 s34, s34, 1
    s_mov_b32 s6, 100000
    ds_read_b128 v[72:75], v3 offset:2048
    ds_read_b128 v[76:79], v3 offset:3072
    ds_read_b128 v[80:83], v3 offset:4096
    ds_read_b128 v[84:87], v3 offset:5120
    ds_read_b128 v[88:91], v3 offset:6144
    ds_read_b128 v[92:95], v3 offset:7168
    ds_read_b128 v[48:51], v3 offset:8192
    ds_read_b128 v[52:55], v3 offset:9216
    ds_read_b128 v[56:59], v3 offset:10240
    ds_read_b128 v[60:63], v3 offset:11264
    s_waitcnt lgkmcnt(0)
    s_nop 0
    global_load_dwordx4 v[16:19], v11, s[22:23] sc1
    global_load_dwordx4 v[20:23], v11, s[22:23] offset:2048 sc1
    s_nop 15
    s_nop 15
    global_load_dwordx4 v[16:19], v11, s[22:23] sc1
    global_load_dwordx4 v[20:23], v11, s[22:23] offset:2048 sc1
    s_branch T_hpf_S
T_e622_S:
    s_barrier
    s_branch T_e62b2_S
T_rf2_S:
    s_mov_b64 exec, vcc
    global_load_dwordx4 v[40:43], v11, s[20:21] sc1
    global_load_dwordx4 v[44:47], v11, s[20:21] offset:2048 sc1
    s_mov_b64 exec, -1
    s_sub_u32 s6, s6, 1
    s_cbranch_scc0 T_rp2_S
    s_branch T_rok2_S
T_h3_S:
    ds_read_b128 v[120:123], v0 offset:28672
    ds_read_b32 v10, v0 offset:30720
    v_mov_b64 v[96:97], 0
    v_mov_b64 v[98:99], 0
    v_mov_b64 v[100:101], 0
    v_mov_b64 v[102:103], 0
    v_mov_b64 v[104:105], 0
    v_mov_b64 v[106:107], 0
    s_add_u32 s5, s5, 1
    s_add_u32 s49, s49, 0x2000
    s_and_b32 s49, s49, 0x6000
    s_add_u32 s12, s12, 0x8000
    s_addc_u32 s13, s13, 0
    v_mov_b64 v[108:109], 0
    v_mov_b64 v[110:111], 0
    v_mov_b64 v[112:113], 0
    v_mov_b64 v[114:115], 0
    v_mov_b64 v[116:117], 0
    v_mov_b64 v[118:119], 0
    s_add_u32 s40, s40, 0x8000
    s_addc_u32 s41, s41, 0
    s_add_u32 s14, s14, 0x8000
    s_addc_u32 s15, s15, 0
    s_mov_b32 s6, 100000
    s_waitcnt lgkmcnt(0)
    v_add_u32 v15, s49, v10
    s_add_u32 s22, s42, s49
    s_addc_u32 s23, s43, 0
    ds_read_b128 v[64:67], v3 offset:0
    ds_read_b128 v[68:71], v3 offset:1024
    v_xor_b32 v28, 2048, v4
    v_xor_b32 v36, 4096, v4
    v_xor_b32 v14, 6144, v4
    v_mov_b32 v33, s5
    global_load_dwordx4 v[40:43], v11, s[20:21] sc1
    global_load_dwordx4 v[44:47], v11, s[20:21] offset:2048 sc1
    s_xor_b32 s7, s49, 0x4000
    v_add_u32 v38, s7, v10
    v_lshrrev_b32 v10, 2, v0
    v_mov_b64 v[34:35], -1
    s_nop 15
    s_nop 11
    global_load_dwordx4 v[40:43], v11, s[20:21] sc1
    global_load_dwordx4 v[44:47], v11, s[20:21] offset:2048 sc1
T_rp3_S:
    s_waitcnt vmcnt(3)
    v_bitop3_b32 v12, v40, v42, s34 bitop3:0x7e
    v_mfma_f32_16x16x32_bf16 v[124:127], v[120:123], v[40:43], 0
    s_waitcnt vmcnt(2)
    v_bitop3_b32 v13, v44, v46, s34 bitop3:0x7e
    v_mfma_f32_16x16x32_bf16 v[124:127], v[120:123], v[44:47], v[124:127]
    v_bitop3_b32 v12, v12, v13, 1 bitop3:0xa8
    v_cmp_ne_u32 vcc, 0, v12
T_rp3_Sq:
    s_nop 5
    v_add_f32_dpp v124, v124, v124 row_ror:4 row_mask:0xf bank_mask:0xf
    v_add_f32_dpp v125, v125, v125 row_ror:4 row_mask:0xf bank_mask:0xf
    s_cbranch_vccnz T_rf3_S
T_rok3_S:
    v_add_f32_dpp v124, v124, v124 row_ror:8 row_mask:0xf bank_mask:0xf
    v_add_f32_dpp v125, v125, v125 row_ror:8 row_mask:0xf bank_mask:0xf
    v_cvt_pk_bf16_f32 v126, v124, v125
    global_store_dword v15, v126, s[24:25] sc1
    s_cmp_eq_u32 s5, 63
    s_cbranch_scc1 T_e623_S
T_e62b3_S:
    s_xor_b32 s34, s34, 1
    s_mov_b32 s6, 100000
    ds_read_b128 v[72:75], v3 offset:2048
    ds_read_b128 v[76:79], v3 offset:3072
    ds_read_b128 v[80:83], v3 offset:4096
    ds_read_b128 v[84:87], v3 offset:5120
    ds_read_b128 v[88:91], v3 offset:6144
    ds_read_b128 v[92:95], v3 offset:7168
    ds_read_b128 v[48:51], v3 offset:8192
    ds_read_b128 v[52:55], v3 offset:9216
    ds_read_b128 v[56:59], v3 offset:10240
    ds_read_b128 v[60:63], v3 offset:11264
    s_waitcnt lgkmcnt(0)
    s_nop 0
    global_load_dwordx4 v[16:19], v11, s[22:23] sc1
    global_load_dwordx4 v[20:23], v11, s[22:23] offset:2048 sc1
    s_nop 15
    s_nop 15
    global_load_dwordx4 v[16:19], v11, s[22:23] sc1
    global_load_dwordx4 v[20:23], v11, s[22:23] offset:2048 sc1
    s_branch T_hpf_S
T_e623_S:
    s_barrier
    s_branch T_e62b3_S
T_rf3_S:
    s_mov_b64 exec, vcc
    global_load_dwordx4 v[40:43], v11, s[20:21] sc1
    global_load_dwordx4 v[44:47], v11, s[20:21] offset:2048 sc1
    s_mov_b64 exec, -1
    s_sub_u32 s6, s6, 1
    s_cbranch_scc0 T_rp3_S
    s_branch T_rok3_S
T_fb_S:
    s_nop 7
    v_max3_f32 v12, v96, v97, v98
    v_max3_f32 v12, v12, v99, v100
    v_max3_f32 v12, v12, v101, v102
    v_max3_f32 v12, v12, v103, v10
    v_max_f32 v12, v12, v11
    v_mov_b32 v13, v12
    s_nop 1
    v_permlane32_swap_b32 v12, v13
    v_max_f32 v12, v12, v13
    v_mov_b32 v13, v12
    s_nop 1
    v_permlane16_swap_b32 v12, v13
    v_max_f32 v12, v12, v13
    v_sub_f32 v96, v96, v12
    v_sub_f32 v97, v97, v12
    v_sub_f32 v98, v98, v12
    v_sub_f32 v99, v99, v12
    v_sub_f32 v100, v100, v12
    v_sub_f32 v101, v101, v12
    v_sub_f32 v102, v102, v12
    v_sub_f32 v103, v103, v12
    v_sub_f32 v10, v10, v12
    v_sub_f32 v11, v11, v12
    v_exp_f32 v96, v96
    v_exp_f32 v97, v97
    v_exp_f32 v98, v98
    v_exp_f32 v99, v99
    v_exp_f32 v100, v100
    v_exp_f32 v101, v101
    v_exp_f32 v102, v102
    v_exp_f32 v103, v103
    v_exp_f32 v10, v10
    v_exp_f32 v11, v11
    v_cvt_pk_bf16_f32 v80, v96, v97
    v_cvt_pk_bf16_f32 v81, v98, v99
    v_cvt_pk_bf16_f32 v82, v100, v101
    v_cvt_pk_bf16_f32 v83, v102, v103
    v_cvt_pk_bf16_f32 v76, v10, v11
    v_cvt_pk_bf16_f32 v79, v10, v11
    s_nop 1
    v_mfma_f32_16x16x32_bf16 v[84:87], v[72:75], v[80:83], 0
    v_mfma_f32_16x16x32_bf16 v[104:107], v[120:123], v[80:83], 0
    v_mfma_f32_16x16x16_bf16 v[84:87], v[72:73], v[76:77], v[84:87]
    v_mfma_f32_16x16x32_bf16 v[108:111], v[124:127], v[80:83], 0
    v_mfma_f32_16x16x16_bf16 v[104:107], v[114:115], v[76:77], v[104:107]
    v_mfma_f32_16x16x16_bf16 v[108:111], v[114:115], v[78:79], v[108:111]
    s_nop 7
    v_rcp_f32 v12, v84
    s_mov_b64 vcc, 0
    s_branch T_back_S
T_end:
    v_lshrrev_b32 v10, 1, v4
    v_mov_b32 v11, 64
    s_waitcnt lgkmcnt(5)
    v_smfmac_f32_16x16x64_bf16 v[104:107], v[24:27], v[160:167], v1
    v_smfmac_f32_16x16x64_bf16 v[108:111], v[24:27], v[168:175], v1
    v_smfmac_f32_16x16x64_bf16 v[112:115], v[24:27], a[32:39], v1
    v_smfmac_f32_16x16x64_bf16 v[116:119], v[24:27], a[40:47], v1
    s_mov_b32 s76, s14
    s_and_b32 s77, s15, 0xffff
    s_mov_b32 s79, 0x20000
    s_waitcnt lgkmcnt(4)
    v_smfmac_f32_16x16x64_bf16 v[104:107], v[28:31], v[176:183], v1
    v_smfmac_f32_16x16x64_bf16 v[108:111], v[28:31], v[184:191], v1
    v_smfmac_f32_16x16x64_bf16 v[112:115], v[28:31], a[48:55], v1
    v_smfmac_f32_16x16x64_bf16 v[116:119], v[28:31], a[56:63], v1
    s_cmp_eq_u32 s5, 63
    s_cselect_b32 s78, 4096, 0
    s_waitcnt lgkmcnt(3)
    v_smfmac_f32_16x16x64_bf16 v[104:107], v[32:35], v[192:199], v1
    v_smfmac_f32_16x16x64_bf16 v[108:111], v[32:35], v[200:207], v1
    v_smfmac_f32_16x16x64_bf16 v[112:115], v[32:35], a[64:71], v1
    v_smfmac_f32_16x16x64_bf16 v[116:119], v[32:35], a[72:79], v1
    s_waitcnt lgkmcnt(2)
    v_smfmac_f32_16x16x64_bf16 v[104:107], v[36:39], v[208:215], v1
    v_smfmac_f32_16x16x64_bf16 v[108:111], v[36:39], v[216:223], v1
    v_smfmac_f32_16x16x64_bf16 v[112:115], v[36:39], a[80:87], v1
    v_smfmac_f32_16x16x64_bf16 v[116:119], v[36:39], a[88:95], v1
    s_waitcnt lgkmcnt(1)
    v_smfmac_f32_16x16x64_bf16 v[104:107], v[40:43], v[224:231], v1
    v_smfmac_f32_16x16x64_bf16 v[108:111], v[40:43], v[232:239], v1
    v_smfmac_f32_16x16x64_bf16 v[112:115], v[40:43], a[96:103], v1
    v_smfmac_f32_16x16x64_bf16 v[116:119], v[40:43], a[104:111], v1
    s_waitcnt lgkmcnt(0)
    v_smfmac_f32_16x16x64_bf16 v[104:107], v[44:47], v[240:247], v1
    v_smfmac_f32_16x16x64_bf16 v[108:111], v[44:47], v[248:255], v1
    v_smfmac_f32_16x16x64_bf16 v[112:115], v[44:47], a[112:119], v1
    v_smfmac_f32_16x16x64_bf16 v[116:119], v[44:47], a[120:127], v1
    s_nop 1
    v_add_f32 v104, v104, v106
    v_add_f32 v105, v105, v107
    v_cvt_pk_bf16_f32 v12, v104, v105
    v_add_f32 v108, v108, v110
    v_add_f32 v109, v109, v111
    v_cvt_pk_bf16_f32 v13, v108, v109
    buffer_store_dwordx2 v[12:13], v10, s[76:79], 0 offen offset:0 sc1
    v_add_f32 v112, v112, v114
    v_add_f32 v113, v113, v115
    v_cvt_pk_bf16_f32 v14, v112, v113
    v_add_f32 v116, v116, v118
    v_add_f32 v117, v117, v119
    v_cvt_pk_bf16_f32 v15, v116, v117
    buffer_store_dwordx2 v[14:15], v10, s[76:79], 0 offen offset:512 sc1
    s_cbranch_scc0 T_warm_back
    s_waitcnt vmcnt(0)
    s_barrier
    buffer_store_dword v11, off, s[36:39], 0 sc1
    s_lshl_b32 s7, s3, 6
    v_lshrrev_b32 v0, 4, v0
    v_add_u32 v0, s7, v0
    s_waitcnt vmcnt(0) lgkmcnt(0)
    s_barrier
    s_branch K_late7
K_exit:
    s_endpgm
K_work:
    s_getreg_b32 s58, hwreg(HW_REG_XCC_ID)
    s_sub_u32 s58, s58, s3
    s_and_b32 s58, s58, 3
    s_and_b32 s3, s2, 7
    s_add_u32 s5, s3, s58
    s_and_b32 s5, s5, 7
    s_xor_b32 s6, s5, s58
    s_lshl_b32 s6, s6, 2
    s_lshr_b32 s6, 0x5760, s6
    s_and_b32 s6, s6, 7
    s_sub_u32 s7, s5, 3
    s_cmp_lt_u32 s5, 4
    s_cselect_b32 s3, s6, s7
    s_cmp_le_u32 s3, 3
    s_cbranch_scc1 K_go
K_true:
    s_load_dwordx2 s[10:11], s[0:1], 104
    v_mov_b32 v8, 192
    s_mov_b32 s9, 800000
    s_waitcnt lgkmcnt(0)
I_w_23:
    global_load_dword v9, v8, s[10:11] sc1
    s_waitcnt vmcnt(0)
    v_cmp_le_u32 vcc, 1, v9
    s_cbranch_vccnz I_d_24
    s_sleep 1
    s_sub_u32 s9, s9, 1
    s_cbranch_scc0 I_w_23
I_d_24:
    v_readfirstlane_b32 s58, v9
    s_nop 3
    s_sub_u32 s58, s58, 1
    s_and_b32 s58, s58, 3
    s_and_b32 s3, s2, 7
    s_add_u32 s5, s3, s58
    s_and_b32 s5, s5, 7
    s_xor_b32 s6, s5, s58
    s_lshl_b32 s6, s6, 2
    s_lshr_b32 s6, 0x5760, s6
    s_and_b32 s6, s6, 7
    s_sub_u32 s7, s5, 3
    s_cmp_lt_u32 s5, 4
    s_cselect_b32 s3, s6, s7
K_go:
    s_sub_u32 s3, s3, 1
    s_lshl_b32 s3, s3, 5
    s_lshr_b32 s5, s2, 3
    s_add_u32 s3, s3, s5
    s_cmp_ge_u32 s3, 96
    s_cbranch_scc1 K_down
    s_mul_i32 s4, s3, 21846
    s_lshr_b32 s4, s4, 16
    s_mul_i32 s5, s4, 3
    s_sub_u32 s6, s3, s5
    v_lshrrev_b32 v8, 6, v0
    s_load_dwordx4 s[36:39], s[0:1], 16
    s_load_dwordx2 s[40:41], s[0:1], 32
    s_load_dwordx2 s[12:13], s[0:1], 112
    v_readfirstlane_b32 s3, v8
    v_and_b32 v16, 63, v0
    v_lshlrev_b32 v0, 4, v16
    s_lshl_b32 s44, s3, 15
    s_mov_b32 s47, 8192
    v_bfe_u32 v17, v16, 2, 1
    v_lshlrev_b32 v18, 6, v17
    v_bfe_u32 v17, v16, 4, 1
    v_lshlrev_b32 v21, 6, v17
    v_xor_b32 v18, v18, v21
    v_bfe_u32 v17, v16, 3, 3
    v_lshl_add_u32 v18, v17, 13, v18
    v_bfe_u32 v17, v16, 0, 2
    v_lshl_add_u32 v18, v17, 4, v18
    v_bfe_u32 v17, v16, 3, 1
    v_lshlrev_b32 v19, 6, v17
    s_and_b32 s7, s3, 1
    s_lshl_b32 s7, s7, 6
    v_xor_b32 v19, s7, v19
    v_bfe_u32 v17, v16, 5, 1
    v_lshl_add_u32 v19, v17, 15, v19
    v_bfe_u32 v17, v16, 2, 2
    v_lshl_add_u32 v19, v17, 7, v19
    v_bfe_u32 v17, v16, 4, 1
    v_lshl_add_u32 v19, v17, 5, v19
    v_bfe_u32 v17, v16, 0, 1
    v_lshl_add_u32 v19, v17, 4, v19
    v_bfe_u32 v17, v16, 1, 1
    v_lshl_add_u32 v19, v17, 3, v19
    s_and_b32 s7, s3, 2
    s_lshl_b32 s7, s7, 15
    v_add_u32 v19, s7, v19
    v_add_u32 v20, 512, v19
    s_lshl_b32 s7, s3, 11
    v_add_u32 v1, s7, v0
    v_bfe_u32 v17, v16, 3, 1
    v_lshlrev_b32 v2, 12, v17
    v_bfe_u32 v17, v16, 4, 1
    v_lshl_add_u32 v2, v17, 7, v2
    v_bfe_u32 v17, v16, 0, 3
    v_lshl_add_u32 v2, v17, 4, v2
    v_bfe_u32 v17, v16, 5, 1
    v_lshl_add_u32 v2, v17, 8, v2
    s_lshr_b32 s7, s3, 1
    s_lshl_b32 s7, s7, 11
    s_and_b32 s8, s3, 1
    s_lshl_b32 s8, s8, 9
    s_add_u32 s7, s7, s8
    v_add_u32 v2, s7, v2
    v_bfe_u32 v17, v16, 4, 1
    v_lshlrev_b32 v3, 10, v17
    v_bfe_u32 v17, v16, 2, 1
    v_lshl_add_u32 v3, v17, 7, v3
    v_bfe_u32 v17, v16, 3, 1
    v_lshl_add_u32 v3, v17, 6, v3
    v_bfe_u32 v17, v16, 0, 2
    v_lshl_add_u32 v3, v17, 4, v3
    v_bfe_u32 v17, v16, 5, 1
    v_lshl_add_u32 v3, v17, 8, v3
    s_lshl_b32 s7, s3, 11
    s_add_u32 s7, s7, 16384
    v_add_u32 v3, s7, v3
    v_bfe_u32 v17, v16, 0, 2
    v_lshlrev_b32 v4, 7, v17
    v_bfe_u32 v17, v16, 5, 1
    v_lshl_add_u32 v4, v17, 6, v4
    v_bfe_u32 v17, v16, 2, 2
    v_lshl_add_u32 v4, v17, 3, v4
    v_bfe_u32 v17, v16, 5, 1
    v_lshlrev_b32 v5, 7, v17
    v_bfe_u32 v17, v16, 2, 1
    v_lshl_add_u32 v5, v17, 6, v5
    v_bfe_u32 v17, v16, 3, 1
    v_lshl_add_u32 v5, v17, 5, v5
    v_bfe_u32 v17, v16, 0, 2
    v_lshl_add_u32 v5, v17, 3, v5
    v_bfe_u32 v17, v16, 4, 1
    v_lshl_add_u32 v5, v17, 2, v5
    s_lshl_b32 s7, s3, 10
    s_add_u32 s7, s7, 512
    v_add_u32 v5, s7, v5
    s_mov_b32 s10, 0x3fb8aa3b
    v_mov_b32 v6, 0x3db504f3
    s_waitcnt lgkmcnt(0)
    s_mov_b32 s8, 0
    s_lshl_b32 s7, s3, 13
    s_add_u32 s8, s8, s7
    s_add_u32 s14, s12, s8
    s_addc_u32 s15, s13, 0
    s_mov_b32 s8, 4194304
    s_lshl_b32 s7, s4, 21
    s_add_u32 s8, s8, s7
    s_add_u32 s16, s12, s8
    s_addc_u32 s17, s13, 0
    s_mov_b32 s8, 149848064
    s_lshl_b32 s7, s4, 8
    s_add_u32 s8, s8, s7
    s_add_u32 s18, s12, s8
    s_addc_u32 s19, s13, 0
    s_mov_b32 s8, 149864448
    s_lshl_b32 s7, s4, 8
    s_add_u32 s8, s8, s7
    s_add_u32 s20, s12, s8
    s_addc_u32 s21, s13, 0
    s_mov_b32 s8, 83886080
    s_lshl_b32 s7, s4, 14
    s_add_u32 s8, s8, s7
    s_add_u32 s24, s12, s8
    s_addc_u32 s25, s13, 0
    s_lshr_b32 s45, s4, 2
    s_and_b32 s46, s4, 3
    s_mov_b32 s8, 84754432
    s_lshl_b32 s7, s45, 7
    s_add_u32 s8, s8, s7
    s_lshl_b32 s7, s46, 2
    s_add_u32 s8, s8, s7
    s_add_u32 s50, s12, s8
    s_addc_u32 s51, s13, 0
    s_mov_b32 s34, 0x400000
    s_mov_b32 s35, 0x20000
    s_lshl_b32 s46, s4, 8
    s_and_b32 s7, s3, 2
    s_lshl_b32 s7, s7, 6
    s_add_u32 s46, s46, s7
    s_and_b32 s7, s3, 1
    s_lshl_b32 s7, s7, 16
    s_add_u32 s46, s46, s7
    s_lshl_b32 s48, s3, 13
    v_add_u32 v7, 131072, v0
    s_mov_b32 s32, s38
    s_and_b32 s33, s39, 0xffff
    s_add_u32 m0, s44, 0
    s_add_u32 s45, s46, 0
    buffer_load_dwordx4 v18, s[32:35], s45 offen lds
    s_add_u32 m0, s44, 1024
    s_add_u32 s45, s46, 131072
    buffer_load_dwordx4 v18, s[32:35], s45 offen lds
    s_add_u32 m0, s44, 2048
    s_add_u32 s45, s46, 262144
    buffer_load_dwordx4 v18, s[32:35], s45 offen lds
    s_add_u32 m0, s44, 3072
    s_add_u32 s45, s46, 393216
    buffer_load_dwordx4 v18, s[32:35], s45 offen lds
    s_add_u32 m0, s44, 4096
    s_add_u32 s45, s46, 524288
    buffer_load_dwordx4 v18, s[32:35], s45 offen lds
    s_add_u32 m0, s44, 5120
    s_add_u32 s45, s46, 655360
    buffer_load_dwordx4 v18, s[32:35], s45 offen lds
    s_add_u32 m0, s44, 6144
    s_add_u32 s45, s46, 786432
    buffer_load_dwordx4 v18, s[32:35], s45 offen lds
    s_add_u32 m0, s44, 7168
    s_add_u32 s45, s46, 917504
    buffer_load_dwordx4 v18, s[32:35], s45 offen lds
    s_add_u32 m0, s44, 8192
    s_add_u32 s45, s46, 1048576
    buffer_load_dwordx4 v18, s[32:35], s45 offen lds
    s_add_u32 m0, s44, 9216
    s_add_u32 s45, s46, 1179648
    buffer_load_dwordx4 v18, s[32:35], s45 offen lds
    s_add_u32 m0, s44, 10240
    s_add_u32 s45, s46, 1310720
    buffer_load_dwordx4 v18, s[32:35], s45 offen lds
    s_add_u32 m0, s44, 11264
    s_add_u32 s45, s46, 1441792
    buffer_load_dwordx4 v18, s[32:35], s45 offen lds
    s_add_u32 m0, s44, 12288
    s_add_u32 s45, s46, 1572864
    buffer_load_dwordx4 v18, s[32:35], s45 offen lds
    s_add_u32 m0, s44, 13312
    s_add_u32 s45, s46, 1703936
    buffer_load_dwordx4 v18, s[32:35], s45 offen lds
    s_add_u32 m0, s44, 14336
    s_add_u32 s45, s46, 1835008
    buffer_load_dwordx4 v18, s[32:35], s45 offen lds
    s_add_u32 m0, s44, 15360
    s_add_u32 s45, s46, 1966080
    buffer_load_dwordx4 v18, s[32:35], s45 offen lds
    s_add_u32 m0, s44, 16384
    s_add_u32 s45, s46, 2097152
    buffer_load_dwordx4 v18, s[32:35], s45 offen lds
    s_add_u32 m0, s44, 17408
    s_add_u32 s45, s46, 2228224
    buffer_load_dwordx4 v18, s[32:35], s45 offen lds
    s_add_u32 m0, s44, 18432
    s_add_u32 s45, s46, 2359296
    buffer_load_dwordx4 v18, s[32:35], s45 offen lds
    s_add_u32 m0, s44, 19456
    s_add_u32 s45, s46, 2490368
    buffer_load_dwordx4 v18, s[32:35], s45 offen lds
    s_add_u32 m0, s44, 20480
    s_add_u32 s45, s46, 2621440
    buffer_load_dwordx4 v18, s[32:35], s45 offen lds
    s_add_u32 m0, s44, 21504
    s_add_u32 s45, s46, 2752512
    buffer_load_dwordx4 v18, s[32:35], s45 offen lds
    s_add_u32 m0, s44, 22528
    s_add_u32 s45, s46, 2883584
    buffer_load_dwordx4 v18, s[32:35], s45 offen lds
    s_add_u32 m0, s44, 23552
    s_add_u32 s45, s46, 3014656
    buffer_load_dwordx4 v18, s[32:35], s45 offen lds
    s_add_u32 m0, s44, 24576
    s_add_u32 s45, s46, 3145728
    buffer_load_dwordx4 v18, s[32:35], s45 offen lds
    s_add_u32 m0, s44, 25600
    s_add_u32 s45, s46, 3276800
    buffer_load_dwordx4 v18, s[32:35], s45 offen lds
    s_add_u32 m0, s44, 26624
    s_add_u32 s45, s46, 3407872
    buffer_load_dwordx4 v18, s[32:35], s45 offen lds
    s_add_u32 m0, s44, 27648
    s_add_u32 s45, s46, 3538944
    buffer_load_dwordx4 v18, s[32:35], s45 offen lds
    s_add_u32 m0, s44, 28672
    s_add_u32 s45, s46, 3670016
    buffer_load_dwordx4 v18, s[32:35], s45 offen lds
    s_add_u32 m0, s44, 29696
    s_add_u32 s45, s46, 3801088
    buffer_load_dwordx4 v18, s[32:35], s45 offen lds
    s_add_u32 m0, s44, 30720
    s_add_u32 s45, s46, 3932160
    buffer_load_dwordx4 v18, s[32:35], s45 offen lds
    s_add_u32 m0, s44, 31744
    s_add_u32 s45, s46, 4063232
    buffer_load_dwordx4 v18, s[32:35], s45 offen lds
    s_waitcnt vmcnt(16)
    s_barrier
    ds_read_b64_tr_b16 a[128:129], v19 offset:0
    ds_read_b64_tr_b16 a[130:131], v20 offset:0
    ds_read_b64_tr_b16 a[132:133], v19 offset:1024
    ds_read_b64_tr_b16 a[134:135], v20 offset:1024
    ds_read_b64_tr_b16 a[136:137], v19 offset:2048
    ds_read_b64_tr_b16 a[138:139], v20 offset:2048
    ds_read_b64_tr_b16 a[140:141], v19 offset:3072
    ds_read_b64_tr_b16 a[142:143], v20 offset:3072
    ds_read_b64_tr_b16 a[144:145], v19 offset:4096
    ds_read_b64_tr_b16 a[146:147], v20 offset:4096
    ds_read_b64_tr_b16 a[148:149], v19 offset:5120
    ds_read_b64_tr_b16 a[150:151], v20 offset:5120
    ds_read_b64_tr_b16 a[152:153], v19 offset:6144
    ds_read_b64_tr_b16 a[154:155], v20 offset:6144
    ds_read_b64_tr_b16 a[156:157], v19 offset:7168
    ds_read_b64_tr_b16 a[158:159], v20 offset:7168
    ds_read_b64_tr_b16 a[160:161], v19 offset:8192
    ds_read_b64_tr_b16 a[162:163], v20 offset:8192
    ds_read_b64_tr_b16 a[164:165], v19 offset:9216
    ds_read_b64_tr_b16 a[166:167], v20 offset:9216
    ds_read_b64_tr_b16 a[168:169], v19 offset:10240
    ds_read_b64_tr_b16 a[170:171], v20 offset:10240
    ds_read_b64_tr_b16 a[172:173], v19 offset:11264
    ds_read_b64_tr_b16 a[174:175], v20 offset:11264
    ds_read_b64_tr_b16 a[176:177], v19 offset:12288
    ds_read_b64_tr_b16 a[178:179], v20 offset:12288
    ds_read_b64_tr_b16 a[180:181], v19 offset:13312
    ds_read_b64_tr_b16 a[182:183], v20 offset:13312
    ds_read_b64_tr_b16 a[184:185], v19 offset:14336
    ds_read_b64_tr_b16 a[186:187], v20 offset:14336
    ds_read_b64_tr_b16 a[188:189], v19 offset:15360
    ds_read_b64_tr_b16 a[190:191], v20 offset:15360
    s_waitcnt lgkmcnt(0)
    s_barrier
    s_mov_b32 s32, s40
    s_and_b32 s33, s41, 0xffff
    s_add_u32 m0, s44, 0
    s_add_u32 s45, s46, 0
    buffer_load_dwordx4 v18, s[32:35], s45 offen lds
    s_add_u32 m0, s44, 1024
    s_add_u32 s45, s46, 131072
    buffer_load_dwordx4 v18, s[32:35], s45 offen lds
    s_add_u32 m0, s44, 2048
    s_add_u32 s45, s46, 262144
    buffer_load_dwordx4 v18, s[32:35], s45 offen lds
    s_add_u32 m0, s44, 3072
    s_add_u32 s45, s46, 393216
    buffer_load_dwordx4 v18, s[32:35], s45 offen lds
    s_add_u32 m0, s44, 4096
    s_add_u32 s45, s46, 524288
    buffer_load_dwordx4 v18, s[32:35], s45 offen lds
    s_add_u32 m0, s44, 5120
    s_add_u32 s45, s46, 655360
    buffer_load_dwordx4 v18, s[32:35], s45 offen lds
    s_add_u32 m0, s44, 6144
    s_add_u32 s45, s46, 786432
    buffer_load_dwordx4 v18, s[32:35], s45 offen lds
    s_add_u32 m0, s44, 7168
    s_add_u32 s45, s46, 917504
    buffer_load_dwordx4 v18, s[32:35], s45 offen lds
    s_add_u32 m0, s44, 8192
    s_add_u32 s45, s46, 1048576
    buffer_load_dwordx4 v18, s[32:35], s45 offen lds
    s_add_u32 m0, s44, 9216
    s_add_u32 s45, s46, 1179648
    buffer_load_dwordx4 v18, s[32:35], s45 offen lds
    s_add_u32 m0, s44, 10240
    s_add_u32 s45, s46, 1310720
    buffer_load_dwordx4 v18, s[32:35], s45 offen lds
    s_add_u32 m0, s44, 11264
    s_add_u32 s45, s46, 1441792
    buffer_load_dwordx4 v18, s[32:35], s45 offen lds
    s_add_u32 m0, s44, 12288
    s_add_u32 s45, s46, 1572864
    buffer_load_dwordx4 v18, s[32:35], s45 offen lds
    s_add_u32 m0, s44, 13312
    s_add_u32 s45, s46, 1703936
    buffer_load_dwordx4 v18, s[32:35], s45 offen lds
    s_add_u32 m0, s44, 14336
    s_add_u32 s45, s46, 1835008
    buffer_load_dwordx4 v18, s[32:35], s45 offen lds
    s_add_u32 m0, s44, 15360
    s_add_u32 s45, s46, 1966080
    buffer_load_dwordx4 v18, s[32:35], s45 offen lds
    s_waitcnt vmcnt(16)
    s_barrier
    ds_read_b64_tr_b16 a[192:193], v19 offset:16384
    ds_read_b64_tr_b16 a[194:195], v20 offset:16384
    ds_read_b64_tr_b16 a[196:197], v19 offset:17408
    ds_read_b64_tr_b16 a[198:199], v20 offset:17408
    ds_read_b64_tr_b16 a[200:201], v19 offset:18432
    ds_read_b64_tr_b16 a[202:203], v20 offset:18432
    ds_read_b64_tr_b16 a[204:205], v19 offset:19456
    ds_read_b64_tr_b16 a[206:207], v20 offset:19456
    ds_read_b64_tr_b16 a[208:209], v19 offset:20480
    ds_read_b64_tr_b16 a[210:211], v20 offset:20480
    ds_read_b64_tr_b16 a[212:213], v19 offset:21504
    ds_read_b64_tr_b16 a[214:215], v20 offset:21504
    ds_read_b64_tr_b16 a[216:217], v19 offset:22528
    ds_read_b64_tr_b16 a[218:219], v20 offset:22528
    ds_read_b64_tr_b16 a[220:221], v19 offset:23552
    ds_read_b64_tr_b16 a[222:223], v20 offset:23552
    ds_read_b64_tr_b16 a[224:225], v19 offset:24576
    ds_read_b64_tr_b16 a[226:227], v20 offset:24576
    ds_read_b64_tr_b16 a[228:229], v19 offset:25600
    ds_read_b64_tr_b16 a[230:231], v20 offset:25600
    ds_read_b64_tr_b16 a[232:233], v19 offset:26624
    ds_read_b64_tr_b16 a[234:235], v20 offset:26624
    ds_read_b64_tr_b16 a[236:237], v19 offset:27648
    ds_read_b64_tr_b16 a[238:239], v20 offset:27648
    ds_read_b64_tr_b16 a[240:241], v19 offset:28672
    ds_read_b64_tr_b16 a[242:243], v20 offset:28672
    ds_read_b64_tr_b16 a[244:245], v19 offset:29696
    ds_read_b64_tr_b16 a[246:247], v20 offset:29696
    ds_read_b64_tr_b16 a[248:249], v19 offset:30720
    ds_read_b64_tr_b16 a[250:251], v20 offset:30720
    ds_read_b64_tr_b16 a[252:253], v19 offset:31744
    ds_read_b64_tr_b16 a[254:255], v20 offset:31744
    s_waitcnt lgkmcnt(0)
    s_barrier
    s_add_u32 m0, s44, 16384
    s_add_u32 s45, s46, 2097152
    buffer_load_dwordx4 v18, s[32:35], s45 offen lds
    s_add_u32 m0, s44, 17408
    s_add_u32 s45, s46, 2228224
    buffer_load_dwordx4 v18, s[32:35], s45 offen lds
    s_add_u32 m0, s44, 18432
    s_add_u32 s45, s46, 2359296
    buffer_load_dwordx4 v18, s[32:35], s45 offen lds
    s_add_u32 m0, s44, 19456
    s_add_u32 s45, s46, 2490368
    buffer_load_dwordx4 v18, s[32:35], s45 offen lds
    s_add_u32 m0, s44, 20480
    s_add_u32 s45, s46, 2621440
    buffer_load_dwordx4 v18, s[32:35], s45 offen lds
    s_add_u32 m0, s44, 21504
    s_add_u32 s45, s46, 2752512
    buffer_load_dwordx4 v18, s[32:35], s45 offen lds
    s_add_u32 m0, s44, 22528
    s_add_u32 s45, s46, 2883584
    buffer_load_dwordx4 v18, s[32:35], s45 offen lds
    s_add_u32 m0, s44, 23552
    s_add_u32 s45, s46, 3014656
    buffer_load_dwordx4 v18, s[32:35], s45 offen lds
    s_add_u32 m0, s44, 24576
    s_add_u32 s45, s46, 3145728
    buffer_load_dwordx4 v18, s[32:35], s45 offen lds
    s_add_u32 m0, s44, 25600
    s_add_u32 s45, s46, 3276800
    buffer_load_dwordx4 v18, s[32:35], s45 offen lds
    s_add_u32 m0, s44, 26624
    s_add_u32 s45, s46, 3407872
    buffer_load_dwordx4 v18, s[32:35], s45 offen lds
    s_add_u32 m0, s44, 27648
    s_add_u32 s45, s46, 3538944
    buffer_load_dwordx4 v18, s[32:35], s45 offen lds
    s_add_u32 m0, s44, 28672
    s_add_u32 s45, s46, 3670016
    buffer_load_dwordx4 v18, s[32:35], s45 offen lds
    s_add_u32 m0, s44, 29696
    s_add_u32 s45, s46, 3801088
    buffer_load_dwordx4 v18, s[32:35], s45 offen lds
    s_add_u32 m0, s44, 30720
    s_add_u32 s45, s46, 3932160
    buffer_load_dwordx4 v18, s[32:35], s45 offen lds
    s_add_u32 m0, s44, 31744
    s_add_u32 s45, s46, 4063232
    buffer_load_dwordx4 v18, s[32:35], s45 offen lds
    s_waitcnt vmcnt(16)
    s_barrier
    ds_read_b64_tr_b16 v[128:129], v19 offset:0
    ds_read_b64_tr_b16 v[130:131], v20 offset:0
    ds_read_b64_tr_b16 v[132:133], v19 offset:1024
    ds_read_b64_tr_b16 v[134:135], v20 offset:1024
    ds_read_b64_tr_b16 v[136:137], v19 offset:2048
    ds_read_b64_tr_b16 v[138:139], v20 offset:2048
    ds_read_b64_tr_b16 v[140:141], v19 offset:3072
    ds_read_b64_tr_b16 v[142:143], v20 offset:3072
    ds_read_b64_tr_b16 v[144:145], v19 offset:4096
    ds_read_b64_tr_b16 v[146:147], v20 offset:4096
    ds_read_b64_tr_b16 v[148:149], v19 offset:5120
    ds_read_b64_tr_b16 v[150:151], v20 offset:5120
    ds_read_b64_tr_b16 v[152:153], v19 offset:6144
    ds_read_b64_tr_b16 v[154:155], v20 offset:6144
    ds_read_b64_tr_b16 v[156:157], v19 offset:7168
    ds_read_b64_tr_b16 v[158:159], v20 offset:7168
    ds_read_b64_tr_b16 v[160:161], v19 offset:8192
    ds_read_b64_tr_b16 v[162:163], v20 offset:8192
    ds_read_b64_tr_b16 v[164:165], v19 offset:9216
    ds_read_b64_tr_b16 v[166:167], v20 offset:9216
    ds_read_b64_tr_b16 v[168:169], v19 offset:10240
    ds_read_b64_tr_b16 v[170:171], v20 offset:10240
    ds_read_b64_tr_b16 v[172:173], v19 offset:11264
    ds_read_b64_tr_b16 v[174:175], v20 offset:11264
    ds_read_b64_tr_b16 v[176:177], v19 offset:12288
    ds_read_b64_tr_b16 v[178:179], v20 offset:12288
    ds_read_b64_tr_b16 v[180:181], v19 offset:13312
    ds_read_b64_tr_b16 v[182:183], v20 offset:13312
    ds_read_b64_tr_b16 v[184:185], v19 offset:14336
    ds_read_b64_tr_b16 v[186:187], v20 offset:14336
    ds_read_b64_tr_b16 v[188:189], v19 offset:15360
    ds_read_b64_tr_b16 v[190:191], v20 offset:15360
    s_waitcnt lgkmcnt(0)
    s_barrier
    s_mov_b32 s32, s36
    s_and_b32 s33, s37, 0xffff
    s_add_u32 m0, s44, 0
    s_add_u32 s45, s46, 0
    buffer_load_dwordx4 v18, s[32:35], s45 offen lds
    s_add_u32 m0, s44, 1024
    s_add_u32 s45, s46, 131072
    buffer_load_dwordx4 v18, s[32:35], s45 offen lds
    s_add_u32 m0, s44, 2048
    s_add_u32 s45, s46, 262144
    buffer_load_dwordx4 v18, s[32:35], s45 offen lds
    s_add_u32 m0, s44, 3072
    s_add_u32 s45, s46, 393216
    buffer_load_dwordx4 v18, s[32:35], s45 offen lds
    s_add_u32 m0, s44, 4096
    s_add_u32 s45, s46, 524288
    buffer_load_dwordx4 v18, s[32:35], s45 offen lds
    s_add_u32 m0, s44, 5120
    s_add_u32 s45, s46, 655360
    buffer_load_dwordx4 v18, s[32:35], s45 offen lds
    s_add_u32 m0, s44, 6144
    s_add_u32 s45, s46, 786432
    buffer_load_dwordx4 v18, s[32:35], s45 offen lds
    s_add_u32 m0, s44, 7168
    s_add_u32 s45, s46, 917504
    buffer_load_dwordx4 v18, s[32:35], s45 offen lds
    s_add_u32 m0, s44, 8192
    s_add_u32 s45, s46, 1048576
    buffer_load_dwordx4 v18, s[32:35], s45 offen lds
    s_add_u32 m0, s44, 9216
    s_add_u32 s45, s46, 1179648
    buffer_load_dwordx4 v18, s[32:35], s45 offen lds
    s_add_u32 m0, s44, 10240
    s_add_u32 s45, s46, 1310720
    buffer_load_dwordx4 v18, s[32:35], s45 offen lds
    s_add_u32 m0, s44, 11264
    s_add_u32 s45, s46, 1441792
    buffer_load_dwordx4 v18, s[32:35], s45 offen lds
    s_add_u32 m0, s44, 12288
    s_add_u32 s45, s46, 1572864
    buffer_load_dwordx4 v18, s[32:35], s45 offen lds
    s_add_u32 m0, s44, 13312
    s_add_u32 s45, s46, 1703936
    buffer_load_dwordx4 v18, s[32:35], s45 offen lds
    s_add_u32 m0, s44, 14336
    s_add_u32 s45, s46, 1835008
    buffer_load_dwordx4 v18, s[32:35], s45 offen lds
    s_add_u32 m0, s44, 15360
    s_add_u32 s45, s46, 1966080
    buffer_load_dwordx4 v18, s[32:35], s45 offen lds
    s_waitcnt vmcnt(16)
    s_barrier
    ds_read_b64_tr_b16 v[192:193], v19 offset:16384
    ds_read_b64_tr_b16 v[194:195], v20 offset:16384
    ds_read_b64_tr_b16 v[196:197], v19 offset:17408
    ds_read_b64_tr_b16 v[198:199], v20 offset:17408
    ds_read_b64_tr_b16 v[200:201], v19 offset:18432
    ds_read_b64_tr_b16 v[202:203], v20 offset:18432
    ds_read_b64_tr_b16 v[204:205], v19 offset:19456
    ds_read_b64_tr_b16 v[206:207], v20 offset:19456
    ds_read_b64_tr_b16 v[208:209], v19 offset:20480
    ds_read_b64_tr_b16 v[210:211], v20 offset:20480
    ds_read_b64_tr_b16 v[212:213], v19 offset:21504
    ds_read_b64_tr_b16 v[214:215], v20 offset:21504
    ds_read_b64_tr_b16 v[216:217], v19 offset:22528
    ds_read_b64_tr_b16 v[218:219], v20 offset:22528
    ds_read_b64_tr_b16 v[220:221], v19 offset:23552
    ds_read_b64_tr_b16 v[222:223], v20 offset:23552
    ds_read_b64_tr_b16 v[224:225], v19 offset:24576
    ds_read_b64_tr_b16 v[226:227], v20 offset:24576
    ds_read_b64_tr_b16 v[228:229], v19 offset:25600
    ds_read_b64_tr_b16 v[230:231], v20 offset:25600
    ds_read_b64_tr_b16 v[232:233], v19 offset:26624
    ds_read_b64_tr_b16 v[234:235], v20 offset:26624
    ds_read_b64_tr_b16 v[236:237], v19 offset:27648
    ds_read_b64_tr_b16 v[238:239], v20 offset:27648
    ds_read_b64_tr_b16 v[240:241], v19 offset:28672
    ds_read_b64_tr_b16 v[242:243], v20 offset:28672
    ds_read_b64_tr_b16 v[244:245], v19 offset:29696
    ds_read_b64_tr_b16 v[246:247], v20 offset:29696
    ds_read_b64_tr_b16 v[248:249], v19 offset:30720
    ds_read_b64_tr_b16 v[250:251], v20 offset:30720
    ds_read_b64_tr_b16 v[252:253], v19 offset:31744
    ds_read_b64_tr_b16 v[254:255], v20 offset:31744
    s_waitcnt lgkmcnt(0)
    s_barrier
    s_add_u32 m0, s44, 16384
    s_add_u32 s45, s46, 2097152
    buffer_load_dwordx4 v18, s[32:35], s45 offen lds
    s_add_u32 m0, s44, 17408
    s_add_u32 s45, s46, 2228224
    buffer_load_dwordx4 v18, s[32:35], s45 offen lds
    s_add_u32 m0, s44, 18432
    s_add_u32 s45, s46, 2359296
    buffer_load_dwordx4 v18, s[32:35], s45 offen lds
    s_add_u32 m0, s44, 19456
    s_add_u32 s45, s46, 2490368
    buffer_load_dwordx4 v18, s[32:35], s45 offen lds
    s_add_u32 m0, s44, 20480
    s_add_u32 s45, s46, 2621440
    buffer_load_dwordx4 v18, s[32:35], s45 offen lds
    s_add_u32 m0, s44, 21504
    s_add_u32 s45, s46, 2752512
    buffer_load_dwordx4 v18, s[32:35], s45 offen lds
    s_add_u32 m0, s44, 22528
    s_add_u32 s45, s46, 2883584
    buffer_load_dwordx4 v18, s[32:35], s45 offen lds
    s_add_u32 m0, s44, 23552
    s_add_u32 s45, s46, 3014656
    buffer_load_dwordx4 v18, s[32:35], s45 offen lds
    s_add_u32 m0, s44, 24576
    s_add_u32 s45, s46, 3145728
    buffer_load_dwordx4 v18, s[32:35], s45 offen lds
    s_add_u32 m0, s44, 25600
    s_add_u32 s45, s46, 3276800
    buffer_load_dwordx4 v18, s[32:35], s45 offen lds
    s_add_u32 m0, s44, 26624
    s_add_u32 s45, s46, 3407872
    buffer_load_dwordx4 v18, s[32:35], s45 offen lds
    s_add_u32 m0, s44, 27648
    s_add_u32 s45, s46, 3538944
    buffer_load_dwordx4 v18, s[32:35], s45 offen lds
    s_add_u32 m0, s44, 28672
    s_add_u32 s45, s46, 3670016
    buffer_load_dwordx4 v18, s[32:35], s45 offen lds
    s_add_u32 m0, s44, 29696
    s_add_u32 s45, s46, 3801088
    buffer_load_dwordx4 v18, s[32:35], s45 offen lds
    s_add_u32 m0, s44, 30720
    s_add_u32 s45, s46, 3932160
    buffer_load_dwordx4 v18, s[32:35], s45 offen lds
    s_add_u32 m0, s44, 31744
    s_add_u32 s45, s46, 4063232
    buffer_load_dwordx4 v18, s[32:35], s45 offen lds
    s_waitcnt vmcnt(16)
    s_barrier
    ds_read_b64_tr_b16 a[0:1], v19 offset:0
    ds_read_b64_tr_b16 a[2:3], v20 offset:0
    ds_read_b64_tr_b16 a[4:5], v19 offset:1024
    ds_read_b64_tr_b16 a[6:7], v20 offset:1024
    ds_read_b64_tr_b16 a[8:9], v19 offset:2048
    ds_read_b64_tr_b16 a[10:11], v20 offset:2048
    ds_read_b64_tr_b16 a[12:13], v19 offset:3072
    ds_read_b64_tr_b16 a[14:15], v20 offset:3072
    ds_read_b64_tr_b16 a[16:17], v19 offset:4096
    ds_read_b64_tr_b16 a[18:19], v20 offset:4096
    ds_read_b64_tr_b16 a[20:21], v19 offset:5120
    ds_read_b64_tr_b16 a[22:23], v20 offset:5120
    ds_read_b64_tr_b16 a[24:25], v19 offset:6144
    ds_read_b64_tr_b16 a[26:27], v20 offset:6144
    ds_read_b64_tr_b16 a[28:29], v19 offset:7168
    ds_read_b64_tr_b16 a[30:31], v20 offset:7168
    ds_read_b64_tr_b16 a[32:33], v19 offset:8192
    ds_read_b64_tr_b16 a[34:35], v20 offset:8192
    ds_read_b64_tr_b16 a[36:37], v19 offset:9216
    ds_read_b64_tr_b16 a[38:39], v20 offset:9216
    ds_read_b64_tr_b16 a[40:41], v19 offset:10240
    ds_read_b64_tr_b16 a[42:43], v20 offset:10240
    ds_read_b64_tr_b16 a[44:45], v19 offset:11264
    ds_read_b64_tr_b16 a[46:47], v20 offset:11264
    ds_read_b64_tr_b16 a[48:49], v19 offset:12288
    ds_read_b64_tr_b16 a[50:51], v20 offset:12288
    ds_read_b64_tr_b16 a[52:53], v19 offset:13312
    ds_read_b64_tr_b16 a[54:55], v20 offset:13312
    ds_read_b64_tr_b16 a[56:57], v19 offset:14336
    ds_read_b64_tr_b16 a[58:59], v20 offset:14336
    ds_read_b64_tr_b16 a[60:61], v19 offset:15360
    ds_read_b64_tr_b16 a[62:63], v20 offset:15360
    s_waitcnt lgkmcnt(0)
    s_barrier
    s_waitcnt vmcnt(0)
    s_load_dwordx2 s[26:27], s[0:1], 104
    v_mov_b32 v8, 192
    s_mov_b32 s9, 800000
    s_waitcnt lgkmcnt(0)
I_w_25:
    global_load_dword v9, v8, s[26:27] sc1
    s_waitcnt vmcnt(0)
    v_cmp_le_u32 vcc, 1, v9
    s_cbranch_vccnz I_d_26
    s_sleep 1
    s_sub_u32 s9, s9, 1
    s_cbranch_scc0 I_w_25
I_d_26:
    v_readfirstlane_b32 s59, v9
    s_nop 3
    s_sub_u32 s59, s59, 1
    s_and_b32 s59, s59, 3
    s_cmp_eq_u32 s58, s59
    s_cbranch_scc1 K_ok_27
    s_lshl_b32 s7, s3, 6
    v_lshrrev_b32 v0, 4, v0
    v_add_u32 v0, s7, v0
    s_waitcnt lgkmcnt(0)
    s_barrier
    s_branch K_true
K_ok_27:
    s_load_dwordx2 s[26:27], s[0:1], 104
    v_mov_b32 v8, 32
    s_mov_b32 s9, 800000
    s_waitcnt lgkmcnt(0)
I_w_28:
    global_load_dword v9, v8, s[26:27] sc1
    s_waitcnt vmcnt(0)
    v_cmp_le_u32 vcc, 128, v9
    s_cbranch_vccnz I_d_29
    s_sleep 4
    s_sub_u32 s9, s9, 1
    s_cbranch_scc0 I_w_28
I_d_29:
    s_lshl_b32 s7, s6, 15
    s_add_u32 s26, s14, s7
    s_addc_u32 s27, s15, 0
    s_add_u32 s28, s26, 4096
    s_addc_u32 s29, s27, 0
    s_add_u32 m0, s48, 131072
    s_nop 0
    global_load_lds_dwordx4 v0, s[26:27] offset:0 sc1
    global_load_lds_dwordx4 v0, s[26:27] offset:1024 sc1
    global_load_lds_dwordx4 v0, s[26:27] offset:2048 sc1
    global_load_lds_dwordx4 v0, s[26:27] offset:3072 sc1
    s_add_u32 m0, s48, 135168
    s_nop 0
    global_load_lds_dwordx4 v0, s[28:29] offset:0 sc1
    global_load_lds_dwordx4 v0, s[28:29] offset:1024 sc1
    global_load_lds_dwordx4 v0, s[28:29] offset:2048 sc1
    global_load_lds_dwordx4 v0, s[28:29] offset:3072 sc1
    s_barrier
    ds_read_b64_tr_b16 a[64:65], v19 offset:16384
    ds_read_b64_tr_b16 a[66:67], v20 offset:16384
    ds_read_b64_tr_b16 a[68:69], v19 offset:17408
    ds_read_b64_tr_b16 a[70:71], v20 offset:17408
    ds_read_b64_tr_b16 a[72:73], v19 offset:18432
    ds_read_b64_tr_b16 a[74:75], v20 offset:18432
    ds_read_b64_tr_b16 a[76:77], v19 offset:19456
    ds_read_b64_tr_b16 a[78:79], v20 offset:19456
    ds_read_b64_tr_b16 a[80:81], v19 offset:20480
    ds_read_b64_tr_b16 a[82:83], v20 offset:20480
    ds_read_b64_tr_b16 a[84:85], v19 offset:21504
    ds_read_b64_tr_b16 a[86:87], v20 offset:21504
    ds_read_b64_tr_b16 a[88:89], v19 offset:22528
    ds_read_b64_tr_b16 a[90:91], v20 offset:22528
    ds_read_b64_tr_b16 a[92:93], v19 offset:23552
    ds_read_b64_tr_b16 a[94:95], v20 offset:23552
    ds_read_b64_tr_b16 a[96:97], v19 offset:24576
    ds_read_b64_tr_b16 a[98:99], v20 offset:24576
    ds_read_b64_tr_b16 a[100:101], v19 offset:25600
    ds_read_b64_tr_b16 a[102:103], v20 offset:25600
    ds_read_b64_tr_b16 a[104:105], v19 offset:26624
    ds_read_b64_tr_b16 a[106:107], v20 offset:26624
    ds_read_b64_tr_b16 a[108:109], v19 offset:27648
    ds_read_b64_tr_b16 a[110:111], v20 offset:27648
    ds_read_b64_tr_b16 a[112:113], v19 offset:28672
    ds_read_b64_tr_b16 a[114:115], v20 offset:28672
    ds_read_b64_tr_b16 a[116:117], v19 offset:29696
    ds_read_b64_tr_b16 a[118:119], v20 offset:29696
    ds_read_b64_tr_b16 a[120:121], v19 offset:30720
    ds_read_b64_tr_b16 a[122:123], v20 offset:30720
    ds_read_b64_tr_b16 a[124:125], v19 offset:31744
    ds_read_b64_tr_b16 a[126:127], v20 offset:31744
    s_waitcnt lgkmcnt(0)
    s_barrier
    v_and_b32 v20, 31, v16
    v_lshrrev_b32 v21, 5, v16
    v_lshlrev_b32 v21, 2, v21
    v_sub_u32 v20, v20, v21
    v_mov_b32 v21, 0xf149f2ca
    v_cmp_gt_i32 vcc, 0, v20
    s_nop 1
    v_cndmask_b32 v24, 0, v21, vcc
    v_cmp_gt_i32 vcc, 1, v20
    s_nop 1
    v_cndmask_b32 v25, 0, v21, vcc
    v_cmp_gt_i32 vcc, 2, v20
    s_nop 1
    v_cndmask_b32 v26, 0, v21, vcc
    v_cmp_gt_i32 vcc, 3, v20
    s_nop 1
    v_cndmask_b32 v27, 0, v21, vcc
    v_add_u32 v22, 4096, v0
    ds_write_b128 v22, v[24:27]
    v_cmp_gt_i32 vcc, 8, v20
    s_nop 1
    v_cndmask_b32 v24, 0, v21, vcc
    v_cmp_gt_i32 vcc, 9, v20
    s_nop 1
    v_cndmask_b32 v25, 0, v21, vcc
    v_cmp_gt_i32 vcc, 10, v20
    s_nop 1
    v_cndmask_b32 v26, 0, v21, vcc
    v_cmp_gt_i32 vcc, 11, v20
    s_nop 1
    v_cndmask_b32 v27, 0, v21, vcc
    v_add_u32 v22, 5120, v0
    ds_write_b128 v22, v[24:27]
    v_cmp_gt_i32 vcc, 16, v20
    s_nop 1
    v_cndmask_b32 v24, 0, v21, vcc
    v_cmp_gt_i32 vcc, 17, v20
    s_nop 1
    v_cndmask_b32 v25, 0, v21, vcc
    v_cmp_gt_i32 vcc, 18, v20
    s_nop 1
    v_cndmask_b32 v26, 0, v21, vcc
    v_cmp_gt_i32 vcc, 19, v20
    s_nop 1
    v_cndmask_b32 v27, 0, v21, vcc
    v_add_u32 v22, 6144, v0
    ds_write_b128 v22, v[24:27]
    v_cmp_gt_i32 vcc, 24, v20
    s_nop 1
    v_cndmask_b32 v24, 0, v21, vcc
    v_cmp_gt_i32 vcc, 25, v20
    s_nop 1
    v_cndmask_b32 v25, 0, v21, vcc
    v_cmp_gt_i32 vcc, 26, v20
    s_nop 1
    v_cndmask_b32 v26, 0, v21, vcc
    v_cmp_gt_i32 vcc, 27, v20
    s_nop 1
    v_cndmask_b32 v27, 0, v21, vcc
    v_add_u32 v22, 7168, v0
    ds_write_b128 v22, v[24:27]
    s_load_dwordx2 s[26:27], s[0:1], 104
    v_mov_b32 v8, 36
    s_mov_b32 s9, 800000
    s_waitcnt lgkmcnt(0)
I_w_30:
    global_load_dword v9, v8, s[26:27] sc1
    s_waitcnt vmcnt(0)
    v_cmp_le_u32 vcc, 1, v9
    s_cbranch_vccnz I_d_31
    s_sleep 4
    s_sub_u32 s9, s9, 1
    s_cbranch_scc0 I_w_30
I_d_31:
    v_readfirstlane_b32 s97, v9
    s_nop 3
    s_lshl_b32 s97, s97, 13
    s_and_b32 s97, s97, 0x2000
    s_xor_b32 s96, s97, 0x2000
    s_add_u32 s18, s18, s97
    s_addc_u32 s19, s19, 0
    s_add_u32 s20, s20, s97
    s_addc_u32 s21, s21, 0
    s_lshl_b32 s7, s4, 2
    s_add_u32 s7, s7, 149767808
    v_mov_b32 v8, s7
    s_mov_b32 s9, 800000
I_w_32:
    global_load_dword v9, v8, s[12:13] sc1
    s_waitcnt vmcnt(0)
    v_cmp_ne_u32 vcc, 0, v9
    s_cbranch_vccnz I_d_33
    s_sleep 2
    s_sub_u32 s9, s9, 1
    s_cbranch_scc0 I_w_32
I_d_33:
    v_readfirstlane_b32 s7, v9
    s_nop 3
    s_lshl_b32 s7, s7, 12
    s_and_b32 s7, s7, 0x2000
    s_add_u32 s16, s16, s7
    s_addc_u32 s17, s17, 0
    s_sub_u32 s5, s6, 6
    s_mov_b32 s11, 8192
W_loop:
    s_waitcnt vmcnt(0) lgkmcnt(0)
    s_barrier
    v_mov_b32 v12, 0
    s_cmp_ge_u32 s6, 64
    s_cbranch_scc1 W_nogemm
    s_lshl_b32 s7, s6, 15
    s_add_u32 s26, s16, s7
    s_addc_u32 s27, s17, 0
    v_add_u32 v8, s11, v1
    ds_read_b128 v[16:19], v7 offset:0
    ds_read_b128 v[20:23], v7 offset:1024
    ds_read_b128 v[24:27], v7 offset:2048
    ds_read_b128 v[28:31], v7 offset:3072
    ds_read_b128 v[32:35], v7 offset:4096
    ds_read_b128 v[36:39], v7 offset:5120
    s_waitcnt lgkmcnt(5)
    v_mfma_f32_32x32x16_bf16 v[64:79], a[128:131], v[16:19], 0
    ds_read_b128 v[40:43], v7 offset:6144
    v_mfma_f32_32x32x16_bf16 v[80:95], v[16:19], v[128:131], 0
    s_waitcnt lgkmcnt(5)
    v_mfma_f32_32x32x16_bf16 v[64:79], a[132:135], v[20:23], v[64:79]
    ds_read_b128 v[44:47], v7 offset:7168
    v_mfma_f32_32x32x16_bf16 v[80:95], v[20:23], v[132:135], v[80:95]
    s_waitcnt lgkmcnt(5)
    v_mfma_f32_32x32x16_bf16 v[64:79], a[136:139], v[24:27], v[64:79]
    ds_read_b128 v[16:19], v7 offset:8192
    v_mfma_f32_32x32x16_bf16 v[80:95], v[24:27], v[136:139], v[80:95]
    s_waitcnt lgkmcnt(5)
    v_mfma_f32_32x32x16_bf16 v[64:79], a[140:143], v[28:31], v[64:79]
    ds_read_b128 v[20:23], v7 offset:9216
    v_mfma_f32_32x32x16_bf16 v[80:95], v[28:31], v[140:143], v[80:95]
    s_waitcnt lgkmcnt(5)
    v_mfma_f32_32x32x16_bf16 v[64:79], a[144:147], v[32:35], v[64:79]
    ds_read_b128 v[24:27], v7 offset:10240
    v_mfma_f32_32x32x16_bf16 v[80:95], v[32:35], v[144:147], v[80:95]
    s_waitcnt lgkmcnt(5)
    v_mfma_f32_32x32x16_bf16 v[64:79], a[148:151], v[36:39], v[64:79]
    ds_read_b128 v[28:31], v7 offset:11264
    v_mfma_f32_32x32x16_bf16 v[80:95], v[36:39], v[148:151], v[80:95]
    s_waitcnt lgkmcnt(5)
    v_mfma_f32_32x32x16_bf16 v[64:79], a[152:155], v[40:43], v[64:79]
    ds_read_b128 v[32:35], v7 offset:12288
    v_mfma_f32_32x32x16_bf16 v[80:95], v[40:43], v[152:155], v[80:95]
    s_waitcnt lgkmcnt(5)
    v_mfma_f32_32x32x16_bf16 v[64:79], a[156:159], v[44:47], v[64:79]
    ds_read_b128 v[36:39], v7 offset:13312
    v_mfma_f32_32x32x16_bf16 v[80:95], v[44:47], v[156:159], v[80:95]
    s_waitcnt lgkmcnt(5)
    v_mfma_f32_32x32x16_bf16 v[64:79], a[160:163], v[16:19], v[64:79]
    ds_read_b128 v[40:43], v7 offset:14336
    v_mfma_f32_32x32x16_bf16 v[80:95], v[16:19], v[160:163], v[80:95]
    s_waitcnt lgkmcnt(5)
    v_mfma_f32_32x32x16_bf16 v[64:79], a[164:167], v[20:23], v[64:79]
    ds_read_b128 v[44:47], v7 offset:15360
    v_mfma_f32_32x32x16_bf16 v[80:95], v[20:23], v[164:167], v[80:95]
    s_waitcnt lgkmcnt(5)
    v_mfma_f32_32x32x16_bf16 v[64:79], a[168:171], v[24:27], v[64:79]
    ds_read_b128 v[16:19], v7 offset:16384
    v_mfma_f32_32x32x16_bf16 v[80:95], v[24:27], v[168:171], v[80:95]
    s_waitcnt lgkmcnt(5)
    v_mfma_f32_32x32x16_bf16 v[64:79], a[172:175], v[28:31], v[64:79]
    ds_read_b128 v[20:23], v7 offset:17408
    v_mfma_f32_32x32x16_bf16 v[80:95], v[28:31], v[172:175], v[80:95]
    s_waitcnt lgkmcnt(5)
    v_mfma_f32_32x32x16_bf16 v[64:79], a[176:179], v[32:35], v[64:79]
    ds_read_b128 v[24:27], v7 offset:18432
    v_mfma_f32_32x32x16_bf16 v[80:95], v[32:35], v[176:179], v[80:95]
    s_waitcnt lgkmcnt(5)
    v_mfma_f32_32x32x16_bf16 v[64:79], a[180:183], v[36:39], v[64:79]
    ds_read_b128 v[28:31], v7 offset:19456
    v_mfma_f32_32x32x16_bf16 v[80:95], v[36:39], v[180:183], v[80:95]
    s_waitcnt lgkmcnt(5)
    v_mfma_f32_32x32x16_bf16 v[64:79], a[184:187], v[40:43], v[64:79]
    ds_read_b128 v[32:35], v7 offset:20480
    v_mfma_f32_32x32x16_bf16 v[80:95], v[40:43], v[184:187], v[80:95]
    s_waitcnt lgkmcnt(5)
    v_mfma_f32_32x32x16_bf16 v[64:79], a[188:191], v[44:47], v[64:79]
    ds_read_b128 v[36:39], v7 offset:21504
    v_mfma_f32_32x32x16_bf16 v[80:95], v[44:47], v[188:191], v[80:95]
    s_waitcnt lgkmcnt(5)
    v_mfma_f32_32x32x16_bf16 v[64:79], a[192:195], v[16:19], v[64:79]
    ds_read_b128 v[40:43], v7 offset:22528
    v_mfma_f32_32x32x16_bf16 v[80:95], v[16:19], v[192:195], v[80:95]
    s_waitcnt lgkmcnt(5)
    v_mfma_f32_32x32x16_bf16 v[64:79], a[196:199], v[20:23], v[64:79]
    ds_read_b128 v[44:47], v7 offset:23552
    v_mfma_f32_32x32x16_bf16 v[80:95], v[20:23], v[196:199], v[80:95]
    s_waitcnt lgkmcnt(5)
    v_mfma_f32_32x32x16_bf16 v[64:79], a[200:203], v[24:27], v[64:79]
    ds_read_b128 v[16:19], v7 offset:24576
    v_mfma_f32_32x32x16_bf16 v[80:95], v[24:27], v[200:203], v[80:95]
    s_waitcnt lgkmcnt(5)
    v_mfma_f32_32x32x16_bf16 v[64:79], a[204:207], v[28:31], v[64:79]
    ds_read_b128 v[20:23], v7 offset:25600
    v_mfma_f32_32x32x16_bf16 v[80:95], v[28:31], v[204:207], v[80:95]
    s_waitcnt lgkmcnt(5)
    v_mfma_f32_32x32x16_bf16 v[64:79], a[208:211], v[32:35], v[64:79]
    ds_read_b128 v[24:27], v7 offset:26624
    v_mfma_f32_32x32x16_bf16 v[80:95], v[32:35], v[208:211], v[80:95]
    s_waitcnt lgkmcnt(5)
    v_mfma_f32_32x32x16_bf16 v[64:79], a[212:215], v[36:39], v[64:79]
    ds_read_b128 v[28:31], v7 offset:27648
    v_mfma_f32_32x32x16_bf16 v[80:95], v[36:39], v[212:215], v[80:95]
    s_waitcnt lgkmcnt(5)
    v_mfma_f32_32x32x16_bf16 v[64:79], a[216:219], v[40:43], v[64:79]
    ds_read_b128 v[32:35], v7 offset:28672
    v_mfma_f32_32x32x16_bf16 v[80:95], v[40:43], v[216:219], v[80:95]
    s_waitcnt lgkmcnt(5)
    v_mfma_f32_32x32x16_bf16 v[64:79], a[220:223], v[44:47], v[64:79]
    ds_read_b128 v[36:39], v7 offset:29696
    v_mfma_f32_32x32x16_bf16 v[80:95], v[44:47], v[220:223], v[80:95]
    s_waitcnt lgkmcnt(5)
    v_mfma_f32_32x32x16_bf16 v[64:79], a[224:227], v[16:19], v[64:79]
    ds_read_b128 v[40:43], v7 offset:30720
    v_mfma_f32_32x32x16_bf16 v[80:95], v[16:19], v[224:227], v[80:95]
    s_waitcnt lgkmcnt(5)
    v_mfma_f32_32x32x16_bf16 v[64:79], a[228:231], v[20:23], v[64:79]
    ds_read_b128 v[44:47], v7 offset:31744
    v_mfma_f32_32x32x16_bf16 v[80:95], v[20:23], v[228:231], v[80:95]
    s_waitcnt lgkmcnt(5)
    v_mfma_f32_32x32x16_bf16 v[64:79], a[232:235], v[24:27], v[64:79]
    ds_read_b128 v[16:19], v7 offset:0
    v_mfma_f32_32x32x16_bf16 v[80:95], v[24:27], v[232:235], v[80:95]
    s_waitcnt lgkmcnt(5)
    v_mfma_f32_32x32x16_bf16 v[64:79], a[236:239], v[28:31], v[64:79]
    ds_read_b128 v[20:23], v7 offset:1024
    v_mfma_f32_32x32x16_bf16 v[80:95], v[28:31], v[236:239], v[80:95]
    s_waitcnt lgkmcnt(5)
    v_mfma_f32_32x32x16_bf16 v[64:79], a[240:243], v[32:35], v[64:79]
    ds_read_b128 v[24:27], v7 offset:2048
    v_mfma_f32_32x32x16_bf16 v[80:95], v[32:35], v[240:243], v[80:95]
    s_waitcnt lgkmcnt(5)
    v_mfma_f32_32x32x16_bf16 v[64:79], a[244:247], v[36:39], v[64:79]
    ds_read_b128 v[28:31], v7 offset:3072
    v_mfma_f32_32x32x16_bf16 v[80:95], v[36:39], v[244:247], v[80:95]
    s_waitcnt lgkmcnt(5)
    v_mfma_f32_32x32x16_bf16 v[64:79], a[248:251], v[40:43], v[64:79]
    ds_read_b128 v[32:35], v7 offset:4096
    v_mfma_f32_32x32x16_bf16 v[80:95], v[40:43], v[248:251], v[80:95]
    s_waitcnt lgkmcnt(5)
    v_mfma_f32_32x32x16_bf16 v[64:79], a[252:255], v[44:47], v[64:79]
    ds_read_b128 v[36:39], v7 offset:5120
    v_mfma_f32_32x32x16_bf16 v[80:95], v[44:47], v[252:255], v[80:95]
    s_waitcnt lgkmcnt(5)
    v_mfma_f32_32x32x16_bf16 v[48:63], a[0:3], v[16:19], 0
    ds_read_b128 v[40:43], v7 offset:6144
    v_cvt_pk_bf16_f32 v112, v64, v65
    v_cvt_pk_bf16_f32 v113, v66, v67
    v_cvt_pk_bf16_f32 v114, v68, v69
    v_cvt_pk_bf16_f32 v115, v70, v71
    s_waitcnt lgkmcnt(5)
    v_mfma_f32_32x32x16_bf16 v[48:63], a[4:7], v[20:23], v[48:63]
    ds_read_b128 v[44:47], v7 offset:7168
    v_cvt_pk_bf16_f32 v116, v72, v73
    v_cvt_pk_bf16_f32 v117, v74, v75
    v_cvt_pk_bf16_f32 v118, v76, v77
    v_cvt_pk_bf16_f32 v119, v78, v79
    s_waitcnt lgkmcnt(5)
    v_mfma_f32_32x32x16_bf16 v[48:63], a[8:11], v[24:27], v[48:63]
    ds_read_b128 v[16:19], v7 offset:8192
    global_store_dwordx4 v2, v[112:115], s[26:27] sc1
    global_store_dwordx4 v2, v[116:119], s[26:27] offset:1024 sc1
    v_cvt_pk_bf16_f32 v104, v80, v81
    v_cvt_pk_bf16_f32 v105, v82, v83
    s_waitcnt lgkmcnt(5)
    v_mfma_f32_32x32x16_bf16 v[48:63], a[12:15], v[28:31], v[48:63]
    ds_read_b128 v[20:23], v7 offset:9216
    v_cvt_pk_bf16_f32 v106, v84, v85
    v_cvt_pk_bf16_f32 v107, v86, v87
    v_cvt_pk_bf16_f32 v108, v88, v89
    v_cvt_pk_bf16_f32 v109, v90, v91
    s_waitcnt lgkmcnt(5)
    v_mfma_f32_32x32x16_bf16 v[48:63], a[16:19], v[32:35], v[48:63]
    ds_read_b128 v[24:27], v7 offset:10240
    v_cvt_pk_bf16_f32 v110, v92, v93
    v_cvt_pk_bf16_f32 v111, v94, v95
    global_store_dwordx4 v3, v[104:107], s[26:27] sc1
    global_store_dwordx4 v3, v[108:111], s[26:27] offset:512 sc1
    s_waitcnt lgkmcnt(5)
    v_mfma_f32_32x32x16_bf16 v[48:63], a[20:23], v[36:39], v[48:63]
    ds_read_b128 v[28:31], v7 offset:11264
    s_waitcnt lgkmcnt(5)
    v_mfma_f32_32x32x16_bf16 v[48:63], a[24:27], v[40:43], v[48:63]
    ds_read_b128 v[32:35], v7 offset:12288
    s_waitcnt lgkmcnt(5)
    v_mfma_f32_32x32x16_bf16 v[48:63], a[28:31], v[44:47], v[48:63]
    ds_read_b128 v[36:39], v7 offset:13312
    s_waitcnt lgkmcnt(5)
    v_mfma_f32_32x32x16_bf16 v[48:63], a[32:35], v[16:19], v[48:63]
    ds_read_b128 v[40:43], v7 offset:14336
    s_waitcnt lgkmcnt(5)
    v_mfma_f32_32x32x16_bf16 v[48:63], a[36:39], v[20:23], v[48:63]
    ds_read_b128 v[44:47], v7 offset:15360
    s_waitcnt lgkmcnt(5)
    v_mfma_f32_32x32x16_bf16 v[48:63], a[40:43], v[24:27], v[48:63]
    ds_read_b128 v[16:19], v7 offset:16384
    s_waitcnt lgkmcnt(5)
    v_mfma_f32_32x32x16_bf16 v[48:63], a[44:47], v[28:31], v[48:63]
    ds_read_b128 v[20:23], v7 offset:17408
    s_waitcnt lgkmcnt(5)
    v_mfma_f32_32x32x16_bf16 v[48:63], a[48:51], v[32:35], v[48:63]
    ds_read_b128 v[24:27], v7 offset:18432
    s_waitcnt lgkmcnt(5)
    v_mfma_f32_32x32x16_bf16 v[48:63], a[52:55], v[36:39], v[48:63]
    ds_read_b128 v[28:31], v7 offset:19456
    s_waitcnt lgkmcnt(5)
    v_mfma_f32_32x32x16_bf16 v[48:63], a[56:59], v[40:43], v[48:63]
    ds_read_b128 v[32:35], v7 offset:20480
    s_waitcnt lgkmcnt(5)
    v_mfma_f32_32x32x16_bf16 v[48:63], a[60:63], v[44:47], v[48:63]
    ds_read_b128 v[36:39], v7 offset:21504
    s_waitcnt lgkmcnt(5)
    v_mfma_f32_32x32x16_bf16 v[48:63], a[64:67], v[16:19], v[48:63]
    ds_read_b128 v[40:43], v7 offset:22528
    s_waitcnt lgkmcnt(5)
    v_mfma_f32_32x32x16_bf16 v[48:63], a[68:71], v[20:23], v[48:63]
    ds_read_b128 v[44:47], v7 offset:23552
    s_waitcnt lgkmcnt(5)
    v_mfma_f32_32x32x16_bf16 v[48:63], a[72:75], v[24:27], v[48:63]
    ds_read_b128 v[16:19], v7 offset:24576
    s_waitcnt lgkmcnt(5)
    v_mfma_f32_32x32x16_bf16 v[48:63], a[76:79], v[28:31], v[48:63]
    ds_read_b128 v[20:23], v7 offset:25600
    s_waitcnt lgkmcnt(5)
    v_mfma_f32_32x32x16_bf16 v[48:63], a[80:83], v[32:35], v[48:63]
    ds_read_b128 v[24:27], v7 offset:26624
    s_waitcnt lgkmcnt(5)
    v_mfma_f32_32x32x16_bf16 v[48:63], a[84:87], v[36:39], v[48:63]
    ds_read_b128 v[28:31], v7 offset:27648
    s_waitcnt lgkmcnt(5)
    v_mfma_f32_32x32x16_bf16 v[48:63], a[88:91], v[40:43], v[48:63]
    ds_read_b128 v[32:35], v7 offset:28672
    s_waitcnt lgkmcnt(5)
    v_mfma_f32_32x32x16_bf16 v[48:63], a[92:95], v[44:47], v[48:63]
    ds_read_b128 v[36:39], v7 offset:29696
    s_waitcnt lgkmcnt(5)
    v_mfma_f32_32x32x16_bf16 v[48:63], a[96:99], v[16:19], v[48:63]
    ds_read_b128 v[40:43], v7 offset:30720
    s_waitcnt lgkmcnt(5)
    v_mfma_f32_32x32x16_bf16 v[48:63], a[100:103], v[20:23], v[48:63]
    ds_read_b128 v[44:47], v7 offset:31744
    s_waitcnt lgkmcnt(5)
    v_mfma_f32_32x32x16_bf16 v[48:63], a[104:107], v[24:27], v[48:63]
    s_waitcnt lgkmcnt(4)
    v_mfma_f32_32x32x16_bf16 v[48:63], a[108:111], v[28:31], v[48:63]
    s_waitcnt lgkmcnt(3)
    v_mfma_f32_32x32x16_bf16 v[48:63], a[112:115], v[32:35], v[48:63]
    s_waitcnt lgkmcnt(2)
    v_mfma_f32_32x32x16_bf16 v[48:63], a[116:119], v[36:39], v[48:63]
    s_waitcnt lgkmcnt(1)
    v_mfma_f32_32x32x16_bf16 v[48:63], a[120:123], v[40:43], v[48:63]
    s_waitcnt lgkmcnt(0)
    v_mfma_f32_32x32x16_bf16 v[48:63], a[124:127], v[44:47], v[48:63]
    ds_write_b128 v8, v[112:115] offset:8192
    ds_write_b128 v8, v[116:119] offset:9216
    ds_write_b128 v8, v[104:107] offset:16384
    ds_write_b128 v8, v[108:111] offset:17408
    s_nop 7
    v_cvt_pk_bf16_f32 v24, v48, v49
    v_cvt_pk_bf16_f32 v25, v50, v51
    v_cvt_pk_bf16_f32 v26, v52, v53
    v_cvt_pk_bf16_f32 v27, v54, v55
    v_cvt_pk_bf16_f32 v28, v56, v57
    v_cvt_pk_bf16_f32 v29, v58, v59
    v_cvt_pk_bf16_f32 v30, v60, v61
    v_cvt_pk_bf16_f32 v31, v62, v63
    ds_write_b128 v8, v[24:27]
    ds_write_b128 v8, v[28:31] offset:1024
    s_waitcnt vmcnt(0) lgkmcnt(0)
    s_barrier
    s_cmp_lg_u32 s3, 0
    s_cbranch_scc1 W_nf_34
    s_lshl_b32 s7, s6, 2
    v_mov_b32 v8, s7
    v_mov_b32 v9, 1
    global_store_dword v8, v9, s[18:19] sc1
W_nf_34:
    v_mov_b32 v8, 0
    global_load_dword v12, v8, s[20:21] sc1
    s_add_u32 s8, s6, 3
    s_cmp_ge_u32 s8, 64
    s_cbranch_scc1 W_nx_35
    s_lshl_b32 s7, s8, 15
    s_add_u32 s26, s14, s7
    s_addc_u32 s27, s15, 0
    s_add_u32 s28, s26, 4096
    s_addc_u32 s29, s27, 0
    s_add_u32 m0, s48, 131072
    s_nop 0
    global_load_lds_dwordx4 v0, s[26:27] offset:0 sc1
    global_load_lds_dwordx4 v0, s[26:27] offset:1024 sc1
    global_load_lds_dwordx4 v0, s[26:27] offset:2048 sc1
    global_load_lds_dwordx4 v0, s[26:27] offset:3072 sc1
    s_add_u32 m0, s48, 135168
    s_nop 0
    global_load_lds_dwordx4 v0, s[28:29] offset:0 sc1
    global_load_lds_dwordx4 v0, s[28:29] offset:1024 sc1
    global_load_lds_dwordx4 v0, s[28:29] offset:2048 sc1
    global_load_lds_dwordx4 v0, s[28:29] offset:3072 sc1
W_nx_35:
W_nogemm:
    s_add_u32 s11, s11, 24576
    s_cmp_eq_u32 s11, 81920
    s_cselect_b32 s11, 8192, s11
    s_cmp_lt_i32 s5, 0
    s_cbranch_scc1 W_noatt
    v_add_u32 v8, s11, v0
    v_add_u32 v9, 4096, v0
    ds_read_b128 v[48:51], v9 offset:0
    ds_read_b128 v[52:55], v9 offset:1024
    ds_read_b128 v[56:59], v9 offset:2048
    ds_read_b128 v[60:63], v9 offset:3072
    ds_read_b128 v[16:19], v8 offset:0
    ds_read_b128 v[20:23], v8 offset:1024
    ds_read_b128 v[24:27], v8 offset:2048
    ds_read_b128 v[28:31], v8 offset:3072
    ds_read_b128 v[32:35], v8 offset:4096
    ds_read_b128 v[36:39], v8 offset:5120
    ds_read_b128 v[40:43], v8 offset:6144
    ds_read_b128 v[44:47], v8 offset:7168
    s_waitcnt lgkmcnt(8)
    ds_read_b128 v[64:67], v8 offset:8192
    ds_read_b128 v[68:71], v8 offset:9216
    ds_read_b128 v[72:75], v8 offset:10240
    ds_read_b128 v[76:79], v8 offset:11264
    ds_read_b128 v[80:83], v8 offset:12288
    ds_read_b128 v[84:87], v8 offset:13312
    ds_read_b128 v[88:91], v8 offset:14336
    ds_read_b128 v[92:95], v8 offset:15360
    s_waitcnt lgkmcnt(7)
    v_mfma_f32_32x32x16_bf16 v[48:63], v[64:67], v[16:19], v[48:63]
    s_waitcnt lgkmcnt(6)
    v_mfma_f32_32x32x16_bf16 v[48:63], v[68:71], v[20:23], v[48:63]
    s_waitcnt lgkmcnt(5)
    v_mfma_f32_32x32x16_bf16 v[48:63], v[72:75], v[24:27], v[48:63]
    s_waitcnt lgkmcnt(4)
    v_mfma_f32_32x32x16_bf16 v[48:63], v[76:79], v[28:31], v[48:63]
    s_waitcnt lgkmcnt(3)
    v_mfma_f32_32x32x16_bf16 v[48:63], v[80:83], v[32:35], v[48:63]
    s_waitcnt lgkmcnt(2)
    v_mfma_f32_32x32x16_bf16 v[48:63], v[84:87], v[36:39], v[48:63]
    s_waitcnt lgkmcnt(1)
    v_mfma_f32_32x32x16_bf16 v[48:63], v[88:91], v[40:43], v[48:63]
    s_waitcnt lgkmcnt(0)
    v_mfma_f32_32x32x16_bf16 v[48:63], v[92:95], v[44:47], v[48:63]
    v_add_u32 v9, s11, v1
    ds_read_b128 v[96:99], v9 offset:16384
    ds_read_b128 v[100:103], v9 offset:17408
    s_nop 8
    v_cvt_pk_bf16_f32 v11, v48, v49
    v_lshlrev_b32 v48, 16, v11
    v_and_b32 v49, 0xffff0000, v11
    v_pk_mul_f32 v[48:49], v[48:49], v[6:7] op_sel_hi:[1,0]
    v_cvt_pk_bf16_f32 v11, v48, v49
    v_lshlrev_b32 v48, 16, v11
    v_and_b32 v49, 0xffff0000, v11
    v_cvt_pk_bf16_f32 v11, v50, v51
    v_lshlrev_b32 v50, 16, v11
    v_and_b32 v51, 0xffff0000, v11
    v_pk_mul_f32 v[50:51], v[50:51], v[6:7] op_sel_hi:[1,0]
    v_cvt_pk_bf16_f32 v11, v50, v51
    v_lshlrev_b32 v50, 16, v11
    v_and_b32 v51, 0xffff0000, v11
    v_cvt_pk_bf16_f32 v11, v52, v53
    v_lshlrev_b32 v52, 16, v11
    v_and_b32 v53, 0xffff0000, v11
    v_pk_mul_f32 v[52:53], v[52:53], v[6:7] op_sel_hi:[1,0]
    v_cvt_pk_bf16_f32 v11, v52, v53
    v_lshlrev_b32 v52, 16, v11
    v_and_b32 v53, 0xffff0000, v11
    v_cvt_pk_bf16_f32 v11, v54, v55
    v_lshlrev_b32 v54, 16, v11
    v_and_b32 v55, 0xffff0000, v11
    v_pk_mul_f32 v[54:55], v[54:55], v[6:7] op_sel_hi:[1,0]
    v_cvt_pk_bf16_f32 v11, v54, v55
    v_lshlrev_b32 v54, 16, v11
    v_and_b32 v55, 0xffff0000, v11
    v_cvt_pk_bf16_f32 v11, v56, v57
    v_lshlrev_b32 v56, 16, v11
    v_and_b32 v57, 0xffff0000, v11
    v_pk_mul_f32 v[56:57], v[56:57], v[6:7] op_sel_hi:[1,0]
    v_cvt_pk_bf16_f32 v11, v56, v57
    v_lshlrev_b32 v56, 16, v11
    v_and_b32 v57, 0xffff0000, v11
    v_cvt_pk_bf16_f32 v11, v58, v59
    v_lshlrev_b32 v58, 16, v11
    v_and_b32 v59, 0xffff0000, v11
    v_pk_mul_f32 v[58:59], v[58:59], v[6:7] op_sel_hi:[1,0]
    v_cvt_pk_bf16_f32 v11, v58, v59
    v_lshlrev_b32 v58, 16, v11
    v_and_b32 v59, 0xffff0000, v11
    v_cvt_pk_bf16_f32 v11, v60, v61
    v_lshlrev_b32 v60, 16, v11
    v_and_b32 v61, 0xffff0000, v11
    v_pk_mul_f32 v[60:61], v[60:61], v[6:7] op_sel_hi:[1,0]
    v_cvt_pk_bf16_f32 v11, v60, v61
    v_lshlrev_b32 v60, 16, v11
    v_and_b32 v61, 0xffff0000, v11
    v_cvt_pk_bf16_f32 v11, v62, v63
    v_lshlrev_b32 v62, 16, v11
    v_and_b32 v63, 0xffff0000, v11
    v_pk_mul_f32 v[62:63], v[62:63], v[6:7] op_sel_hi:[1,0]
    v_cvt_pk_bf16_f32 v11, v62, v63
    v_lshlrev_b32 v62, 16, v11
    v_and_b32 v63, 0xffff0000, v11
    v_max3_f32 v10, v48, v49, v50
    v_max3_f32 v10, v10, v51, v52
    v_max3_f32 v10, v10, v53, v54
    v_max3_f32 v10, v10, v55, v56
    v_max3_f32 v10, v10, v57, v58
    v_max3_f32 v10, v10, v59, v60
    v_max3_f32 v10, v10, v61, v62
    v_max_f32 v10, v10, v63
    s_mov_b32 s9, 800000
    v_mov_b32 v8, 0
W_pw_36:
    v_cmp_lt_u32 vcc, s5, v12
    s_cbranch_vccnz W_pd_37
    s_sleep 1
    global_load_dword v12, v8, s[20:21] sc1
    s_sub_u32 s9, s9, 1
    s_waitcnt vmcnt(0)
    s_cbranch_scc0 W_pw_36
W_pd_37:
    s_lshl_b32 s7, s5, 12
    s_xor_b32 s7, s7, s97
    s_and_b32 s7, s7, 0x2000
    s_lshl_b32 s52, s5, 20
    s_add_u32 s52, s52, s7
    s_add_u32 s28, s24, s52
    s_addc_u32 s29, s25, 0
    s_lshl_b32 s7, s5, 15
    s_add_u32 s26, s16, s7
    s_addc_u32 s27, s17, 0
    s_lshr_b32 s7, s48, 3
    s_add_u32 m0, s7, 0
    v_add_u32 v8, s7, v0
    global_load_lds_dwordx4 v8, s[26:27] sc1
    global_load_dword v12, v5, s[26:27] sc1
    global_load_dword v13, v5, s[26:27] offset:256 sc1
    v_add_u32 v9, 0, v4
    s_waitcnt vmcnt(0)
    v_mov_b64 v[14:15], 0
    s_barrier
    ds_read_b64_tr_b16 v[112:113], v9 offset:0
    ds_read_b64_tr_b16 v[114:115], v9 offset:32
    ds_read_b64_tr_b16 v[116:117], v9 offset:1024
    ds_read_b64_tr_b16 v[118:119], v9 offset:1056
    ds_read_b64_tr_b16 v[120:121], v9 offset:2048
    ds_read_b64_tr_b16 v[122:123], v9 offset:2080
    ds_read_b64_tr_b16 v[124:125], v9 offset:3072
    ds_read_b64_tr_b16 v[126:127], v9 offset:3104
    s_waitcnt lgkmcnt(6)
    v_mfma_f32_32x32x16_bf16 v[64:79], v[112:115], v[16:19], 0
    v_mfma_f32_32x32x16_bf16 v[80:95], v[112:115], v[20:23], 0
    s_waitcnt lgkmcnt(4)
    v_mfma_f32_32x32x16_bf16 v[64:79], v[116:119], v[24:27], v[64:79]
    v_mfma_f32_32x32x16_bf16 v[80:95], v[116:119], v[28:31], v[80:95]
    s_waitcnt lgkmcnt(2)
    v_mfma_f32_32x32x16_bf16 v[64:79], v[120:123], v[32:35], v[64:79]
    v_mfma_f32_32x32x16_bf16 v[80:95], v[120:123], v[36:39], v[80:95]
    s_waitcnt lgkmcnt(0)
    v_mfma_f32_32x32x16_bf16 v[64:79], v[124:127], v[40:43], v[64:79]
    v_mfma_f32_32x32x16_bf16 v[80:95], v[124:127], v[44:47], v[80:95]
    s_nop 11
    v_add_f32 v112, v64, v82
    v_add_f32 v113, v65, v83
    v_add_f32 v114, v68, v86
    v_add_f32 v115, v69, v87
    v_cvt_pk_bf16_f32 v11, v112, v113
    v_lshlrev_b32 v112, 16, v11
    v_and_b32 v113, 0xffff0000, v11
    v_pk_mul_f32 v[112:113], v[112:113], v[6:7] op_sel_hi:[1,0]
    v_cvt_pk_bf16_f32 v11, v112, v113
    v_lshlrev_b32 v112, 16, v11
    v_and_b32 v113, 0xffff0000, v11
    v_cvt_pk_bf16_f32 v11, v114, v115
    v_lshlrev_b32 v114, 16, v11
    v_and_b32 v115, 0xffff0000, v11
    v_pk_mul_f32 v[114:115], v[114:115], v[6:7] op_sel_hi:[1,0]
    v_cvt_pk_bf16_f32 v11, v114, v115
    v_lshlrev_b32 v114, 16, v11
    v_and_b32 v115, 0xffff0000, v11
    v_max3_f32 v10, v10, v112, v113
    v_max3_f32 v10, v10, v114, v115
    v_mov_b32 v11, v10
    s_nop 1
    v_permlane32_swap_b32 v10, v11
    v_max_f32 v10, v10, v11
    v_mul_f32 v10, s10, v10
    v_fma_f32 v48, v48, s10, -v10
    v_fma_f32 v49, v49, s10, -v10
    v_fma_f32 v50, v50, s10, -v10
    v_fma_f32 v51, v51, s10, -v10
    v_fma_f32 v52, v52, s10, -v10
    v_fma_f32 v53, v53, s10, -v10
    v_fma_f32 v54, v54, s10, -v10
    v_fma_f32 v55, v55, s10, -v10
    v_fma_f32 v56, v56, s10, -v10
    v_fma_f32 v57, v57, s10, -v10
    v_fma_f32 v58, v58, s10, -v10
    v_fma_f32 v59, v59, s10, -v10
    v_fma_f32 v60, v60, s10, -v10
    v_fma_f32 v61, v61, s10, -v10
    v_fma_f32 v62, v62, s10, -v10
    v_fma_f32 v63, v63, s10, -v10
    v_fma_f32 v112, v112, s10, -v10
    v_fma_f32 v113, v113, s10, -v10
    v_fma_f32 v114, v114, s10, -v10
    v_fma_f32 v115, v115, s10, -v10
    v_exp_f32 v48, v48
    v_exp_f32 v49, v49
    v_exp_f32 v50, v50
    v_exp_f32 v51, v51
    v_exp_f32 v52, v52
    v_exp_f32 v53, v53
    v_exp_f32 v54, v54
    v_exp_f32 v55, v55
    v_exp_f32 v56, v56
    v_exp_f32 v57, v57
    v_exp_f32 v58, v58
    v_exp_f32 v59, v59
    v_exp_f32 v60, v60
    v_exp_f32 v61, v61
    v_exp_f32 v62, v62
    v_exp_f32 v63, v63
    v_exp_f32 v112, v112
    v_exp_f32 v113, v113
    v_exp_f32 v114, v114
    v_exp_f32 v115, v115
    v_cvt_pk_bf16_f32 v16, v48, v49
    v_cvt_pk_bf16_f32 v17, v50, v51
    v_cvt_pk_bf16_f32 v18, v52, v53
    v_cvt_pk_bf16_f32 v19, v54, v55
    v_cvt_pk_bf16_f32 v20, v56, v57
    v_cvt_pk_bf16_f32 v21, v58, v59
    v_cvt_pk_bf16_f32 v22, v60, v61
    v_cvt_pk_bf16_f32 v23, v62, v63
    v_cvt_pk_bf16_f32 v24, v112, v113
    v_cvt_pk_bf16_f32 v25, v114, v115
    v_mov_b64 v[26:27], 0
    v_mfma_f32_32x32x16_bf16 v[64:79], v[96:99], v[16:19], 0
    v_add_f32 v10, v48, v49
    v_add_f32 v11, v50, v51
    v_mfma_f32_32x32x16_bf16 v[64:79], v[100:103], v[20:23], v[64:79]
    v_add_f32 v10, v10, v52
    v_add_f32 v11, v11, v53
    v_add_f32 v10, v10, v54
    v_add_f32 v11, v11, v55
    v_add_f32 v10, v10, v56
    v_add_f32 v11, v11, v57
    v_add_f32 v10, v10, v58
    v_add_f32 v11, v11, v59
    v_mfma_f32_32x32x16_bf16 v[64:79], v[12:15], v[24:27], v[64:79]
    v_add_f32 v10, v10, v60
    v_add_f32 v11, v11, v61
    v_add_f32 v10, v10, v62
    v_add_f32 v11, v11, v63
    v_add_f32 v10, v10, v112
    v_add_f32 v11, v11, v113
    v_add_f32 v10, v10, v114
    v_add_f32 v11, v11, v115
    v_add_f32 v10, v10, v11
    v_mov_b32 v11, v10
    s_nop 1
    v_permlane32_swap_b32 v10, v11
    v_add_f32 v10, v10, v11
    v_rcp_f32 v10, v10
    s_nop 0
    v_mul_f32 v64, v64, v10
    v_mul_f32 v65, v65, v10
    v_mul_f32 v66, v66, v10
    v_mul_f32 v67, v67, v10
    v_mul_f32 v68, v68, v10
    v_mul_f32 v69, v69, v10
    v_mul_f32 v70, v70, v10
    v_mul_f32 v71, v71, v10
    v_mul_f32 v72, v72, v10
    v_mul_f32 v73, v73, v10
    v_mul_f32 v74, v74, v10
    v_mul_f32 v75, v75, v10
    v_mul_f32 v76, v76, v10
    v_mul_f32 v77, v77, v10
    v_mul_f32 v78, v78, v10
    v_mul_f32 v79, v79, v10
    v_cvt_pk_bf16_f32 v16, v64, v65
    v_cvt_pk_bf16_f32 v17, v66, v67
    v_cvt_pk_bf16_f32 v18, v68, v69
    v_cvt_pk_bf16_f32 v19, v70, v71
    v_cvt_pk_bf16_f32 v20, v72, v73
    v_cvt_pk_bf16_f32 v21, v74, v75
    v_cvt_pk_bf16_f32 v22, v76, v77
    v_cvt_pk_bf16_f32 v23, v78, v79
    global_store_dwordx4 v1, v[16:19], s[28:29] sc1
    global_store_dwordx4 v1, v[20:23], s[28:29] offset:1024 sc1
    v_mov_b32 v8, s52
    v_mov_b32 v9, 1
    s_waitcnt vmcnt(0)
    s_barrier
    s_cmp_lg_u32 s3, 0
    s_cbranch_scc1 W_ns_38
    global_store_dword v8, v9, s[50:51] sc1
W_ns_38:
W_noatt:
    s_add_u32 s5, s5, 3
    s_add_u32 s6, s6, 3
    s_cmp_lt_i32 s5, 64
    s_cbranch_scc1 W_loop
    s_lshl_b32 s7, s3, 6
    v_lshrrev_b32 v0, 4, v0
    v_add_u32 v0, s7, v0
    s_waitcnt vmcnt(0) lgkmcnt(0)
    s_barrier
    s_branch K_late7
K_down:
    s_sub_u32 s60, s3, 96
    s_load_dwordx2 s[10:11], s[0:1], 0
    s_load_dwordx2 s[12:13], s[0:1], 112
    s_load_dwordx2 s[14:15], s[0:1], 104
    s_load_dwordx8 s[20:27], s[0:1], 16
    v_bfe_u32 v2, v0, 6, 2
    v_lshlrev_b32 v3, 12, v2
    v_bfe_u32 v2, v0, 0, 2
    v_lshl_add_u32 v3, v2, 10, v3
    v_bfe_u32 v2, v0, 2, 4
    v_lshl_add_u32 v3, v2, 4, v3
    v_bfe_u32 v2, v0, 2, 4
    v_lshlrev_b32 v4, 9, v2
    v_bfe_u32 v2, v0, 6, 2
    v_lshl_add_u32 v4, v2, 6, v4
    v_bfe_u32 v2, v0, 0, 2
    v_lshl_add_u32 v4, v2, 4, v4
    s_lshl_b32 s8, s60, 14
    s_lshr_b32 s9, s60, 1
    s_lshl_b32 s9, s9, 15
    s_and_b32 s7, s60, 1
    s_lshl_b32 s7, s7, 8
    s_add_u32 s9, s9, s7
    s_waitcnt lgkmcnt(0)
    s_add_u32 s10, s10, s8
    s_addc_u32 s11, s11, 0
    global_load_dwordx4 v[16:19], v3, s[10:11] offset:0
    global_load_dwordx4 v[20:23], v3, s[10:11] offset:256
    global_load_dwordx4 v[24:27], v3, s[10:11] offset:512
    global_load_dwordx4 v[28:31], v3, s[10:11] offset:768
    v_lshlrev_b32 v5, 3, v0
    v_mov_b64 v[8:9], 0
    s_lshr_b32 s7, s60, 1
    s_lshl_b32 s7, s7, 20
    s_and_b32 s18, s60, 1
    s_lshl_b32 s18, s18, 13
    s_add_u32 s7, s7, s18
    s_add_u32 s7, s7, 84754432
    s_add_u32 s16, s12, s7
    s_addc_u32 s17, s13, 0
    global_store_dwordx2 v5, v[8:9], s[16:17] sc1
    s_lshl_b32 s7, s60, 8
    s_add_u32 s7, s7, 149848064
    s_add_u32 s16, s12, s7
    s_addc_u32 s17, s13, 0
    v_and_b32 v5, 248, v5
    global_store_dwordx2 v5, v[8:9], s[16:17] sc1
    s_add_u32 s12, s12, s9
    s_addc_u32 s13, s13, 0
    s_waitcnt vmcnt(2)
    v_lshlrev_b32 v32, 16, v16
    v_and_b32 v33, 0xffff0000, v16
    v_lshlrev_b32 v34, 16, v17
    v_and_b32 v35, 0xffff0000, v17
    v_lshlrev_b32 v36, 16, v18
    v_and_b32 v37, 0xffff0000, v18
    v_lshlrev_b32 v38, 16, v19
    v_and_b32 v39, 0xffff0000, v19
    v_lshlrev_b32 v40, 16, v20
    v_and_b32 v41, 0xffff0000, v20
    v_lshlrev_b32 v42, 16, v21
    v_and_b32 v43, 0xffff0000, v21
    v_lshlrev_b32 v44, 16, v22
    v_and_b32 v45, 0xffff0000, v22
    v_lshlrev_b32 v46, 16, v23
    v_and_b32 v47, 0xffff0000, v23
    v_lshlrev_b32 v48, 16, v24
    v_and_b32 v49, 0xffff0000, v24
    v_lshlrev_b32 v50, 16, v25
    v_and_b32 v51, 0xffff0000, v25
    v_lshlrev_b32 v52, 16, v26
    v_and_b32 v53, 0xffff0000, v26
    v_lshlrev_b32 v54, 16, v27
    v_and_b32 v55, 0xffff0000, v27
    v_lshlrev_b32 v56, 16, v28
    v_and_b32 v57, 0xffff0000, v28
    v_lshlrev_b32 v58, 16, v29
    v_and_b32 v59, 0xffff0000, v29
    v_lshlrev_b32 v60, 16, v30
    v_and_b32 v61, 0xffff0000, v30
    v_lshlrev_b32 v62, 16, v31
    v_and_b32 v63, 0xffff0000, v31
    v_add_f32 v8, v32, v33
    v_add_f32 v9, v34, v35
    v_add_f32 v8, v8, v36
    v_add_f32 v9, v9, v37
    v_add_f32 v8, v8, v38
    v_add_f32 v9, v9, v39
    v_add_f32 v8, v8, v40
    v_add_f32 v9, v9, v41
    v_add_f32 v8, v8, v42
    v_add_f32 v9, v9, v43
    v_add_f32 v8, v8, v44
    v_add_f32 v9, v9, v45
    v_add_f32 v8, v8, v46
    v_add_f32 v9, v9, v47
    v_add_f32 v8, v8, v48
    v_add_f32 v9, v9, v49
    v_add_f32 v8, v8, v50
    v_add_f32 v9, v9, v51
    v_add_f32 v8, v8, v52
    v_add_f32 v9, v9, v53
    v_add_f32 v8, v8, v54
    v_add_f32 v9, v9, v55
    v_add_f32 v8, v8, v56
    v_add_f32 v9, v9, v57
    v_add_f32 v8, v8, v58
    v_add_f32 v9, v9, v59
    v_add_f32 v8, v8, v60
    v_add_f32 v9, v9, v61
    v_add_f32 v8, v8, v62
    v_add_f32 v9, v9, v63
    v_add_f32 v8, v8, v9
    s_nop 1
    v_add_f32_dpp v8, v8, v8 row_ror:4 row_mask:0xf bank_mask:0xf
    s_nop 1
    v_add_f32_dpp v8, v8, v8 row_ror:8 row_mask:0xf bank_mask:0xf
    v_mov_b32 v9, v8
    s_nop 1
    v_permlane16_swap_b32 v8, v9
    v_add_f32 v8, v8, v9
    v_mov_b32 v9, v8
    s_nop 1
    v_permlane32_swap_b32 v8, v9
    v_add_f32 v8, v8, v9
    v_mul_f32 v10, 0x3b000000, v8
    v_mov_b32 v11, v10
    v_cvt_pk_bf16_f32 v11, v11, v11
    v_and_b32 v11, 0xffff0000, v11
    v_mov_b32 v8, 0
    v_mov_b32 v9, 0
    v_sub_f32 v12, v32, v10
    v_fmac_f32 v8, v12, v12
    v_sub_f32 v13, v33, v10
    v_fmac_f32 v9, v13, v13
    v_sub_f32 v12, v34, v10
    v_fmac_f32 v8, v12, v12
    v_sub_f32 v13, v35, v10
    v_fmac_f32 v9, v13, v13
    v_sub_f32 v12, v36, v10
    v_fmac_f32 v8, v12, v12
    v_sub_f32 v13, v37, v10
    v_fmac_f32 v9, v13, v13
    v_sub_f32 v12, v38, v10
    v_fmac_f32 v8, v12, v12
    v_sub_f32 v13, v39, v10
    v_fmac_f32 v9, v13, v13
    v_sub_f32 v12, v40, v10
    v_fmac_f32 v8, v12, v12
    v_sub_f32 v13, v41, v10
    v_fmac_f32 v9, v13, v13
    v_sub_f32 v12, v42, v10
    v_fmac_f32 v8, v12, v12
    v_sub_f32 v13, v43, v10
    v_fmac_f32 v9, v13, v13
    v_sub_f32 v12, v44, v10
    v_fmac_f32 v8, v12, v12
    v_sub_f32 v13, v45, v10
    v_fmac_f32 v9, v13, v13
    v_sub_f32 v12, v46, v10
    v_fmac_f32 v8, v12, v12
    v_sub_f32 v13, v47, v10
    v_fmac_f32 v9, v13, v13
    v_sub_f32 v12, v48, v10
    v_fmac_f32 v8, v12, v12
    v_sub_f32 v13, v49, v10
    v_fmac_f32 v9, v13, v13
    v_sub_f32 v12, v50, v10
    v_fmac_f32 v8, v12, v12
    v_sub_f32 v13, v51, v10
    v_fmac_f32 v9, v13, v13
    v_sub_f32 v12, v52, v10
    v_fmac_f32 v8, v12, v12
    v_sub_f32 v13, v53, v10
    v_fmac_f32 v9, v13, v13
    v_sub_f32 v12, v54, v10
    v_fmac_f32 v8, v12, v12
    v_sub_f32 v13, v55, v10
    v_fmac_f32 v9, v13, v13
    v_sub_f32 v12, v56, v10
    v_fmac_f32 v8, v12, v12
    v_sub_f32 v13, v57, v10
    v_fmac_f32 v9, v13, v13
    v_sub_f32 v12, v58, v10
    v_fmac_f32 v8, v12, v12
    v_sub_f32 v13, v59, v10
    v_fmac_f32 v9, v13, v13
    v_sub_f32 v12, v60, v10
    v_fmac_f32 v8, v12, v12
    v_sub_f32 v13, v61, v10
    v_fmac_f32 v9, v13, v13
    v_sub_f32 v12, v62, v10
    v_fmac_f32 v8, v12, v12
    v_sub_f32 v13, v63, v10
    v_fmac_f32 v9, v13, v13
    v_add_f32 v8, v8, v9
    s_nop 1
    v_add_f32_dpp v8, v8, v8 row_ror:4 row_mask:0xf bank_mask:0xf
    s_nop 1
    v_add_f32_dpp v8, v8, v8 row_ror:8 row_mask:0xf bank_mask:0xf
    v_mov_b32 v9, v8
    s_nop 1
    v_permlane16_swap_b32 v8, v9
    v_add_f32 v8, v8, v9
    v_mov_b32 v9, v8
    s_nop 1
    v_permlane32_swap_b32 v8, v9
    v_add_f32 v8, v8, v9
    v_mul_f32 v8, 0x3b000000, v8
    v_cvt_pk_bf16_f32 v8, v8, v8
    v_and_b32 v8, 0xffff0000, v8
    v_add_f32 v8, 0x3727c5ac, v8
    v_cvt_pk_bf16_f32 v8, v8, v8
    v_and_b32 v8, 0xffff0000, v8
    v_sqrt_f32 v8, v8
    s_nop 0
    v_cvt_pk_bf16_f32 v8, v8, v8
    v_and_b32 v8, 0xffff0000, v8
    v_rcp_f32 v8, v8
    v_sub_f32 v32, v32, v11
    v_sub_f32 v33, v33, v11
    v_cvt_pk_bf16_f32 v12, v32, v33
    v_lshlrev_b32 v32, 16, v12
    v_and_b32 v33, 0xffff0000, v12
    v_mul_f32 v32, v32, v8
    v_mul_f32 v33, v33, v8
    v_cvt_pk_bf16_f32 v16, v32, v33
    v_sub_f32 v34, v34, v11
    v_sub_f32 v35, v35, v11
    v_cvt_pk_bf16_f32 v12, v34, v35
    v_lshlrev_b32 v34, 16, v12
    v_and_b32 v35, 0xffff0000, v12
    v_mul_f32 v34, v34, v8
    v_mul_f32 v35, v35, v8
    v_cvt_pk_bf16_f32 v17, v34, v35
    v_sub_f32 v36, v36, v11
    v_sub_f32 v37, v37, v11
    v_cvt_pk_bf16_f32 v12, v36, v37
    v_lshlrev_b32 v36, 16, v12
    v_and_b32 v37, 0xffff0000, v12
    v_mul_f32 v36, v36, v8
    v_mul_f32 v37, v37, v8
    v_cvt_pk_bf16_f32 v18, v36, v37
    v_sub_f32 v38, v38, v11
    v_sub_f32 v39, v39, v11
    v_cvt_pk_bf16_f32 v12, v38, v39
    v_lshlrev_b32 v38, 16, v12
    v_and_b32 v39, 0xffff0000, v12
    v_mul_f32 v38, v38, v8
    v_mul_f32 v39, v39, v8
    v_cvt_pk_bf16_f32 v19, v38, v39
    v_sub_f32 v40, v40, v11
    v_sub_f32 v41, v41, v11
    v_cvt_pk_bf16_f32 v12, v40, v41
    v_lshlrev_b32 v40, 16, v12
    v_and_b32 v41, 0xffff0000, v12
    v_mul_f32 v40, v40, v8
    v_mul_f32 v41, v41, v8
    v_cvt_pk_bf16_f32 v20, v40, v41
    v_sub_f32 v42, v42, v11
    v_sub_f32 v43, v43, v11
    v_cvt_pk_bf16_f32 v12, v42, v43
    v_lshlrev_b32 v42, 16, v12
    v_and_b32 v43, 0xffff0000, v12
    v_mul_f32 v42, v42, v8
    v_mul_f32 v43, v43, v8
    v_cvt_pk_bf16_f32 v21, v42, v43
    v_sub_f32 v44, v44, v11
    v_sub_f32 v45, v45, v11
    v_cvt_pk_bf16_f32 v12, v44, v45
    v_lshlrev_b32 v44, 16, v12
    v_and_b32 v45, 0xffff0000, v12
    v_mul_f32 v44, v44, v8
    v_mul_f32 v45, v45, v8
    v_cvt_pk_bf16_f32 v22, v44, v45
    v_sub_f32 v46, v46, v11
    v_sub_f32 v47, v47, v11
    v_cvt_pk_bf16_f32 v12, v46, v47
    v_lshlrev_b32 v46, 16, v12
    v_and_b32 v47, 0xffff0000, v12
    v_mul_f32 v46, v46, v8
    v_mul_f32 v47, v47, v8
    v_cvt_pk_bf16_f32 v23, v46, v47
    v_sub_f32 v48, v48, v11
    v_sub_f32 v49, v49, v11
    v_cvt_pk_bf16_f32 v12, v48, v49
    v_lshlrev_b32 v48, 16, v12
    v_and_b32 v49, 0xffff0000, v12
    v_mul_f32 v48, v48, v8
    v_mul_f32 v49, v49, v8
    v_cvt_pk_bf16_f32 v24, v48, v49
    v_sub_f32 v50, v50, v11
    v_sub_f32 v51, v51, v11
    v_cvt_pk_bf16_f32 v12, v50, v51
    v_lshlrev_b32 v50, 16, v12
    v_and_b32 v51, 0xffff0000, v12
    v_mul_f32 v50, v50, v8
    v_mul_f32 v51, v51, v8
    v_cvt_pk_bf16_f32 v25, v50, v51
    v_sub_f32 v52, v52, v11
    v_sub_f32 v53, v53, v11
    v_cvt_pk_bf16_f32 v12, v52, v53
    v_lshlrev_b32 v52, 16, v12
    v_and_b32 v53, 0xffff0000, v12
    v_mul_f32 v52, v52, v8
    v_mul_f32 v53, v53, v8
    v_cvt_pk_bf16_f32 v26, v52, v53
    v_sub_f32 v54, v54, v11
    v_sub_f32 v55, v55, v11
    v_cvt_pk_bf16_f32 v12, v54, v55
    v_lshlrev_b32 v54, 16, v12
    v_and_b32 v55, 0xffff0000, v12
    v_mul_f32 v54, v54, v8
    v_mul_f32 v55, v55, v8
    v_cvt_pk_bf16_f32 v27, v54, v55
    v_sub_f32 v56, v56, v11
    v_sub_f32 v57, v57, v11
    v_cvt_pk_bf16_f32 v12, v56, v57
    v_lshlrev_b32 v56, 16, v12
    v_and_b32 v57, 0xffff0000, v12
    v_mul_f32 v56, v56, v8
    v_mul_f32 v57, v57, v8
    v_cvt_pk_bf16_f32 v28, v56, v57
    v_sub_f32 v58, v58, v11
    v_sub_f32 v59, v59, v11
    v_cvt_pk_bf16_f32 v12, v58, v59
    v_lshlrev_b32 v58, 16, v12
    v_and_b32 v59, 0xffff0000, v12
    v_mul_f32 v58, v58, v8
    v_mul_f32 v59, v59, v8
    v_cvt_pk_bf16_f32 v29, v58, v59
    v_sub_f32 v60, v60, v11
    v_sub_f32 v61, v61, v11
    v_cvt_pk_bf16_f32 v12, v60, v61
    v_lshlrev_b32 v60, 16, v12
    v_and_b32 v61, 0xffff0000, v12
    v_mul_f32 v60, v60, v8
    v_mul_f32 v61, v61, v8
    v_cvt_pk_bf16_f32 v30, v60, v61
    v_sub_f32 v62, v62, v11
    v_sub_f32 v63, v63, v11
    v_cvt_pk_bf16_f32 v12, v62, v63
    v_lshlrev_b32 v62, 16, v12
    v_and_b32 v63, 0xffff0000, v12
    v_mul_f32 v62, v62, v8
    v_mul_f32 v63, v63, v8
    v_cvt_pk_bf16_f32 v31, v62, v63
    global_store_dwordx4 v4, v[16:19], s[12:13] sc1
    s_add_u32 s12, s12, 8192
    s_addc_u32 s13, s13, 0
    global_store_dwordx4 v4, v[20:23], s[12:13] sc1
    s_add_u32 s12, s12, 8192
    s_addc_u32 s13, s13, 0
    global_store_dwordx4 v4, v[24:27], s[12:13] sc1
    s_add_u32 s12, s12, 8192
    s_addc_u32 s13, s13, 0
    global_store_dwordx4 v4, v[28:31], s[12:13] sc1
    s_waitcnt vmcnt(0)
    s_barrier
    v_cmp_eq_u32 vcc, 0, v0
    v_mov_b32 v8, 32
    v_mov_b32 v9, 1
    s_and_saveexec_b64 s[16:17], vcc
    s_cbranch_execz LN1_ns
    global_atomic_add v8, v9, s[14:15] sc1
LN1_ns:
    s_mov_b64 exec, -1
    s_sub_u32 s4, s60, 32
    s_cmp_ge_u32 s4, 66
    s_cbranch_scc1 CAL_nb
    v_cmp_gt_u32 vcc, 64, v0
    s_cbranch_vccz CAL_skip
    s_load_dwordx2 s[26:27], s[0:1], 104
    s_load_dwordx2 s[10:11], s[0:1], 112
    s_lshr_b32 s41, s4, 1
    s_and_b32 s40, s4, 1
    s_lshl_b32 s6, s41, 21
    s_add_u32 s6, s6, 4194304
    s_lshl_b32 s7, s41, 2
    s_add_u32 s7, s7, 149767808
    s_xor_b32 s42, s40, 0
    s_add_u32 s42, s42, 1
    s_sub_u32 s37, 3, s42
    s_waitcnt lgkmcnt(0)
    s_cmp_eq_u32 s41, 32
    s_cselect_b32 s6, 149880832, s6
    s_cselect_b32 s7, 36, s7
    s_cselect_b32 s42, s37, s42
    s_cselect_b64 s[26:27], s[26:27], s[10:11]
    s_lshl_b32 s40, s40, 13
    s_add_u32 s6, s6, s40
    v_mov_b32 v8, s6
    v_mov_b32 v9, s7
    v_mov_b32 v12, s42
    v_mov_b32 v13, 0
    global_store_dword v8, v8, s[10:11] sc1
    s_load_dwordx2 s[14:15], s[0:1], 104
    v_mov_b32 v10, 32
    s_mov_b32 s8, 800000
    s_waitcnt lgkmcnt(0)
I_w_39:
    global_load_dword v11, v10, s[14:15] sc1
    s_waitcnt vmcnt(0)
    v_cmp_le_u32 vcc, 128, v11
    s_cbranch_vccnz I_d_40
    s_sleep 1
    s_sub_u32 s8, s8, 1
    s_cbranch_scc0 I_w_39
I_d_40:
    global_store_dword v8, v8, s[10:11] sc1
    s_waitcnt vmcnt(0)
    global_store_dword v8, v8, s[10:11] sc1
    s_waitcnt vmcnt(0)
    global_store_dword v8, v8, s[10:11] sc1
    s_waitcnt vmcnt(0)
    global_store_dword v8, v8, s[10:11] sc1
    s_waitcnt vmcnt(0)
    global_store_dword v8, v8, s[10:11] sc1
    s_waitcnt vmcnt(0)
    global_store_dword v8, v8, s[10:11] sc1
    s_waitcnt vmcnt(0)
    global_store_dword v8, v8, s[10:11] sc1
    s_waitcnt vmcnt(0)
    global_store_dword v8, v8, s[10:11] sc1
    s_waitcnt vmcnt(0)
    global_store_dword v8, v8, s[10:11] sc1
    s_waitcnt vmcnt(0)
    global_store_dword v8, v8, s[10:11] sc1
    s_waitcnt vmcnt(0)
    s_mov_b64 exec, 1
    global_atomic_cmpswap v9, v[12:13], s[26:27] sc1
    s_mov_b64 exec, -1
CAL_skip:
    s_barrier
CAL_nb:
    s_branch K_pre7
K_late7:
    s_mov_b32 s60, 1000
K_pre7:
    v_lshrrev_b32 v8, 6, v0
    s_load_dwordx2 s[10:11], s[0:1], 112
    s_load_dwordx2 s[24:25], s[0:1], 88
    v_readfirstlane_b32 s3, v8
    v_and_b32 v16, 63, v0
    v_lshlrev_b32 v0, 4, v16
    v_lshlrev_b32 v1, 2, v16
    v_and_b32 v1, 127, v1
    s_lshl_b32 s36, s3, 15
    s_bfe_u32 s38, s2, 0x20003
    s_lshl_b32 s38, s38, 8
    s_lshl_b32 s6, s3, 6
    s_add_u32 s38, s38, s6
    s_waitcnt lgkmcnt(0)
    s_mov_b32 s32, s24
    s_and_b32 s33, s25, 0xffff
    s_mov_b32 s34, 704512
    s_mov_b32 s35, 0x20000
    s_mov_b32 s39, 1024
    v_lshrrev_b32 v20, 2, v16
    v_mul_lo_u32 v18, v20, s39
    v_bfe_u32 v17, v16, 0, 2
    v_lshl_add_u32 v18, v17, 4, v18
    v_bfe_u32 v17, v16, 5, 1
    v_lshlrev_b32 v19, 9, v17
    v_bfe_u32 v17, v16, 2, 2
    v_lshl_add_u32 v19, v17, 6, v19
    v_bfe_u32 v17, v16, 4, 1
    v_lshl_add_u32 v19, v17, 5, v19
    v_bfe_u32 v17, v16, 0, 1
    v_lshl_add_u32 v19, v17, 4, v19
    v_bfe_u32 v17, v16, 1, 1
    v_lshl_add_u32 v19, v17, 3, v19
    v_add_u32 v19, s36, v19
    s_add_u32 m0, s36, 0
    s_add_u32 s37, s38, 0
    buffer_load_dwordx4 v18, s[32:35], s37 offen lds
    s_add_u32 m0, s36, 1024
    s_add_u32 s37, s38, 16384
    buffer_load_dwordx4 v18, s[32:35], s37 offen lds
    s_add_u32 m0, s36, 2048
    s_add_u32 s37, s38, 32768
    buffer_load_dwordx4 v18, s[32:35], s37 offen lds
    s_add_u32 m0, s36, 3072
    s_add_u32 s37, s38, 49152
    buffer_load_dwordx4 v18, s[32:35], s37 offen lds
    s_add_u32 m0, s36, 4096
    s_add_u32 s37, s38, 65536
    buffer_load_dwordx4 v18, s[32:35], s37 offen lds
    s_add_u32 m0, s36, 5120
    s_add_u32 s37, s38, 81920
    buffer_load_dwordx4 v18, s[32:35], s37 offen lds
    s_add_u32 m0, s36, 6144
    s_add_u32 s37, s38, 98304
    buffer_load_dwordx4 v18, s[32:35], s37 offen lds
    s_add_u32 m0, s36, 7168
    s_add_u32 s37, s38, 114688
    buffer_load_dwordx4 v18, s[32:35], s37 offen lds
    s_add_u32 m0, s36, 8192
    s_add_u32 s37, s38, 131072
    buffer_load_dwordx4 v18, s[32:35], s37 offen lds
    s_add_u32 m0, s36, 9216
    s_add_u32 s37, s38, 147456
    buffer_load_dwordx4 v18, s[32:35], s37 offen lds
    s_add_u32 m0, s36, 10240
    s_add_u32 s37, s38, 163840
    buffer_load_dwordx4 v18, s[32:35], s37 offen lds
    s_add_u32 m0, s36, 11264
    s_add_u32 s37, s38, 180224
    buffer_load_dwordx4 v18, s[32:35], s37 offen lds
    s_add_u32 m0, s36, 12288
    s_add_u32 s37, s38, 196608
    buffer_load_dwordx4 v18, s[32:35], s37 offen lds
    s_add_u32 m0, s36, 13312
    s_add_u32 s37, s38, 212992
    buffer_load_dwordx4 v18, s[32:35], s37 offen lds
    s_add_u32 m0, s36, 14336
    s_add_u32 s37, s38, 229376
    buffer_load_dwordx4 v18, s[32:35], s37 offen lds
    s_add_u32 m0, s36, 15360
    s_add_u32 s37, s38, 245760
    buffer_load_dwordx4 v18, s[32:35], s37 offen lds
    s_add_u32 m0, s36, 16384
    s_add_u32 s37, s38, 262144
    buffer_load_dwordx4 v18, s[32:35], s37 offen lds
    s_add_u32 m0, s36, 17408
    s_add_u32 s37, s38, 278528
    buffer_load_dwordx4 v18, s[32:35], s37 offen lds
    s_add_u32 m0, s36, 18432
    s_add_u32 s37, s38, 294912
    buffer_load_dwordx4 v18, s[32:35], s37 offen lds
    s_add_u32 m0, s36, 19456
    s_add_u32 s37, s38, 311296
    buffer_load_dwordx4 v18, s[32:35], s37 offen lds
    s_add_u32 m0, s36, 20480
    s_add_u32 s37, s38, 327680
    buffer_load_dwordx4 v18, s[32:35], s37 offen lds
    s_add_u32 m0, s36, 21504
    s_add_u32 s37, s38, 344064
    buffer_load_dwordx4 v18, s[32:35], s37 offen lds
    s_add_u32 m0, s36, 22528
    s_add_u32 s37, s38, 360448
    buffer_load_dwordx4 v18, s[32:35], s37 offen lds
    s_add_u32 m0, s36, 23552
    s_add_u32 s37, s38, 376832
    buffer_load_dwordx4 v18, s[32:35], s37 offen lds
    s_add_u32 m0, s36, 24576
    s_add_u32 s37, s38, 393216
    buffer_load_dwordx4 v18, s[32:35], s37 offen lds
    s_add_u32 m0, s36, 25600
    s_add_u32 s37, s38, 409600
    buffer_load_dwordx4 v18, s[32:35], s37 offen lds
    s_add_u32 m0, s36, 26624
    s_add_u32 s37, s38, 425984
    buffer_load_dwordx4 v18, s[32:35], s37 offen lds
    s_add_u32 m0, s36, 27648
    s_add_u32 s37, s38, 442368
    buffer_load_dwordx4 v18, s[32:35], s37 offen lds
    s_add_u32 m0, s36, 28672
    s_add_u32 s37, s38, 458752
    buffer_load_dwordx4 v18, s[32:35], s37 offen lds
    s_add_u32 m0, s36, 29696
    s_add_u32 s37, s38, 475136
    buffer_load_dwordx4 v18, s[32:35], s37 offen lds
    s_add_u32 m0, s36, 30720
    s_add_u32 s37, s38, 491520
    buffer_load_dwordx4 v18, s[32:35], s37 offen lds
    s_add_u32 m0, s36, 31744
    s_add_u32 s37, s38, 507904
    buffer_load_dwordx4 v18, s[32:35], s37 offen lds
    s_waitcnt vmcnt(28)
    ds_read_b64_tr_b16 a[0:1], v19 offset:0
    ds_read_b64_tr_b16 a[2:3], v19 offset:256
    ds_read_b64_tr_b16 a[4:5], v19 offset:1024
    ds_read_b64_tr_b16 a[6:7], v19 offset:1280
    ds_read_b64_tr_b16 a[8:9], v19 offset:2048
    ds_read_b64_tr_b16 a[10:11], v19 offset:2304
    ds_read_b64_tr_b16 a[12:13], v19 offset:3072
    ds_read_b64_tr_b16 a[14:15], v19 offset:3328
    s_waitcnt lgkmcnt(0)
    s_add_u32 m0, s36, 0
    s_add_u32 s37, s38, 524288
    buffer_load_dwordx4 v18, s[32:35], s37 offen lds
    s_add_u32 m0, s36, 1024
    s_add_u32 s37, s38, 540672
    buffer_load_dwordx4 v18, s[32:35], s37 offen lds
    s_add_u32 m0, s36, 2048
    s_add_u32 s37, s38, 557056
    buffer_load_dwordx4 v18, s[32:35], s37 offen lds
    s_add_u32 m0, s36, 3072
    s_add_u32 s37, s38, 573440
    buffer_load_dwordx4 v18, s[32:35], s37 offen lds
    s_waitcnt vmcnt(28)
    ds_read_b64_tr_b16 a[16:17], v19 offset:4096
    ds_read_b64_tr_b16 a[18:19], v19 offset:4352
    ds_read_b64_tr_b16 a[20:21], v19 offset:5120
    ds_read_b64_tr_b16 a[22:23], v19 offset:5376
    ds_read_b64_tr_b16 a[24:25], v19 offset:6144
    ds_read_b64_tr_b16 a[26:27], v19 offset:6400
    ds_read_b64_tr_b16 a[28:29], v19 offset:7168
    ds_read_b64_tr_b16 a[30:31], v19 offset:7424
    s_waitcnt lgkmcnt(0)
    s_add_u32 m0, s36, 4096
    s_add_u32 s37, s38, 589824
    buffer_load_dwordx4 v18, s[32:35], s37 offen lds
    s_add_u32 m0, s36, 5120
    s_add_u32 s37, s38, 606208
    buffer_load_dwordx4 v18, s[32:35], s37 offen lds
    s_add_u32 m0, s36, 6144
    s_add_u32 s37, s38, 622592
    buffer_load_dwordx4 v18, s[32:35], s37 offen lds
    s_add_u32 m0, s36, 7168
    s_add_u32 s37, s38, 638976
    buffer_load_dwordx4 v18, s[32:35], s37 offen lds
    s_waitcnt vmcnt(28)
    ds_read_b64_tr_b16 a[32:33], v19 offset:8192
    ds_read_b64_tr_b16 a[34:35], v19 offset:8448
    ds_read_b64_tr_b16 a[36:37], v19 offset:9216
    ds_read_b64_tr_b16 a[38:39], v19 offset:9472
    ds_read_b64_tr_b16 a[40:41], v19 offset:10240
    ds_read_b64_tr_b16 a[42:43], v19 offset:10496
    ds_read_b64_tr_b16 a[44:45], v19 offset:11264
    ds_read_b64_tr_b16 a[46:47], v19 offset:11520
    s_waitcnt lgkmcnt(0)
    s_add_u32 m0, s36, 8192
    s_add_u32 s37, s38, 655360
    buffer_load_dwordx4 v18, s[32:35], s37 offen lds
    s_add_u32 m0, s36, 9216
    s_add_u32 s37, s38, 671744
    buffer_load_dwordx4 v18, s[32:35], s37 offen lds
    s_add_u32 m0, s36, 10240
    s_add_u32 s37, s38, 688128
    buffer_load_dwordx4 v18, s[32:35], s37 offen lds
    s_waitcnt vmcnt(27)
    ds_read_b64_tr_b16 a[48:49], v19 offset:12288
    ds_read_b64_tr_b16 a[50:51], v19 offset:12544
    ds_read_b64_tr_b16 a[52:53], v19 offset:13312
    ds_read_b64_tr_b16 a[54:55], v19 offset:13568
    ds_read_b64_tr_b16 a[56:57], v19 offset:14336
    ds_read_b64_tr_b16 a[58:59], v19 offset:14592
    ds_read_b64_tr_b16 a[60:61], v19 offset:15360
    ds_read_b64_tr_b16 a[62:63], v19 offset:15616
    s_waitcnt lgkmcnt(0)
    s_waitcnt vmcnt(23)
    ds_read_b64_tr_b16 a[64:65], v19 offset:16384
    ds_read_b64_tr_b16 a[66:67], v19 offset:16640
    ds_read_b64_tr_b16 a[68:69], v19 offset:17408
    ds_read_b64_tr_b16 a[70:71], v19 offset:17664
    ds_read_b64_tr_b16 a[72:73], v19 offset:18432
    ds_read_b64_tr_b16 a[74:75], v19 offset:18688
    ds_read_b64_tr_b16 a[76:77], v19 offset:19456
    ds_read_b64_tr_b16 a[78:79], v19 offset:19712
    s_waitcnt lgkmcnt(0)
    s_waitcnt vmcnt(19)
    ds_read_b64_tr_b16 a[80:81], v19 offset:20480
    ds_read_b64_tr_b16 a[82:83], v19 offset:20736
    ds_read_b64_tr_b16 a[84:85], v19 offset:21504
    ds_read_b64_tr_b16 a[86:87], v19 offset:21760
    ds_read_b64_tr_b16 a[88:89], v19 offset:22528
    ds_read_b64_tr_b16 a[90:91], v19 offset:22784
    ds_read_b64_tr_b16 a[92:93], v19 offset:23552
    ds_read_b64_tr_b16 a[94:95], v19 offset:23808
    s_waitcnt lgkmcnt(0)
    s_waitcnt vmcnt(15)
    ds_read_b64_tr_b16 a[96:97], v19 offset:24576
    ds_read_b64_tr_b16 a[98:99], v19 offset:24832
    ds_read_b64_tr_b16 a[100:101], v19 offset:25600
    ds_read_b64_tr_b16 a[102:103], v19 offset:25856
    ds_read_b64_tr_b16 a[104:105], v19 offset:26624
    ds_read_b64_tr_b16 a[106:107], v19 offset:26880
    ds_read_b64_tr_b16 a[108:109], v19 offset:27648
    ds_read_b64_tr_b16 a[110:111], v19 offset:27904
    s_waitcnt lgkmcnt(0)
    s_waitcnt vmcnt(11)
    ds_read_b64_tr_b16 a[112:113], v19 offset:28672
    ds_read_b64_tr_b16 a[114:115], v19 offset:28928
    ds_read_b64_tr_b16 a[116:117], v19 offset:29696
    ds_read_b64_tr_b16 a[118:119], v19 offset:29952
    ds_read_b64_tr_b16 a[120:121], v19 offset:30720
    ds_read_b64_tr_b16 a[122:123], v19 offset:30976
    ds_read_b64_tr_b16 a[124:125], v19 offset:31744
    ds_read_b64_tr_b16 a[126:127], v19 offset:32000
    s_waitcnt lgkmcnt(0)
    s_waitcnt vmcnt(7)
    ds_read_b64_tr_b16 a[128:129], v19 offset:0
    ds_read_b64_tr_b16 a[130:131], v19 offset:256
    ds_read_b64_tr_b16 a[132:133], v19 offset:1024
    ds_read_b64_tr_b16 a[134:135], v19 offset:1280
    ds_read_b64_tr_b16 a[136:137], v19 offset:2048
    ds_read_b64_tr_b16 a[138:139], v19 offset:2304
    ds_read_b64_tr_b16 a[140:141], v19 offset:3072
    ds_read_b64_tr_b16 a[142:143], v19 offset:3328
    s_waitcnt lgkmcnt(0)
    s_waitcnt vmcnt(3)
    ds_read_b64_tr_b16 a[144:145], v19 offset:4096
    ds_read_b64_tr_b16 a[146:147], v19 offset:4352
    ds_read_b64_tr_b16 a[148:149], v19 offset:5120
    ds_read_b64_tr_b16 a[150:151], v19 offset:5376
    ds_read_b64_tr_b16 a[152:153], v19 offset:6144
    ds_read_b64_tr_b16 a[154:155], v19 offset:6400
    ds_read_b64_tr_b16 a[156:157], v19 offset:7168
    ds_read_b64_tr_b16 a[158:159], v19 offset:7424
    s_waitcnt lgkmcnt(0)
    s_waitcnt vmcnt(0)
    ds_read_b64_tr_b16 a[160:161], v19 offset:8192
    ds_read_b64_tr_b16 a[162:163], v19 offset:8448
    ds_read_b64_tr_b16 a[164:165], v19 offset:9216
    ds_read_b64_tr_b16 a[166:167], v19 offset:9472
    ds_read_b64_tr_b16 a[168:169], v19 offset:10240
    ds_read_b64_tr_b16 a[170:171], v19 offset:10496
    s_waitcnt lgkmcnt(0)
    s_barrier
    s_cmp_ge_u32 s60, 128
    s_cbranch_scc1 R7_run
    s_cmp_ge_u32 s60, 32
    s_cbranch_scc1 K_n_41
    s_sub_u32 s4, s60, 0
    s_mov_b32 s5, 0
    s_branch K_r3
K_n_41:
    s_cmp_ge_u32 s60, 54
    s_cbranch_scc1 K_n_42
    s_sub_u32 s4, s60, 32
    s_mov_b32 s5, 0
    s_branch K_r6
K_n_42:
    s_cmp_ge_u32 s60, 62
    s_cbranch_scc1 K_n_43
    s_sub_u32 s4, s60, 54
    s_mov_b32 s5, 0
    s_branch K_r4
K_n_43:
    s_cmp_ge_u32 s60, 64
    s_cbranch_scc1 K_n_44
    s_sub_u32 s4, s60, 62
    s_mov_b32 s5, 0
    s_branch K_sp
K_n_44:
    s_cmp_ge_u32 s60, 86
    s_cbranch_scc1 K_n_45
    s_sub_u32 s4, s60, 42
    s_mov_b32 s5, 0
    s_branch K_r6
K_n_45:
    s_cmp_ge_u32 s60, 94
    s_cbranch_scc1 K_n_46
    s_sub_u32 s4, s60, 86
    s_mov_b32 s5, 1
    s_branch K_r4
K_n_46:
    s_cmp_ge_u32 s60, 96
    s_cbranch_scc1 K_n_47
    s_sub_u32 s4, s60, 92
    s_mov_b32 s5, 0
    s_branch K_sp
K_n_47:
    s_cmp_ge_u32 s60, 107
    s_cbranch_scc1 K_n_48
    s_sub_u32 s4, s60, 96
    s_mov_b32 s5, 0
    s_branch K_r5
K_n_48:
    s_cmp_ge_u32 s60, 118
    s_cbranch_scc1 K_n_49
    s_sub_u32 s4, s60, 107
    s_mov_b32 s5, 1
    s_branch K_r5
K_n_49:
    s_cmp_ge_u32 s60, 128
    s_cbranch_scc1 K_n_50
    s_sub_u32 s4, s60, 114
    s_mov_b32 s5, 0
    s_branch K_sp
K_n_50:
K_r3:
    s_load_dwordx2 s[24:25], s[0:1], 40
    v_lshrrev_b32 v16, 4, v0
    s_lshr_b32 s41, s4, 2
    s_and_b32 s40, s4, 3
    s_waitcnt lgkmcnt(0)
    s_mov_b32 s32, s24
    s_and_b32 s33, s25, 0xffff
    s_mov_b32 s34, 4194304
    s_mov_b32 s35, 0x20000
    s_lshl_b32 s38, s41, 19
    s_lshl_b32 s6, s40, 8
    s_add_u32 s38, s38, s6
    s_lshl_b32 s6, s3, 6
    s_add_u32 s38, s38, s6
    s_mov_b32 s7, 83886080
    s_mul_i32 s6, s41, 65536
    s_add_u32 s7, s7, s6
    s_mul_i32 s6, s3, 1024
    s_add_u32 s7, s7, s6
    s_add_u32 s16, s10, s7
    s_addc_u32 s17, s11, 0
    v_bfe_u32 v17, v16, 2, 3
    v_lshlrev_b32 v3, 16, v17
    v_bfe_u32 v17, v16, 5, 1
    v_lshl_add_u32 v3, v17, 6, v3
    v_bfe_u32 v17, v16, 0, 2
    v_lshl_add_u32 v3, v17, 4, v3
    s_lshr_b32 s42, s4, 3
    s_mov_b32 s7, 155189248
    s_mul_i32 s6, s4, 1024
    s_add_u32 s7, s7, s6
    s_mul_i32 s6, s42, 8192
    s_add_u32 s7, s7, s6
    s_mul_i32 s6, s3, 256
    s_add_u32 s7, s7, s6
    s_add_u32 s18, s10, s7
    s_addc_u32 s19, s11, 0
    s_mov_b32 s7, 84754432
    s_mul_i32 s6, s41, 128
    s_add_u32 s7, s7, s6
    s_add_u32 s20, s10, s7
    s_addc_u32 s21, s11, 0
    s_mov_b32 s7, 84755456
    s_mul_i32 s6, s4, 4
    s_add_u32 s7, s7, s6
    s_add_u32 s30, s10, s7
    s_addc_u32 s31, s11, 0
    s_mov_b64 s[22:23], 0xf
    s_mov_b32 s39, 1024
    v_lshrrev_b32 v20, 2, v16
    v_mul_lo_u32 v18, v20, s39
    v_bfe_u32 v17, v16, 0, 2
    v_lshl_add_u32 v18, v17, 4, v18
    v_bfe_u32 v17, v16, 5, 1
    v_lshlrev_b32 v19, 9, v17
    v_bfe_u32 v17, v16, 2, 2
    v_lshl_add_u32 v19, v17, 6, v19
    v_bfe_u32 v17, v16, 4, 1
    v_lshl_add_u32 v19, v17, 5, v19
    v_bfe_u32 v17, v16, 0, 1
    v_lshl_add_u32 v19, v17, 4, v19
    v_bfe_u32 v17, v16, 1, 1
    v_lshl_add_u32 v19, v17, 3, v19
    v_add_u32 v19, s36, v19
    s_add_u32 m0, s36, 0
    s_add_u32 s37, s38, 0
    buffer_load_dwordx4 v18, s[32:35], s37 offen lds
    s_add_u32 m0, s36, 1024
    s_add_u32 s37, s38, 16384
    buffer_load_dwordx4 v18, s[32:35], s37 offen lds
    s_add_u32 m0, s36, 2048
    s_add_u32 s37, s38, 32768
    buffer_load_dwordx4 v18, s[32:35], s37 offen lds
    s_add_u32 m0, s36, 3072
    s_add_u32 s37, s38, 49152
    buffer_load_dwordx4 v18, s[32:35], s37 offen lds
    s_add_u32 m0, s36, 4096
    s_add_u32 s37, s38, 65536
    buffer_load_dwordx4 v18, s[32:35], s37 offen lds
    s_add_u32 m0, s36, 5120
    s_add_u32 s37, s38, 81920
    buffer_load_dwordx4 v18, s[32:35], s37 offen lds
    s_add_u32 m0, s36, 6144
    s_add_u32 s37, s38, 98304
    buffer_load_dwordx4 v18, s[32:35], s37 offen lds
    s_add_u32 m0, s36, 7168
    s_add_u32 s37, s38, 114688
    buffer_load_dwordx4 v18, s[32:35], s37 offen lds
    s_add_u32 m0, s36, 8192
    s_add_u32 s37, s38, 131072
    buffer_load_dwordx4 v18, s[32:35], s37 offen lds
    s_add_u32 m0, s36, 9216
    s_add_u32 s37, s38, 147456
    buffer_load_dwordx4 v18, s[32:35], s37 offen lds
    s_add_u32 m0, s36, 10240
    s_add_u32 s37, s38, 163840
    buffer_load_dwordx4 v18, s[32:35], s37 offen lds
    s_add_u32 m0, s36, 11264
    s_add_u32 s37, s38, 180224
    buffer_load_dwordx4 v18, s[32:35], s37 offen lds
    s_add_u32 m0, s36, 12288
    s_add_u32 s37, s38, 196608
    buffer_load_dwordx4 v18, s[32:35], s37 offen lds
    s_add_u32 m0, s36, 13312
    s_add_u32 s37, s38, 212992
    buffer_load_dwordx4 v18, s[32:35], s37 offen lds
    s_add_u32 m0, s36, 14336
    s_add_u32 s37, s38, 229376
    buffer_load_dwordx4 v18, s[32:35], s37 offen lds
    s_add_u32 m0, s36, 15360
    s_add_u32 s37, s38, 245760
    buffer_load_dwordx4 v18, s[32:35], s37 offen lds
    s_add_u32 m0, s36, 16384
    s_add_u32 s37, s38, 262144
    buffer_load_dwordx4 v18, s[32:35], s37 offen lds
    s_add_u32 m0, s36, 17408
    s_add_u32 s37, s38, 278528
    buffer_load_dwordx4 v18, s[32:35], s37 offen lds
    s_add_u32 m0, s36, 18432
    s_add_u32 s37, s38, 294912
    buffer_load_dwordx4 v18, s[32:35], s37 offen lds
    s_add_u32 m0, s36, 19456
    s_add_u32 s37, s38, 311296
    buffer_load_dwordx4 v18, s[32:35], s37 offen lds
    s_add_u32 m0, s36, 20480
    s_add_u32 s37, s38, 327680
    buffer_load_dwordx4 v18, s[32:35], s37 offen lds
    s_add_u32 m0, s36, 21504
    s_add_u32 s37, s38, 344064
    buffer_load_dwordx4 v18, s[32:35], s37 offen lds
    s_add_u32 m0, s36, 22528
    s_add_u32 s37, s38, 360448
    buffer_load_dwordx4 v18, s[32:35], s37 offen lds
    s_add_u32 m0, s36, 23552
    s_add_u32 s37, s38, 376832
    buffer_load_dwordx4 v18, s[32:35], s37 offen lds
    s_add_u32 m0, s36, 24576
    s_add_u32 s37, s38, 393216
    buffer_load_dwordx4 v18, s[32:35], s37 offen lds
    s_add_u32 m0, s36, 25600
    s_add_u32 s37, s38, 409600
    buffer_load_dwordx4 v18, s[32:35], s37 offen lds
    s_add_u32 m0, s36, 26624
    s_add_u32 s37, s38, 425984
    buffer_load_dwordx4 v18, s[32:35], s37 offen lds
    s_add_u32 m0, s36, 27648
    s_add_u32 s37, s38, 442368
    buffer_load_dwordx4 v18, s[32:35], s37 offen lds
    s_add_u32 m0, s36, 28672
    s_add_u32 s37, s38, 458752
    buffer_load_dwordx4 v18, s[32:35], s37 offen lds
    s_add_u32 m0, s36, 29696
    s_add_u32 s37, s38, 475136
    buffer_load_dwordx4 v18, s[32:35], s37 offen lds
    s_add_u32 m0, s36, 30720
    s_add_u32 s37, s38, 491520
    buffer_load_dwordx4 v18, s[32:35], s37 offen lds
    s_add_u32 m0, s36, 31744
    s_add_u32 s37, s38, 507904
    buffer_load_dwordx4 v18, s[32:35], s37 offen lds
    s_waitcnt vmcnt(28)
    ds_read_b64_tr_b16 v[128:129], v19 offset:0
    ds_read_b64_tr_b16 v[130:131], v19 offset:256
    ds_read_b64_tr_b16 v[132:133], v19 offset:1024
    ds_read_b64_tr_b16 v[134:135], v19 offset:1280
    ds_read_b64_tr_b16 v[136:137], v19 offset:2048
    ds_read_b64_tr_b16 v[138:139], v19 offset:2304
    ds_read_b64_tr_b16 v[140:141], v19 offset:3072
    ds_read_b64_tr_b16 v[142:143], v19 offset:3328
    s_waitcnt lgkmcnt(0)
    s_waitcnt vmcnt(24)
    ds_read_b64_tr_b16 v[144:145], v19 offset:4096
    ds_read_b64_tr_b16 v[146:147], v19 offset:4352
    ds_read_b64_tr_b16 v[148:149], v19 offset:5120
    ds_read_b64_tr_b16 v[150:151], v19 offset:5376
    ds_read_b64_tr_b16 v[152:153], v19 offset:6144
    ds_read_b64_tr_b16 v[154:155], v19 offset:6400
    ds_read_b64_tr_b16 v[156:157], v19 offset:7168
    ds_read_b64_tr_b16 v[158:159], v19 offset:7424
    s_waitcnt lgkmcnt(0)
    s_waitcnt vmcnt(20)
    ds_read_b64_tr_b16 v[160:161], v19 offset:8192
    ds_read_b64_tr_b16 v[162:163], v19 offset:8448
    ds_read_b64_tr_b16 v[164:165], v19 offset:9216
    ds_read_b64_tr_b16 v[166:167], v19 offset:9472
    ds_read_b64_tr_b16 v[168:169], v19 offset:10240
    ds_read_b64_tr_b16 v[170:171], v19 offset:10496
    ds_read_b64_tr_b16 v[172:173], v19 offset:11264
    ds_read_b64_tr_b16 v[174:175], v19 offset:11520
    s_waitcnt lgkmcnt(0)
    s_waitcnt vmcnt(16)
    ds_read_b64_tr_b16 v[176:177], v19 offset:12288
    ds_read_b64_tr_b16 v[178:179], v19 offset:12544
    ds_read_b64_tr_b16 v[180:181], v19 offset:13312
    ds_read_b64_tr_b16 v[182:183], v19 offset:13568
    ds_read_b64_tr_b16 v[184:185], v19 offset:14336
    ds_read_b64_tr_b16 v[186:187], v19 offset:14592
    ds_read_b64_tr_b16 v[188:189], v19 offset:15360
    ds_read_b64_tr_b16 v[190:191], v19 offset:15616
    s_waitcnt lgkmcnt(0)
    s_waitcnt vmcnt(12)
    ds_read_b64_tr_b16 v[192:193], v19 offset:16384
    ds_read_b64_tr_b16 v[194:195], v19 offset:16640
    ds_read_b64_tr_b16 v[196:197], v19 offset:17408
    ds_read_b64_tr_b16 v[198:199], v19 offset:17664
    ds_read_b64_tr_b16 v[200:201], v19 offset:18432
    ds_read_b64_tr_b16 v[202:203], v19 offset:18688
    ds_read_b64_tr_b16 v[204:205], v19 offset:19456
    ds_read_b64_tr_b16 v[206:207], v19 offset:19712
    s_waitcnt lgkmcnt(0)
    s_waitcnt vmcnt(8)
    ds_read_b64_tr_b16 v[208:209], v19 offset:20480
    ds_read_b64_tr_b16 v[210:211], v19 offset:20736
    ds_read_b64_tr_b16 v[212:213], v19 offset:21504
    ds_read_b64_tr_b16 v[214:215], v19 offset:21760
    ds_read_b64_tr_b16 v[216:217], v19 offset:22528
    ds_read_b64_tr_b16 v[218:219], v19 offset:22784
    ds_read_b64_tr_b16 v[220:221], v19 offset:23552
    ds_read_b64_tr_b16 v[222:223], v19 offset:23808
    s_waitcnt lgkmcnt(0)
    s_waitcnt vmcnt(4)
    ds_read_b64_tr_b16 v[224:225], v19 offset:24576
    ds_read_b64_tr_b16 v[226:227], v19 offset:24832
    ds_read_b64_tr_b16 v[228:229], v19 offset:25600
    ds_read_b64_tr_b16 v[230:231], v19 offset:25856
    ds_read_b64_tr_b16 v[232:233], v19 offset:26624
    ds_read_b64_tr_b16 v[234:235], v19 offset:26880
    ds_read_b64_tr_b16 v[236:237], v19 offset:27648
    ds_read_b64_tr_b16 v[238:239], v19 offset:27904
    s_waitcnt lgkmcnt(0)
    s_waitcnt vmcnt(0)
    ds_read_b64_tr_b16 v[240:241], v19 offset:28672
    ds_read_b64_tr_b16 v[242:243], v19 offset:28928
    ds_read_b64_tr_b16 v[244:245], v19 offset:29696
    ds_read_b64_tr_b16 v[246:247], v19 offset:29952
    ds_read_b64_tr_b16 v[248:249], v19 offset:30720
    ds_read_b64_tr_b16 v[250:251], v19 offset:30976
    ds_read_b64_tr_b16 v[252:253], v19 offset:31744
    ds_read_b64_tr_b16 v[254:255], v19 offset:32000
    s_waitcnt lgkmcnt(0)
    s_barrier
    s_load_dwordx2 s[12:13], s[0:1], 104
    v_mov_b32 v8, 32
    s_mov_b32 s8, 800000
    s_waitcnt lgkmcnt(0)
I_w_51:
    global_load_dword v9, v8, s[12:13] sc1
    s_waitcnt vmcnt(0)
    v_cmp_le_u32 vcc, 128, v9
    s_cbranch_vccnz I_d_52
    s_sleep 4
    s_sub_u32 s8, s8, 1
    s_cbranch_scc0 I_w_51
I_d_52:
    s_load_dwordx2 s[12:13], s[0:1], 104
    v_mov_b32 v8, 36
    s_mov_b32 s8, 800000
    s_waitcnt lgkmcnt(0)
I_w_53:
    global_load_dword v9, v8, s[12:13] sc1
    s_waitcnt vmcnt(0)
    v_cmp_le_u32 vcc, 1, v9
    s_cbranch_vccnz I_d_54
    s_sleep 4
    s_sub_u32 s8, s8, 1
    s_cbranch_scc0 I_w_53
I_d_54:
    v_readfirstlane_b32 s97, v9
    s_nop 3
    s_lshl_b32 s97, s97, 13
    s_and_b32 s97, s97, 0x2000
    s_xor_b32 s96, s97, 0x2000
    s_mov_b32 s98, s97
    s_lshl_b32 s7, s5, 12
    s_xor_b32 s7, s7, s98
    s_and_b32 s7, s7, 0x2000
    s_lshl_b32 s6, s5, 20
    s_add_u32 s6, s6, s7
    s_add_u32 s14, s20, s6
    s_addc_u32 s15, s21, 0
    global_load_dword v7, v1, s[14:15] sc1
    s_waitcnt vmcnt(0)
    s_mov_b32 s40, 0
    s_mov_b32 s43, 0
R3_loop:
    s_cmp_lg_u32 s43, 0
    s_cbranch_scc1 P_have_55
    s_mov_b32 s8, 800000
P_w_56:
    v_cmp_ne_u32 s[28:29], 0, v7
    s_nop 3
    s_andn2_b64 s[28:29], s[22:23], s[28:29]
    s_cbranch_scc0 P_d_57
    s_sleep 1
    global_load_dword v7, v1, s[14:15] sc1
    s_sub_u32 s8, s8, 1
    s_waitcnt vmcnt(0)
    s_cbranch_scc0 P_w_56
P_d_57:
    s_lshl_b32 s7, s5, 12
    s_xor_b32 s7, s7, s98
    s_and_b32 s7, s7, 0x2000
    s_lshl_b32 s6, s5, 20
    s_add_u32 s6, s6, s7
    s_add_u32 s12, s16, s6
    s_addc_u32 s13, s17, 0
    s_lshl_b32 s7, s3, 10
    s_add_u32 s7, s7, s40
    s_add_u32 m0, s7, 0
    s_nop 0
    global_load_lds_dwordx4 v0, s[12:13] sc1
    s_add_u32 m0, s7, 4096
    s_add_u32 s12, s12, 4096
    s_addc_u32 s13, s13, 0
    global_load_lds_dwordx4 v0, s[12:13] sc1
    s_add_u32 m0, s7, 8192
    s_add_u32 s12, s12, 12288
    s_addc_u32 s13, s13, 0
    global_load_lds_dwordx4 v0, s[12:13] sc1
    s_add_u32 m0, s7, 12288
    s_add_u32 s12, s12, 4096
    s_addc_u32 s13, s13, 0
    global_load_lds_dwordx4 v0, s[12:13] sc1
    s_add_u32 m0, s7, 16384
    s_add_u32 s12, s12, 12288
    s_addc_u32 s13, s13, 0
    global_load_lds_dwordx4 v0, s[12:13] sc1
    s_add_u32 m0, s7, 20480
    s_add_u32 s12, s12, 4096
    s_addc_u32 s13, s13, 0
    global_load_lds_dwordx4 v0, s[12:13] sc1
    s_add_u32 m0, s7, 24576
    s_add_u32 s12, s12, 12288
    s_addc_u32 s13, s13, 0
    global_load_lds_dwordx4 v0, s[12:13] sc1
    s_add_u32 m0, s7, 28672
    s_add_u32 s12, s12, 4096
    s_addc_u32 s13, s13, 0
    global_load_lds_dwordx4 v0, s[12:13] sc1
P_have_55:
    v_add_u32 v6, s40, v0
    s_add_u32 s41, s5, 1
    v_mov_b32 v7, 0
    s_waitcnt vmcnt(5)
    s_barrier
    ds_read_b128 v[16:19], v6 offset:0
    ds_read_b128 v[20:23], v6 offset:1024
    ds_read_b128 v[24:27], v6 offset:2048
    ds_read_b128 v[28:31], v6 offset:3072
    ds_read_b128 v[32:35], v6 offset:4096
    ds_read_b128 v[36:39], v6 offset:5120
    s_waitcnt lgkmcnt(5)
    v_mfma_f32_32x32x16_bf16 v[48:63], v[128:131], v[16:19], 0
    ds_read_b128 v[40:43], v6 offset:6144
    s_waitcnt lgkmcnt(5)
    v_mfma_f32_32x32x16_bf16 v[48:63], v[132:135], v[20:23], v[48:63]
    ds_read_b128 v[44:47], v6 offset:7168
    s_waitcnt lgkmcnt(5)
    v_mfma_f32_32x32x16_bf16 v[48:63], v[136:139], v[24:27], v[48:63]
    ds_read_b128 v[16:19], v6 offset:8192
    s_waitcnt lgkmcnt(5)
    v_mfma_f32_32x32x16_bf16 v[48:63], v[140:143], v[28:31], v[48:63]
    ds_read_b128 v[20:23], v6 offset:9216
    s_waitcnt lgkmcnt(5)
    v_mfma_f32_32x32x16_bf16 v[48:63], v[144:147], v[32:35], v[48:63]
    ds_read_b128 v[24:27], v6 offset:10240
    s_waitcnt lgkmcnt(5)
    v_mfma_f32_32x32x16_bf16 v[48:63], v[148:151], v[36:39], v[48:63]
    ds_read_b128 v[28:31], v6 offset:11264
    s_waitcnt lgkmcnt(5)
    v_mfma_f32_32x32x16_bf16 v[48:63], v[152:155], v[40:43], v[48:63]
    s_waitcnt vmcnt(3)
    s_barrier
    ds_read_b128 v[32:35], v6 offset:12288
    s_waitcnt lgkmcnt(5)
    v_mfma_f32_32x32x16_bf16 v[48:63], v[156:159], v[44:47], v[48:63]
    ds_read_b128 v[36:39], v6 offset:13312
    s_waitcnt lgkmcnt(5)
    v_mfma_f32_32x32x16_bf16 v[48:63], v[160:163], v[16:19], v[48:63]
    ds_read_b128 v[40:43], v6 offset:14336
    s_waitcnt lgkmcnt(5)
    v_mfma_f32_32x32x16_bf16 v[48:63], v[164:167], v[20:23], v[48:63]
    ds_read_b128 v[44:47], v6 offset:15360
    s_waitcnt lgkmcnt(5)
    v_mfma_f32_32x32x16_bf16 v[48:63], v[168:171], v[24:27], v[48:63]
    ds_read_b128 v[16:19], v6 offset:16384
    s_waitcnt lgkmcnt(5)
    v_mfma_f32_32x32x16_bf16 v[48:63], v[172:175], v[28:31], v[48:63]
    ds_read_b128 v[20:23], v6 offset:17408
    s_waitcnt lgkmcnt(5)
    v_mfma_f32_32x32x16_bf16 v[48:63], v[176:179], v[32:35], v[48:63]
    ds_read_b128 v[24:27], v6 offset:18432
    s_waitcnt lgkmcnt(5)
    v_mfma_f32_32x32x16_bf16 v[48:63], v[180:183], v[36:39], v[48:63]
    ds_read_b128 v[28:31], v6 offset:19456
    s_waitcnt lgkmcnt(5)
    v_mfma_f32_32x32x16_bf16 v[48:63], v[184:187], v[40:43], v[48:63]
    s_waitcnt vmcnt(0)
    s_barrier
    s_lshl_b32 s7, s41, 12
    s_xor_b32 s7, s7, s98
    s_and_b32 s7, s7, 0x2000
    s_lshl_b32 s6, s41, 20
    s_add_u32 s6, s6, s7
    s_add_u32 s14, s20, s6
    s_addc_u32 s15, s21, 0
    global_load_dword v7, v1, s[14:15] sc1
    ds_read_b128 v[32:35], v6 offset:20480
    s_waitcnt lgkmcnt(5)
    v_mfma_f32_32x32x16_bf16 v[48:63], v[188:191], v[44:47], v[48:63]
    ds_read_b128 v[36:39], v6 offset:21504
    s_waitcnt lgkmcnt(5)
    v_mfma_f32_32x32x16_bf16 v[48:63], v[192:195], v[16:19], v[48:63]
    ds_read_b128 v[40:43], v6 offset:22528
    s_waitcnt lgkmcnt(5)
    v_mfma_f32_32x32x16_bf16 v[48:63], v[196:199], v[20:23], v[48:63]
    ds_read_b128 v[44:47], v6 offset:23552
    s_waitcnt lgkmcnt(5)
    v_mfma_f32_32x32x16_bf16 v[48:63], v[200:203], v[24:27], v[48:63]
    ds_read_b128 v[16:19], v6 offset:24576
    s_waitcnt lgkmcnt(5)
    v_mfma_f32_32x32x16_bf16 v[48:63], v[204:207], v[28:31], v[48:63]
    ds_read_b128 v[20:23], v6 offset:25600
    s_waitcnt lgkmcnt(5)
    v_mfma_f32_32x32x16_bf16 v[48:63], v[208:211], v[32:35], v[48:63]
    ds_read_b128 v[24:27], v6 offset:26624
    s_waitcnt lgkmcnt(5)
    v_mfma_f32_32x32x16_bf16 v[48:63], v[212:215], v[36:39], v[48:63]
    ds_read_b128 v[28:31], v6 offset:27648
    s_waitcnt lgkmcnt(5)
    v_mfma_f32_32x32x16_bf16 v[48:63], v[216:219], v[40:43], v[48:63]
    ds_read_b128 v[32:35], v6 offset:28672
    s_waitcnt lgkmcnt(5)
    v_mfma_f32_32x32x16_bf16 v[48:63], v[220:223], v[44:47], v[48:63]
    ds_read_b128 v[36:39], v6 offset:29696
    s_waitcnt lgkmcnt(5)
    v_mfma_f32_32x32x16_bf16 v[48:63], v[224:227], v[16:19], v[48:63]
    ds_read_b128 v[40:43], v6 offset:30720
    s_waitcnt lgkmcnt(5)
    v_mfma_f32_32x32x16_bf16 v[48:63], v[228:231], v[20:23], v[48:63]
    ds_read_b128 v[44:47], v6 offset:31744
    s_waitcnt lgkmcnt(5)
    v_mfma_f32_32x32x16_bf16 v[48:63], v[232:235], v[24:27], v[48:63]
    s_waitcnt lgkmcnt(4)
    v_mfma_f32_32x32x16_bf16 v[48:63], v[236:239], v[28:31], v[48:63]
    s_waitcnt lgkmcnt(3)
    v_mfma_f32_32x32x16_bf16 v[48:63], v[240:243], v[32:35], v[48:63]
    s_waitcnt lgkmcnt(2)
    v_mfma_f32_32x32x16_bf16 v[48:63], v[244:247], v[36:39], v[48:63]
    s_waitcnt lgkmcnt(1)
    v_mfma_f32_32x32x16_bf16 v[48:63], v[248:251], v[40:43], v[48:63]
    s_waitcnt lgkmcnt(0)
    v_mfma_f32_32x32x16_bf16 v[48:63], v[252:255], v[44:47], v[48:63]
    s_xor_b32 s40, s40, 32768
    s_lshl_b32 s7, s5, 12
    s_xor_b32 s7, s7, s97
    s_and_b32 s7, s7, 0x2000
    s_lshl_b32 s6, s5, 20
    s_add_u32 s6, s6, s7
    s_add_u32 s12, s18, s6
    s_addc_u32 s13, s19, 0
    s_nop 7
    v_cvt_pk_bf16_f32 v64, v48, v49
    v_cvt_pk_bf16_f32 v65, v50, v51
    v_cvt_pk_bf16_f32 v66, v52, v53
    v_cvt_pk_bf16_f32 v67, v54, v55
    v_cvt_pk_bf16_f32 v68, v56, v57
    v_cvt_pk_bf16_f32 v69, v58, v59
    v_cvt_pk_bf16_f32 v70, v60, v61
    v_cvt_pk_bf16_f32 v71, v62, v63
    global_store_dwordx4 v3, v[64:67], s[12:13] sc1
    global_store_dwordx4 v3, v[68:71], s[12:13] offset:128 sc1
    s_add_u32 s41, s5, 1
    s_lshl_b32 s7, s5, 12
    s_xor_b32 s7, s7, s96
    s_and_b32 s7, s7, 0x2000
    s_lshl_b32 s6, s5, 20
    s_add_u32 s6, s6, s7
    v_mov_b32 v8, s6
    v_mov_b32 v9, 1
    v_cmp_ne_u32 s[28:29], 0, v7
    s_mov_b32 s43, 0
    s_cmp_ge_u32 s41, 64
    s_cbranch_scc1 P_nopre_59
    s_andn2_b64 s[28:29], s[22:23], s[28:29]
    s_cbranch_scc1 P_nopre_59
    s_mov_b32 s43, 1
    s_lshl_b32 s7, s41, 12
    s_xor_b32 s7, s7, s98
    s_and_b32 s7, s7, 0x2000
    s_lshl_b32 s6, s41, 20
    s_add_u32 s6, s6, s7
    s_add_u32 s12, s16, s6
    s_addc_u32 s13, s17, 0
    s_lshl_b32 s7, s3, 10
    s_add_u32 s7, s7, s40
    s_add_u32 m0, s7, 0
    s_nop 0
    global_load_lds_dwordx4 v0, s[12:13] sc1
    s_add_u32 m0, s7, 4096
    s_add_u32 s12, s12, 4096
    s_addc_u32 s13, s13, 0
    global_load_lds_dwordx4 v0, s[12:13] sc1
    s_add_u32 m0, s7, 8192
    s_add_u32 s12, s12, 12288
    s_addc_u32 s13, s13, 0
    global_load_lds_dwordx4 v0, s[12:13] sc1
    s_add_u32 m0, s7, 12288
    s_add_u32 s12, s12, 4096
    s_addc_u32 s13, s13, 0
    global_load_lds_dwordx4 v0, s[12:13] sc1
    s_add_u32 m0, s7, 16384
    s_add_u32 s12, s12, 12288
    s_addc_u32 s13, s13, 0
    global_load_lds_dwordx4 v0, s[12:13] sc1
    s_add_u32 m0, s7, 20480
    s_add_u32 s12, s12, 4096
    s_addc_u32 s13, s13, 0
    global_load_lds_dwordx4 v0, s[12:13] sc1
    s_add_u32 m0, s7, 24576
    s_add_u32 s12, s12, 12288
    s_addc_u32 s13, s13, 0
    global_load_lds_dwordx4 v0, s[12:13] sc1
    s_add_u32 m0, s7, 28672
    s_add_u32 s12, s12, 4096
    s_addc_u32 s13, s13, 0
    global_load_lds_dwordx4 v0, s[12:13] sc1
    s_waitcnt vmcnt(8)
    s_barrier
    s_cmp_lg_u32 s3, 3
    s_cbranch_scc1 P_nf_58j
    global_store_dword v8, v9, s[30:31] sc1
    s_branch P_nf_58j
P_nopre_59:
    s_lshl_b32 s7, s41, 12
    s_xor_b32 s7, s7, s98
    s_and_b32 s7, s7, 0x2000
    s_lshl_b32 s6, s41, 20
    s_add_u32 s6, s6, s7
    s_add_u32 s14, s20, s6
    s_addc_u32 s15, s21, 0
    global_load_dword v7, v1, s[14:15] sc1
    s_waitcnt vmcnt(1)
    s_barrier
    s_cmp_lg_u32 s3, 3
    s_cbranch_scc1 P_nf_58
    global_store_dword v8, v9, s[30:31] sc1
    s_waitcnt vmcnt(1)
    s_branch P_nf_58j
P_nf_58:
    s_waitcnt vmcnt(0)
P_nf_58j:
    s_mov_b32 s5, s41
    s_cmp_lt_u32 s5, 64
    s_cbranch_scc1 R3_loop
    s_branch R7_run
K_r6:
K_r6b:
    s_load_dwordx2 s[24:25], s[0:1], 72
    s_load_dwordx2 s[26:27], s[0:1], 80
    v_lshrrev_b32 v16, 4, v0
    s_mul_i32 s44, s4, 5958
    s_lshr_b32 s44, s44, 16
    s_mul_i32 s45, s44, 11
    s_sub_u32 s45, s4, s45
    s_lshl_b32 s44, s44, 2
    s_add_u32 s44, s44, s3
    s_lshl_b32 s44, s44, 2
    v_bfe_u32 v17, v16, 5, 1
    v_lshlrev_b32 v2, 6, v17
    v_xor_b32 v2, v2, v0
    s_and_b32 s6, s3, 1
    s_lshl_b32 s6, s6, 7
    v_xor_b32 v2, s6, v2
    s_lshl_b32 s6, s3, 10
    v_add_u32 v2, s6, v2
    v_bfe_u32 v17, v16, 0, 6
    v_lshlrev_b32 v3, 3, v17
    v_bfe_u32 v17, v16, 5, 1
    v_lshlrev_b32 v4, 7, v17
    v_bfe_u32 v17, v16, 2, 2
    v_lshl_add_u32 v4, v17, 4, v4
    v_bfe_u32 v17, v16, 0, 1
    v_lshlrev_b32 v5, 6, v17
    v_bfe_u32 v17, v16, 4, 1
    v_lshl_add_u32 v5, v17, 7, v5
    v_xor_b32 v4, v4, v5
    v_bfe_u32 v17, v16, 4, 1
    v_lshl_add_u32 v4, v17, 10, v4
    v_bfe_u32 v17, v16, 0, 1
    v_lshl_add_u32 v4, v17, 9, v4
    v_bfe_u32 v17, v16, 1, 1
    v_lshl_add_u32 v4, v17, 3, v4
    v_xor_b32 v5, 64, v4
    v_bfe_u32 v17, v16, 0, 3
    v_lshlrev_b32 v14, 4, v17
    v_bfe_u32 v17, v16, 4, 2
    v_lshlrev_b32 v15, 4, v17
    v_xor_b32 v14, v14, v15
    v_bfe_u32 v17, v16, 3, 3
    v_lshl_add_u32 v14, v17, 12, v14
    v_xor_b32 v15, 64, v14
    v_bfe_u32 v17, v16, 5, 1
    v_lshlrev_b32 v6, 4, v17
    v_bfe_u32 v17, v16, 1, 3
    v_lshlrev_b32 v8, 4, v17
    v_xor_b32 v6, v6, v8
    v_bfe_u32 v17, v16, 0, 5
    v_lshl_add_u32 v6, v17, 7, v6
    v_bfe_u32 v17, v16, 0, 5
    v_lshlrev_b32 v8, 1, v17
    s_add_u32 s40, s36, 8192
    s_lshl_b32 s46, s44, 17
    s_waitcnt lgkmcnt(0)
    s_mov_b32 s32, s24
    s_and_b32 s33, s25, 0xffff
    s_mov_b32 s34, 8388608
    s_mov_b32 s35, 0x20000
    s_add_u32 s41, s45, 11
    s_lshr_b32 s42, s41, 1
    s_mov_b32 s7, 84475904
    s_mul_i32 s6, s41, 4096
    s_add_u32 s7, s7, s6
    s_mul_i32 s6, s42, 8192
    s_add_u32 s7, s7, s6
    s_mul_i32 s6, s3, 1024
    s_add_u32 s7, s7, s6
    s_add_u32 s16, s10, s7
    s_addc_u32 s17, s11, 0
    s_lshr_b32 s42, s45, 1
    s_mov_b32 s7, 84475904
    s_mul_i32 s6, s45, 4096
    s_add_u32 s7, s7, s6
    s_mul_i32 s6, s42, 8192
    s_add_u32 s7, s7, s6
    s_add_u32 s56, s10, s7
    s_addc_u32 s57, s11, 0
    s_mov_b32 s7, 84755712
    s_add_u32 s20, s10, s7
    s_addc_u32 s21, s11, 0
    s_mov_b32 s7, 84756480
    s_add_u32 s54, s10, s7
    s_addc_u32 s55, s11, 0
    s_mov_b32 s7, 0
    s_mul_i32 s6, s44, 64
    s_add_u32 s7, s7, s6
    s_add_u32 s12, s26, s7
    s_addc_u32 s13, s27, 0
    s_mov_b32 s7, 84656128
    s_mul_i32 s6, s45, 4096
    s_add_u32 s7, s7, s6
    s_add_u32 s18, s10, s7
    s_addc_u32 s19, s11, 0
    s_mov_b32 s7, 84755840
    s_mul_i32 s6, s45, 4
    s_add_u32 s7, s7, s6
    s_add_u32 s30, s10, s7
    s_addc_u32 s31, s11, 0
    s_mov_b64 s[22:23], 0x7ff
    global_load_ushort v20, v8, s[12:13] offset:0
    global_load_ushort v21, v8, s[12:13] offset:64
    global_load_ushort v22, v8, s[12:13] offset:128
    global_load_ushort v23, v8, s[12:13] offset:192
    s_xor_b32 s7, s40, 0
    s_add_u32 m0, s7, 0
    s_add_u32 s37, s46, 0
    buffer_load_dwordx4 v14, s[32:35], s37 offen lds
    s_add_u32 m0, s7, 1024
    s_add_u32 s37, s46, 32768
    buffer_load_dwordx4 v15, s[32:35], s37 offen lds
    s_add_u32 m0, s7, 2048
    s_add_u32 s37, s46, 65536
    buffer_load_dwordx4 v14, s[32:35], s37 offen lds
    s_add_u32 m0, s7, 3072
    s_add_u32 s37, s46, 98304
    buffer_load_dwordx4 v15, s[32:35], s37 offen lds
    s_add_u32 m0, s7, 4096
    s_add_u32 s37, s46, 131072
    buffer_load_dwordx4 v14, s[32:35], s37 offen lds
    s_add_u32 m0, s7, 5120
    s_add_u32 s37, s46, 163840
    buffer_load_dwordx4 v15, s[32:35], s37 offen lds
    s_add_u32 m0, s7, 6144
    s_add_u32 s37, s46, 196608
    buffer_load_dwordx4 v14, s[32:35], s37 offen lds
    s_add_u32 m0, s7, 7168
    s_add_u32 s37, s46, 229376
    buffer_load_dwordx4 v15, s[32:35], s37 offen lds
    s_xor_b32 s7, s40, 0
    s_add_u32 m0, s7, 8192
    s_add_u32 s37, s46, 262144
    buffer_load_dwordx4 v14, s[32:35], s37 offen lds
    s_add_u32 m0, s7, 9216
    s_add_u32 s37, s46, 294912
    buffer_load_dwordx4 v15, s[32:35], s37 offen lds
    s_add_u32 m0, s7, 10240
    s_add_u32 s37, s46, 327680
    buffer_load_dwordx4 v14, s[32:35], s37 offen lds
    s_add_u32 m0, s7, 11264
    s_add_u32 s37, s46, 360448
    buffer_load_dwordx4 v15, s[32:35], s37 offen lds
    s_add_u32 m0, s7, 12288
    s_add_u32 s37, s46, 393216
    buffer_load_dwordx4 v14, s[32:35], s37 offen lds
    s_add_u32 m0, s7, 13312
    s_add_u32 s37, s46, 425984
    buffer_load_dwordx4 v15, s[32:35], s37 offen lds
    s_add_u32 m0, s7, 14336
    s_add_u32 s37, s46, 458752
    buffer_load_dwordx4 v14, s[32:35], s37 offen lds
    s_add_u32 m0, s7, 15360
    s_add_u32 s37, s46, 491520
    buffer_load_dwordx4 v15, s[32:35], s37 offen lds
    s_add_u32 s46, s46, 128
    s_waitcnt vmcnt(16)
    v_lshlrev_b32 v20, 16, v20
    v_mov_b32 v128, v20
    v_mov_b32 v129, v20
    v_mov_b32 v130, v20
    v_mov_b32 v131, v20
    v_mov_b32 v132, v20
    v_mov_b32 v133, v20
    v_mov_b32 v134, v20
    v_mov_b32 v135, v20
    v_mov_b32 v136, v20
    v_mov_b32 v137, v20
    v_mov_b32 v138, v20
    v_mov_b32 v139, v20
    v_mov_b32 v140, v20
    v_mov_b32 v141, v20
    v_mov_b32 v142, v20
    v_mov_b32 v143, v20
    v_mov_b32 v144, v20
    v_mov_b32 v145, v20
    v_mov_b32 v146, v20
    v_mov_b32 v147, v20
    v_mov_b32 v148, v20
    v_mov_b32 v149, v20
    v_mov_b32 v150, v20
    v_mov_b32 v151, v20
    v_mov_b32 v152, v20
    v_mov_b32 v153, v20
    v_mov_b32 v154, v20
    v_mov_b32 v155, v20
    v_mov_b32 v156, v20
    v_mov_b32 v157, v20
    v_mov_b32 v158, v20
    v_mov_b32 v159, v20
    v_lshlrev_b32 v21, 16, v21
    v_mov_b32 v160, v21
    v_mov_b32 v161, v21
    v_mov_b32 v162, v21
    v_mov_b32 v163, v21
    v_mov_b32 v164, v21
    v_mov_b32 v165, v21
    v_mov_b32 v166, v21
    v_mov_b32 v167, v21
    v_mov_b32 v168, v21
    v_mov_b32 v169, v21
    v_mov_b32 v170, v21
    v_mov_b32 v171, v21
    v_mov_b32 v172, v21
    v_mov_b32 v173, v21
    v_mov_b32 v174, v21
    v_mov_b32 v175, v21
    v_mov_b32 v176, v21
    v_mov_b32 v177, v21
    v_mov_b32 v178, v21
    v_mov_b32 v179, v21
    v_mov_b32 v180, v21
    v_mov_b32 v181, v21
    v_mov_b32 v182, v21
    v_mov_b32 v183, v21
    v_mov_b32 v184, v21
    v_mov_b32 v185, v21
    v_mov_b32 v186, v21
    v_mov_b32 v187, v21
    v_mov_b32 v188, v21
    v_mov_b32 v189, v21
    v_mov_b32 v190, v21
    v_mov_b32 v191, v21
    v_lshlrev_b32 v22, 16, v22
    v_mov_b32 v192, v22
    v_mov_b32 v193, v22
    v_mov_b32 v194, v22
    v_mov_b32 v195, v22
    v_mov_b32 v196, v22
    v_mov_b32 v197, v22
    v_mov_b32 v198, v22
    v_mov_b32 v199, v22
    v_mov_b32 v200, v22
    v_mov_b32 v201, v22
    v_mov_b32 v202, v22
    v_mov_b32 v203, v22
    v_mov_b32 v204, v22
    v_mov_b32 v205, v22
    v_mov_b32 v206, v22
    v_mov_b32 v207, v22
    v_mov_b32 v208, v22
    v_mov_b32 v209, v22
    v_mov_b32 v210, v22
    v_mov_b32 v211, v22
    v_mov_b32 v212, v22
    v_mov_b32 v213, v22
    v_mov_b32 v214, v22
    v_mov_b32 v215, v22
    v_mov_b32 v216, v22
    v_mov_b32 v217, v22
    v_mov_b32 v218, v22
    v_mov_b32 v219, v22
    v_mov_b32 v220, v22
    v_mov_b32 v221, v22
    v_mov_b32 v222, v22
    v_mov_b32 v223, v22
    v_lshlrev_b32 v23, 16, v23
    v_mov_b32 v224, v23
    v_mov_b32 v225, v23
    v_mov_b32 v226, v23
    v_mov_b32 v227, v23
    v_mov_b32 v228, v23
    v_mov_b32 v229, v23
    v_mov_b32 v230, v23
    v_mov_b32 v231, v23
    v_mov_b32 v232, v23
    v_mov_b32 v233, v23
    v_mov_b32 v234, v23
    v_mov_b32 v235, v23
    v_mov_b32 v236, v23
    v_mov_b32 v237, v23
    v_mov_b32 v238, v23
    v_mov_b32 v239, v23
    v_mov_b32 v240, v23
    v_mov_b32 v241, v23
    v_mov_b32 v242, v23
    v_mov_b32 v243, v23
    v_mov_b32 v244, v23
    v_mov_b32 v245, v23
    v_mov_b32 v246, v23
    v_mov_b32 v247, v23
    v_mov_b32 v248, v23
    v_mov_b32 v249, v23
    v_mov_b32 v250, v23
    v_mov_b32 v251, v23
    v_mov_b32 v252, v23
    v_mov_b32 v253, v23
    v_mov_b32 v254, v23
    v_mov_b32 v255, v23
    s_mov_b32 s5, 0
    s_load_dwordx2 s[12:13], s[0:1], 104
    v_mov_b32 v8, 32
    s_mov_b32 s8, 800000
    s_waitcnt lgkmcnt(0)
I_w_60:
    global_load_dword v9, v8, s[12:13] sc1
    s_waitcnt vmcnt(0)
    v_cmp_le_u32 vcc, 128, v9
    s_cbranch_vccnz I_d_61
    s_sleep 4
    s_sub_u32 s8, s8, 1
    s_cbranch_scc0 I_w_60
I_d_61:
    s_load_dwordx2 s[12:13], s[0:1], 104
    v_mov_b32 v8, 36
    s_mov_b32 s8, 800000
    s_waitcnt lgkmcnt(0)
I_w_62:
    global_load_dword v9, v8, s[12:13] sc1
    s_waitcnt vmcnt(0)
    v_cmp_le_u32 vcc, 1, v9
    s_cbranch_vccnz I_d_63
    s_sleep 4
    s_sub_u32 s8, s8, 1
    s_cbranch_scc0 I_w_62
I_d_63:
    v_readfirstlane_b32 s97, v9
    s_nop 3
    s_lshl_b32 s97, s97, 13
    s_and_b32 s97, s97, 0x2000
    s_xor_b32 s96, s97, 0x2000
    s_mov_b32 s98, s96
    s_lshl_b32 s7, s5, 12
    s_xor_b32 s7, s7, s98
    s_and_b32 s7, s7, 0x2000
    s_lshl_b32 s6, s5, 20
    s_add_u32 s6, s6, s7
    s_add_u32 s14, s20, s6
    s_addc_u32 s15, s21, 0
    global_load_dword v7, v1, s[14:15] sc1
    s_waitcnt vmcnt(0)
    s_add_u32 s41, s44, 0
    s_lshl_b32 s6, s41, 12
    s_xor_b32 s6, s6, s96
    s_and_b32 s6, s6, 0x2000
    s_lshl_b32 s48, s41, 20
    s_add_u32 s48, s48, s6
    s_lshl_b32 s6, s41, 20
    v_add_u32 v52, s6, v0
    s_add_u32 s41, s44, 1
    s_lshl_b32 s6, s41, 12
    s_xor_b32 s6, s6, s96
    s_and_b32 s6, s6, 0x2000
    s_lshl_b32 s49, s41, 20
    s_add_u32 s49, s49, s6
    s_lshl_b32 s6, s41, 20
    v_add_u32 v53, s6, v0
    s_add_u32 s41, s44, 2
    s_lshl_b32 s6, s41, 12
    s_xor_b32 s6, s6, s96
    s_and_b32 s6, s6, 0x2000
    s_lshl_b32 s50, s41, 20
    s_add_u32 s50, s50, s6
    s_lshl_b32 s6, s41, 20
    v_add_u32 v54, s6, v0
    s_add_u32 s41, s44, 3
    s_lshl_b32 s6, s41, 12
    s_xor_b32 s6, s6, s96
    s_and_b32 s6, s6, 0x2000
    s_lshl_b32 s51, s41, 20
    s_add_u32 s51, s51, s6
    s_lshl_b32 s6, s41, 20
    v_add_u32 v55, s6, v0
    s_mov_b32 s72, s18
    s_and_b32 s73, s19, 0xffff
    s_mov_b32 s75, 0x20000
    s_mov_b32 s74, 0
    s_branch R6_gate
R6_back:
    s_mov_b32 s74, 68157440
R6_loop:
    s_waitcnt vmcnt(0)
    v_add_u32 v10, s40, v6
    v_xor_b32 v11, 32, v10
    ds_read_b128 a[176:179], v10 offset:0
    ds_read_b128 a[180:183], v11 offset:0
    ds_read_b128 a[184:187], v10 offset:4096
    ds_read_b128 a[188:191], v11 offset:4096
    ds_read_b128 a[192:195], v10 offset:8192
    ds_read_b128 a[196:199], v11 offset:8192
    ds_read_b128 a[200:203], v10 offset:12288
    ds_read_b128 a[204:207], v11 offset:12288
    s_mov_b32 s8, 800000
P_w_64:
    v_cmp_ne_u32 s[28:29], 0, v7
    s_nop 3
    s_andn2_b64 s[28:29], s[22:23], s[28:29]
    s_cbranch_scc0 P_d_65
    s_sleep 1
    global_load_dword v7, v1, s[14:15] sc1
    s_sub_u32 s8, s8, 1
    s_waitcnt vmcnt(0)
    s_cbranch_scc0 P_w_64
P_d_65:
    s_lshl_b32 s7, s5, 12
    s_xor_b32 s7, s7, s96
    s_and_b32 s7, s7, 0x2000
    s_lshl_b32 s6, s5, 20
    s_add_u32 s6, s6, s7
    s_add_u32 s12, s16, s6
    s_addc_u32 s13, s17, 0
    global_load_dwordx4 v[32:35], v0, s[12:13] sc1
    s_lshl_b32 s7, s5, 12
    s_xor_b32 s7, s7, s96
    s_and_b32 s7, s7, 0x2000
    s_lshl_b32 s6, s5, 20
    s_add_u32 s6, s6, s7
    s_add_u32 s12, s54, s6
    s_addc_u32 s13, s55, 0
    global_load_dwordx2 v[56:57], v3, s[12:13] offset:0 sc1
    global_load_dwordx2 v[58:59], v3, s[12:13] offset:512 sc1
    global_load_dwordx2 v[60:61], v3, s[12:13] offset:1024 sc1
    s_sub_u32 s42, s5, s44
    s_cmp_ge_u32 s42, 4
    s_cbranch_scc1 R6_nz_66
    s_lshl_b32 s7, s5, 12
    s_xor_b32 s7, s7, s96
    s_and_b32 s7, s7, 0x2000
    s_lshl_b32 s6, s5, 20
    s_add_u32 s6, s6, s7
    s_add_u32 s12, s56, s6
    s_addc_u32 s13, s57, 0
    s_cmp_lg_u32 s42, 0
    s_cbranch_scc1 R6_nj_68
    global_load_dwordx4 v[64:67], v0, s[12:13] offset:0 sc1
    global_load_dwordx4 v[68:71], v0, s[12:13] offset:1024 sc1
    global_load_dwordx4 v[72:75], v0, s[12:13] offset:2048 sc1
    global_load_dwordx4 v[76:79], v0, s[12:13] offset:3072 sc1
    s_waitcnt vmcnt(4)
    s_branch R6_jz_67
R6_nj_68:
    s_cmp_lg_u32 s42, 1
    s_cbranch_scc1 R6_nj_69
    global_load_dwordx4 v[80:83], v0, s[12:13] offset:0 sc1
    global_load_dwordx4 v[84:87], v0, s[12:13] offset:1024 sc1
    global_load_dwordx4 v[88:91], v0, s[12:13] offset:2048 sc1
    global_load_dwordx4 v[92:95], v0, s[12:13] offset:3072 sc1
    s_waitcnt vmcnt(4)
    s_branch R6_jz_67
R6_nj_69:
    s_cmp_lg_u32 s42, 2
    s_cbranch_scc1 R6_nj_70
    global_load_dwordx4 v[96:99], v0, s[12:13] offset:0 sc1
    global_load_dwordx4 v[100:103], v0, s[12:13] offset:1024 sc1
    global_load_dwordx4 v[104:107], v0, s[12:13] offset:2048 sc1
    global_load_dwordx4 v[108:111], v0, s[12:13] offset:3072 sc1
    s_waitcnt vmcnt(4)
    s_branch R6_jz_67
R6_nj_70:
    s_cmp_lg_u32 s42, 3
    s_cbranch_scc1 R6_nj_71
    global_load_dwordx4 v[112:115], v0, s[12:13] offset:0 sc1
    global_load_dwordx4 v[116:119], v0, s[12:13] offset:1024 sc1
    global_load_dwordx4 v[120:123], v0, s[12:13] offset:2048 sc1
    global_load_dwordx4 v[124:127], v0, s[12:13] offset:3072 sc1
    s_waitcnt vmcnt(4)
    s_branch R6_jz_67
R6_nj_71:
R6_nz_66:
    s_waitcnt vmcnt(0)
R6_jz_67:
    v_pk_add_f32 v[36:37], v[56:57], v[58:59]
    v_pk_add_f32 v[36:37], v[36:37], v[60:61]
    v_mov_b64 v[56:57], v[36:37]
    v_lshlrev_b32 v40, 16, v32
    v_and_b32 v41, 0xffff0000, v32
    v_lshlrev_b32 v42, 16, v33
    v_and_b32 v43, 0xffff0000, v33
    v_lshlrev_b32 v44, 16, v34
    v_and_b32 v45, 0xffff0000, v34
    v_lshlrev_b32 v46, 16, v35
    v_and_b32 v47, 0xffff0000, v35
    v_permlane32_swap_b32 v36, v56
    v_permlane32_swap_b32 v37, v57
    v_pk_add_f32 v[36:37], v[36:37], v[56:57]
    v_mul_f32 v48, 0x3abe82fa, v36
    v_mul_f32 v50, 0x3abe82fa, v37
    v_fma_f32 v50, -v48, v48, v50
    v_max_f32 v50, 0, v50
    v_cvt_pk_bf16_f32 v36, v48, v50
    v_lshlrev_b32 v48, 16, v36
    v_and_b32 v50, 0xffff0000, v36
    v_add_f32 v50, 0x3727c5ac, v50
    v_cvt_pk_bf16_f32 v50, v50, v50
    v_and_b32 v50, 0xffff0000, v50
    v_sqrt_f32 v50, v50
    s_nop 0
    v_cvt_pk_bf16_f32 v50, v50, v50
    v_and_b32 v50, 0xffff0000, v50
    v_rcp_f32 v50, v50
    v_pk_add_f32 v[40:41], v[40:41], v[48:49] op_sel_hi:[1,0] neg_lo:[0,1] neg_hi:[0,1]
    v_pk_add_f32 v[42:43], v[42:43], v[48:49] op_sel_hi:[1,0] neg_lo:[0,1] neg_hi:[0,1]
    v_pk_add_f32 v[44:45], v[44:45], v[48:49] op_sel_hi:[1,0] neg_lo:[0,1] neg_hi:[0,1]
    v_pk_add_f32 v[46:47], v[46:47], v[48:49] op_sel_hi:[1,0] neg_lo:[0,1] neg_hi:[0,1]
    v_cvt_pk_bf16_f32 v32, v40, v41
    v_cvt_pk_bf16_f32 v33, v42, v43
    v_cvt_pk_bf16_f32 v34, v44, v45
    v_cvt_pk_bf16_f32 v35, v46, v47
    v_lshlrev_b32 v40, 16, v32
    v_and_b32 v41, 0xffff0000, v32
    v_lshlrev_b32 v42, 16, v33
    v_and_b32 v43, 0xffff0000, v33
    v_lshlrev_b32 v44, 16, v34
    v_and_b32 v45, 0xffff0000, v34
    v_lshlrev_b32 v46, 16, v35
    v_and_b32 v47, 0xffff0000, v35
    v_pk_mul_f32 v[40:41], v[40:41], v[50:51] op_sel_hi:[1,0]
    v_pk_mul_f32 v[42:43], v[42:43], v[50:51] op_sel_hi:[1,0]
    v_pk_mul_f32 v[44:45], v[44:45], v[50:51] op_sel_hi:[1,0]
    v_pk_mul_f32 v[46:47], v[46:47], v[50:51] op_sel_hi:[1,0]
    v_cvt_pk_bf16_f32 v32, v40, v41
    v_cvt_pk_bf16_f32 v33, v42, v43
    v_cvt_pk_bf16_f32 v34, v44, v45
    v_cvt_pk_bf16_f32 v35, v46, v47
    ds_write_b128 v2, v[32:35] offset:0
    s_waitcnt lgkmcnt(0)
    s_barrier
    ds_read_b64_tr_b16 v[16:17], v4 offset:0
    ds_read_b64_tr_b16 v[18:19], v5 offset:0
    ds_read_b64_tr_b16 v[24:25], v4 offset:2048
    ds_read_b64_tr_b16 v[26:27], v5 offset:2048
    ds_read_b64_tr_b16 v[20:21], v4 offset:256
    ds_read_b64_tr_b16 v[22:23], v5 offset:256
    ds_read_b64_tr_b16 v[28:29], v4 offset:2304
    ds_read_b64_tr_b16 v[30:31], v5 offset:2304
    s_waitcnt lgkmcnt(6)
    v_mfma_f32_32x32x16_bf16 v[128:143], v[16:19], a[176:179], v[128:143]
    s_waitcnt lgkmcnt(4)
    v_mfma_f32_32x32x16_bf16 v[144:159], v[24:27], a[176:179], v[144:159]
    s_waitcnt lgkmcnt(2)
    v_mfma_f32_32x32x16_bf16 v[128:143], v[20:23], a[180:183], v[128:143]
    s_waitcnt lgkmcnt(0)
    v_mfma_f32_32x32x16_bf16 v[144:159], v[28:31], a[180:183], v[144:159]
    s_cmp_ge_u32 s5, 62
    s_cbranch_scc1 R6_nw_72
    s_xor_b32 s7, s40, 16384
    s_add_u32 m0, s7, 0
    s_add_u32 s37, s46, 0
    buffer_load_dwordx4 v14, s[32:35], s37 offen lds
    s_add_u32 m0, s7, 1024
    s_add_u32 s37, s46, 32768
    buffer_load_dwordx4 v15, s[32:35], s37 offen lds
    s_add_u32 m0, s7, 2048
    s_add_u32 s37, s46, 65536
    buffer_load_dwordx4 v14, s[32:35], s37 offen lds
    s_add_u32 m0, s7, 3072
    s_add_u32 s37, s46, 98304
    buffer_load_dwordx4 v15, s[32:35], s37 offen lds
    s_add_u32 m0, s7, 4096
    s_add_u32 s37, s46, 131072
    buffer_load_dwordx4 v14, s[32:35], s37 offen lds
    s_add_u32 m0, s7, 5120
    s_add_u32 s37, s46, 163840
    buffer_load_dwordx4 v15, s[32:35], s37 offen lds
    s_add_u32 m0, s7, 6144
    s_add_u32 s37, s46, 196608
    buffer_load_dwordx4 v14, s[32:35], s37 offen lds
    s_add_u32 m0, s7, 7168
    s_add_u32 s37, s46, 229376
    buffer_load_dwordx4 v15, s[32:35], s37 offen lds
R6_nw_72:
    s_add_u32 s41, s5, 1
    s_lshl_b32 s7, s41, 12
    s_xor_b32 s7, s7, s98
    s_and_b32 s7, s7, 0x2000
    s_lshl_b32 s6, s41, 20
    s_add_u32 s6, s6, s7
    s_add_u32 s14, s20, s6
    s_addc_u32 s15, s21, 0
    global_load_dword v7, v1, s[14:15] sc1
    v_mfma_f32_32x32x16_bf16 v[160:175], v[16:19], a[184:187], v[160:175]
    v_mfma_f32_32x32x16_bf16 v[176:191], v[24:27], a[184:187], v[176:191]
    v_mfma_f32_32x32x16_bf16 v[160:175], v[20:23], a[188:191], v[160:175]
    v_mfma_f32_32x32x16_bf16 v[176:191], v[28:31], a[188:191], v[176:191]
    v_mfma_f32_32x32x16_bf16 v[192:207], v[16:19], a[192:195], v[192:207]
    v_mfma_f32_32x32x16_bf16 v[208:223], v[24:27], a[192:195], v[208:223]
    v_mfma_f32_32x32x16_bf16 v[192:207], v[20:23], a[196:199], v[192:207]
    v_mfma_f32_32x32x16_bf16 v[208:223], v[28:31], a[196:199], v[208:223]
    v_mfma_f32_32x32x16_bf16 v[224:239], v[16:19], a[200:203], v[224:239]
    v_mfma_f32_32x32x16_bf16 v[240:255], v[24:27], a[200:203], v[240:255]
    v_mfma_f32_32x32x16_bf16 v[224:239], v[20:23], a[204:207], v[224:239]
    v_mfma_f32_32x32x16_bf16 v[240:255], v[28:31], a[204:207], v[240:255]
    s_add_u32 s5, s5, 1
    s_waitcnt vmcnt(0)
    v_add_u32 v10, s40, v6
    v_xor_b32 v11, 96, v10
    v_xor_b32 v10, 64, v10
    ds_read_b128 a[176:179], v10 offset:0
    ds_read_b128 a[180:183], v11 offset:0
    ds_read_b128 a[184:187], v10 offset:4096
    ds_read_b128 a[188:191], v11 offset:4096
    ds_read_b128 a[192:195], v10 offset:8192
    ds_read_b128 a[196:199], v11 offset:8192
    ds_read_b128 a[200:203], v10 offset:12288
    ds_read_b128 a[204:207], v11 offset:12288
    s_mov_b32 s8, 800000
P_w_73:
    v_cmp_ne_u32 s[28:29], 0, v7
    s_nop 3
    s_andn2_b64 s[28:29], s[22:23], s[28:29]
    s_cbranch_scc0 P_d_74
    s_sleep 1
    global_load_dword v7, v1, s[14:15] sc1
    s_sub_u32 s8, s8, 1
    s_waitcnt vmcnt(0)
    s_cbranch_scc0 P_w_73
P_d_74:
    s_lshl_b32 s7, s5, 12
    s_xor_b32 s7, s7, s96
    s_and_b32 s7, s7, 0x2000
    s_lshl_b32 s6, s5, 20
    s_add_u32 s6, s6, s7
    s_add_u32 s12, s16, s6
    s_addc_u32 s13, s17, 0
    global_load_dwordx4 v[32:35], v0, s[12:13] sc1
    s_lshl_b32 s7, s5, 12
    s_xor_b32 s7, s7, s96
    s_and_b32 s7, s7, 0x2000
    s_lshl_b32 s6, s5, 20
    s_add_u32 s6, s6, s7
    s_add_u32 s12, s54, s6
    s_addc_u32 s13, s55, 0
    global_load_dwordx2 v[56:57], v3, s[12:13] offset:0 sc1
    global_load_dwordx2 v[58:59], v3, s[12:13] offset:512 sc1
    global_load_dwordx2 v[60:61], v3, s[12:13] offset:1024 sc1
    s_sub_u32 s42, s5, s44
    s_cmp_ge_u32 s42, 4
    s_cbranch_scc1 R6_nz_75
    s_lshl_b32 s7, s5, 12
    s_xor_b32 s7, s7, s96
    s_and_b32 s7, s7, 0x2000
    s_lshl_b32 s6, s5, 20
    s_add_u32 s6, s6, s7
    s_add_u32 s12, s56, s6
    s_addc_u32 s13, s57, 0
    s_cmp_lg_u32 s42, 0
    s_cbranch_scc1 R6_nj_77
    global_load_dwordx4 v[64:67], v0, s[12:13] offset:0 sc1
    global_load_dwordx4 v[68:71], v0, s[12:13] offset:1024 sc1
    global_load_dwordx4 v[72:75], v0, s[12:13] offset:2048 sc1
    global_load_dwordx4 v[76:79], v0, s[12:13] offset:3072 sc1
    s_waitcnt vmcnt(4)
    s_branch R6_jz_76
R6_nj_77:
    s_cmp_lg_u32 s42, 1
    s_cbranch_scc1 R6_nj_78
    global_load_dwordx4 v[80:83], v0, s[12:13] offset:0 sc1
    global_load_dwordx4 v[84:87], v0, s[12:13] offset:1024 sc1
    global_load_dwordx4 v[88:91], v0, s[12:13] offset:2048 sc1
    global_load_dwordx4 v[92:95], v0, s[12:13] offset:3072 sc1
    s_waitcnt vmcnt(4)
    s_branch R6_jz_76
R6_nj_78:
    s_cmp_lg_u32 s42, 2
    s_cbranch_scc1 R6_nj_79
    global_load_dwordx4 v[96:99], v0, s[12:13] offset:0 sc1
    global_load_dwordx4 v[100:103], v0, s[12:13] offset:1024 sc1
    global_load_dwordx4 v[104:107], v0, s[12:13] offset:2048 sc1
    global_load_dwordx4 v[108:111], v0, s[12:13] offset:3072 sc1
    s_waitcnt vmcnt(4)
    s_branch R6_jz_76
R6_nj_79:
    s_cmp_lg_u32 s42, 3
    s_cbranch_scc1 R6_nj_80
    global_load_dwordx4 v[112:115], v0, s[12:13] offset:0 sc1
    global_load_dwordx4 v[116:119], v0, s[12:13] offset:1024 sc1
    global_load_dwordx4 v[120:123], v0, s[12:13] offset:2048 sc1
    global_load_dwordx4 v[124:127], v0, s[12:13] offset:3072 sc1
    s_waitcnt vmcnt(4)
    s_branch R6_jz_76
R6_nj_80:
R6_nz_75:
    s_waitcnt vmcnt(0)
R6_jz_76:
    v_pk_add_f32 v[36:37], v[56:57], v[58:59]
    v_pk_add_f32 v[36:37], v[36:37], v[60:61]
    v_mov_b64 v[56:57], v[36:37]
    v_lshlrev_b32 v40, 16, v32
    v_and_b32 v41, 0xffff0000, v32
    v_lshlrev_b32 v42, 16, v33
    v_and_b32 v43, 0xffff0000, v33
    v_lshlrev_b32 v44, 16, v34
    v_and_b32 v45, 0xffff0000, v34
    v_lshlrev_b32 v46, 16, v35
    v_and_b32 v47, 0xffff0000, v35
    v_permlane32_swap_b32 v36, v56
    v_permlane32_swap_b32 v37, v57
    v_pk_add_f32 v[36:37], v[36:37], v[56:57]
    v_mul_f32 v48, 0x3abe82fa, v36
    v_mul_f32 v50, 0x3abe82fa, v37
    v_fma_f32 v50, -v48, v48, v50
    v_max_f32 v50, 0, v50
    v_cvt_pk_bf16_f32 v36, v48, v50
    v_lshlrev_b32 v48, 16, v36
    v_and_b32 v50, 0xffff0000, v36
    v_add_f32 v50, 0x3727c5ac, v50
    v_cvt_pk_bf16_f32 v50, v50, v50
    v_and_b32 v50, 0xffff0000, v50
    v_sqrt_f32 v50, v50
    s_nop 0
    v_cvt_pk_bf16_f32 v50, v50, v50
    v_and_b32 v50, 0xffff0000, v50
    v_rcp_f32 v50, v50
    v_pk_add_f32 v[40:41], v[40:41], v[48:49] op_sel_hi:[1,0] neg_lo:[0,1] neg_hi:[0,1]
    v_pk_add_f32 v[42:43], v[42:43], v[48:49] op_sel_hi:[1,0] neg_lo:[0,1] neg_hi:[0,1]
    v_pk_add_f32 v[44:45], v[44:45], v[48:49] op_sel_hi:[1,0] neg_lo:[0,1] neg_hi:[0,1]
    v_pk_add_f32 v[46:47], v[46:47], v[48:49] op_sel_hi:[1,0] neg_lo:[0,1] neg_hi:[0,1]
    v_cvt_pk_bf16_f32 v32, v40, v41
    v_cvt_pk_bf16_f32 v33, v42, v43
    v_cvt_pk_bf16_f32 v34, v44, v45
    v_cvt_pk_bf16_f32 v35, v46, v47
    v_lshlrev_b32 v40, 16, v32
    v_and_b32 v41, 0xffff0000, v32
    v_lshlrev_b32 v42, 16, v33
    v_and_b32 v43, 0xffff0000, v33
    v_lshlrev_b32 v44, 16, v34
    v_and_b32 v45, 0xffff0000, v34
    v_lshlrev_b32 v46, 16, v35
    v_and_b32 v47, 0xffff0000, v35
    v_pk_mul_f32 v[40:41], v[40:41], v[50:51] op_sel_hi:[1,0]
    v_pk_mul_f32 v[42:43], v[42:43], v[50:51] op_sel_hi:[1,0]
    v_pk_mul_f32 v[44:45], v[44:45], v[50:51] op_sel_hi:[1,0]
    v_pk_mul_f32 v[46:47], v[46:47], v[50:51] op_sel_hi:[1,0]
    v_cvt_pk_bf16_f32 v32, v40, v41
    v_cvt_pk_bf16_f32 v33, v42, v43
    v_cvt_pk_bf16_f32 v34, v44, v45
    v_cvt_pk_bf16_f32 v35, v46, v47
    ds_write_b128 v2, v[32:35] offset:4096
    s_waitcnt lgkmcnt(0)
    s_barrier
    ds_read_b64_tr_b16 v[16:17], v4 offset:4096
    ds_read_b64_tr_b16 v[18:19], v5 offset:4096
    ds_read_b64_tr_b16 v[24:25], v4 offset:6144
    ds_read_b64_tr_b16 v[26:27], v5 offset:6144
    ds_read_b64_tr_b16 v[20:21], v4 offset:4352
    ds_read_b64_tr_b16 v[22:23], v5 offset:4352
    ds_read_b64_tr_b16 v[28:29], v4 offset:6400
    ds_read_b64_tr_b16 v[30:31], v5 offset:6400
    s_waitcnt lgkmcnt(6)
    v_mfma_f32_32x32x16_bf16 v[128:143], v[16:19], a[176:179], v[128:143]
    s_waitcnt lgkmcnt(4)
    v_mfma_f32_32x32x16_bf16 v[144:159], v[24:27], a[176:179], v[144:159]
    s_waitcnt lgkmcnt(2)
    v_mfma_f32_32x32x16_bf16 v[128:143], v[20:23], a[180:183], v[128:143]
    s_waitcnt lgkmcnt(0)
    v_mfma_f32_32x32x16_bf16 v[144:159], v[28:31], a[180:183], v[144:159]
    s_cmp_ge_u32 s5, 62
    s_cbranch_scc1 R6_nw_81
    s_xor_b32 s7, s40, 16384
    s_add_u32 m0, s7, 8192
    s_add_u32 s37, s46, 262144
    buffer_load_dwordx4 v14, s[32:35], s37 offen lds
    s_add_u32 m0, s7, 9216
    s_add_u32 s37, s46, 294912
    buffer_load_dwordx4 v15, s[32:35], s37 offen lds
    s_add_u32 m0, s7, 10240
    s_add_u32 s37, s46, 327680
    buffer_load_dwordx4 v14, s[32:35], s37 offen lds
    s_add_u32 m0, s7, 11264
    s_add_u32 s37, s46, 360448
    buffer_load_dwordx4 v15, s[32:35], s37 offen lds
    s_add_u32 m0, s7, 12288
    s_add_u32 s37, s46, 393216
    buffer_load_dwordx4 v14, s[32:35], s37 offen lds
    s_add_u32 m0, s7, 13312
    s_add_u32 s37, s46, 425984
    buffer_load_dwordx4 v15, s[32:35], s37 offen lds
    s_add_u32 m0, s7, 14336
    s_add_u32 s37, s46, 458752
    buffer_load_dwordx4 v14, s[32:35], s37 offen lds
    s_add_u32 m0, s7, 15360
    s_add_u32 s37, s46, 491520
    buffer_load_dwordx4 v15, s[32:35], s37 offen lds
R6_nw_81:
    s_add_u32 s41, s5, 1
    s_lshl_b32 s7, s41, 12
    s_xor_b32 s7, s7, s98
    s_and_b32 s7, s7, 0x2000
    s_lshl_b32 s6, s41, 20
    s_add_u32 s6, s6, s7
    s_add_u32 s14, s20, s6
    s_addc_u32 s15, s21, 0
    global_load_dword v7, v1, s[14:15] sc1
    v_mfma_f32_32x32x16_bf16 v[160:175], v[16:19], a[184:187], v[160:175]
    v_mfma_f32_32x32x16_bf16 v[176:191], v[24:27], a[184:187], v[176:191]
    v_mfma_f32_32x32x16_bf16 v[160:175], v[20:23], a[188:191], v[160:175]
    v_mfma_f32_32x32x16_bf16 v[176:191], v[28:31], a[188:191], v[176:191]
    v_mfma_f32_32x32x16_bf16 v[192:207], v[16:19], a[192:195], v[192:207]
    v_mfma_f32_32x32x16_bf16 v[208:223], v[24:27], a[192:195], v[208:223]
    v_mfma_f32_32x32x16_bf16 v[192:207], v[20:23], a[196:199], v[192:207]
    v_mfma_f32_32x32x16_bf16 v[208:223], v[28:31], a[196:199], v[208:223]
    v_mfma_f32_32x32x16_bf16 v[224:239], v[16:19], a[200:203], v[224:239]
    v_mfma_f32_32x32x16_bf16 v[240:255], v[24:27], a[200:203], v[240:255]
    v_mfma_f32_32x32x16_bf16 v[224:239], v[20:23], a[204:207], v[224:239]
    v_mfma_f32_32x32x16_bf16 v[240:255], v[28:31], a[204:207], v[240:255]
    s_add_u32 s5, s5, 1
    s_xor_b32 s40, s40, 16384
    s_add_u32 s46, s46, 128
    s_cmp_lt_u32 s5, 64
    s_cbranch_scc1 R6_loop
    v_mov_b32 v9, 1
    s_waitcnt vmcnt(1)
R6_gate:
    v_lshlrev_b32 v32, 16, v64
    v_and_b32 v33, 0xffff0000, v64
    v_lshlrev_b32 v34, 16, v65
    v_and_b32 v35, 0xffff0000, v65
    v_lshlrev_b32 v36, 16, v66
    v_and_b32 v37, 0xffff0000, v66
    v_lshlrev_b32 v38, 16, v67
    v_and_b32 v39, 0xffff0000, v67
    v_pk_mul_f32 v[32:33], v[32:33], v[128:129]
    v_pk_mul_f32 v[34:35], v[34:35], v[130:131]
    v_pk_mul_f32 v[36:37], v[36:37], v[132:133]
    v_pk_mul_f32 v[38:39], v[38:39], v[134:135]
    v_cvt_pk_bf16_f32 v64, v32, v33
    v_cvt_pk_bf16_f32 v65, v34, v35
    v_cvt_pk_bf16_f32 v66, v36, v37
    v_cvt_pk_bf16_f32 v67, v38, v39
    buffer_store_dwordx4 v[64:67], v52, s[72:75], 0 offen offset:0 sc1
    v_lshlrev_b32 v40, 16, v68
    v_and_b32 v41, 0xffff0000, v68
    v_lshlrev_b32 v42, 16, v69
    v_and_b32 v43, 0xffff0000, v69
    v_lshlrev_b32 v44, 16, v70
    v_and_b32 v45, 0xffff0000, v70
    v_lshlrev_b32 v46, 16, v71
    v_and_b32 v47, 0xffff0000, v71
    v_pk_mul_f32 v[40:41], v[40:41], v[136:137]
    v_pk_mul_f32 v[42:43], v[42:43], v[138:139]
    v_pk_mul_f32 v[44:45], v[44:45], v[140:141]
    v_pk_mul_f32 v[46:47], v[46:47], v[142:143]
    v_cvt_pk_bf16_f32 v68, v40, v41
    v_cvt_pk_bf16_f32 v69, v42, v43
    v_cvt_pk_bf16_f32 v70, v44, v45
    v_cvt_pk_bf16_f32 v71, v46, v47
    buffer_store_dwordx4 v[68:71], v52, s[72:75], 0 offen offset:1024 sc1
    v_lshlrev_b32 v32, 16, v72
    v_and_b32 v33, 0xffff0000, v72
    v_lshlrev_b32 v34, 16, v73
    v_and_b32 v35, 0xffff0000, v73
    v_lshlrev_b32 v36, 16, v74
    v_and_b32 v37, 0xffff0000, v74
    v_lshlrev_b32 v38, 16, v75
    v_and_b32 v39, 0xffff0000, v75
    v_pk_mul_f32 v[32:33], v[32:33], v[144:145]
    v_pk_mul_f32 v[34:35], v[34:35], v[146:147]
    v_pk_mul_f32 v[36:37], v[36:37], v[148:149]
    v_pk_mul_f32 v[38:39], v[38:39], v[150:151]
    v_cvt_pk_bf16_f32 v72, v32, v33
    v_cvt_pk_bf16_f32 v73, v34, v35
    v_cvt_pk_bf16_f32 v74, v36, v37
    v_cvt_pk_bf16_f32 v75, v38, v39
    buffer_store_dwordx4 v[72:75], v52, s[72:75], 0 offen offset:2048 sc1
    v_lshlrev_b32 v40, 16, v76
    v_and_b32 v41, 0xffff0000, v76
    v_lshlrev_b32 v42, 16, v77
    v_and_b32 v43, 0xffff0000, v77
    v_lshlrev_b32 v44, 16, v78
    v_and_b32 v45, 0xffff0000, v78
    v_lshlrev_b32 v46, 16, v79
    v_and_b32 v47, 0xffff0000, v79
    v_pk_mul_f32 v[40:41], v[40:41], v[152:153]
    v_pk_mul_f32 v[42:43], v[42:43], v[154:155]
    v_pk_mul_f32 v[44:45], v[44:45], v[156:157]
    v_pk_mul_f32 v[46:47], v[46:47], v[158:159]
    v_cvt_pk_bf16_f32 v76, v40, v41
    v_cvt_pk_bf16_f32 v77, v42, v43
    v_cvt_pk_bf16_f32 v78, v44, v45
    v_cvt_pk_bf16_f32 v79, v46, v47
    buffer_store_dwordx4 v[76:79], v52, s[72:75], 0 offen offset:3072 sc1
    v_lshlrev_b32 v32, 16, v80
    v_and_b32 v33, 0xffff0000, v80
    v_lshlrev_b32 v34, 16, v81
    v_and_b32 v35, 0xffff0000, v81
    v_lshlrev_b32 v36, 16, v82
    v_and_b32 v37, 0xffff0000, v82
    v_lshlrev_b32 v38, 16, v83
    v_and_b32 v39, 0xffff0000, v83
    v_pk_mul_f32 v[32:33], v[32:33], v[160:161]
    v_pk_mul_f32 v[34:35], v[34:35], v[162:163]
    v_pk_mul_f32 v[36:37], v[36:37], v[164:165]
    v_pk_mul_f32 v[38:39], v[38:39], v[166:167]
    v_cvt_pk_bf16_f32 v80, v32, v33
    v_cvt_pk_bf16_f32 v81, v34, v35
    v_cvt_pk_bf16_f32 v82, v36, v37
    v_cvt_pk_bf16_f32 v83, v38, v39
    buffer_store_dwordx4 v[80:83], v53, s[72:75], 0 offen offset:0 sc1
    v_lshlrev_b32 v40, 16, v84
    v_and_b32 v41, 0xffff0000, v84
    v_lshlrev_b32 v42, 16, v85
    v_and_b32 v43, 0xffff0000, v85
    v_lshlrev_b32 v44, 16, v86
    v_and_b32 v45, 0xffff0000, v86
    v_lshlrev_b32 v46, 16, v87
    v_and_b32 v47, 0xffff0000, v87
    v_pk_mul_f32 v[40:41], v[40:41], v[168:169]
    v_pk_mul_f32 v[42:43], v[42:43], v[170:171]
    v_pk_mul_f32 v[44:45], v[44:45], v[172:173]
    v_pk_mul_f32 v[46:47], v[46:47], v[174:175]
    v_cvt_pk_bf16_f32 v84, v40, v41
    v_cvt_pk_bf16_f32 v85, v42, v43
    v_cvt_pk_bf16_f32 v86, v44, v45
    v_cvt_pk_bf16_f32 v87, v46, v47
    buffer_store_dwordx4 v[84:87], v53, s[72:75], 0 offen offset:1024 sc1
    v_lshlrev_b32 v32, 16, v88
    v_and_b32 v33, 0xffff0000, v88
    v_lshlrev_b32 v34, 16, v89
    v_and_b32 v35, 0xffff0000, v89
    v_lshlrev_b32 v36, 16, v90
    v_and_b32 v37, 0xffff0000, v90
    v_lshlrev_b32 v38, 16, v91
    v_and_b32 v39, 0xffff0000, v91
    v_pk_mul_f32 v[32:33], v[32:33], v[176:177]
    v_pk_mul_f32 v[34:35], v[34:35], v[178:179]
    v_pk_mul_f32 v[36:37], v[36:37], v[180:181]
    v_pk_mul_f32 v[38:39], v[38:39], v[182:183]
    v_cvt_pk_bf16_f32 v88, v32, v33
    v_cvt_pk_bf16_f32 v89, v34, v35
    v_cvt_pk_bf16_f32 v90, v36, v37
    v_cvt_pk_bf16_f32 v91, v38, v39
    buffer_store_dwordx4 v[88:91], v53, s[72:75], 0 offen offset:2048 sc1
    v_lshlrev_b32 v40, 16, v92
    v_and_b32 v41, 0xffff0000, v92
    v_lshlrev_b32 v42, 16, v93
    v_and_b32 v43, 0xffff0000, v93
    v_lshlrev_b32 v44, 16, v94
    v_and_b32 v45, 0xffff0000, v94
    v_lshlrev_b32 v46, 16, v95
    v_and_b32 v47, 0xffff0000, v95
    v_pk_mul_f32 v[40:41], v[40:41], v[184:185]
    v_pk_mul_f32 v[42:43], v[42:43], v[186:187]
    v_pk_mul_f32 v[44:45], v[44:45], v[188:189]
    v_pk_mul_f32 v[46:47], v[46:47], v[190:191]
    v_cvt_pk_bf16_f32 v92, v40, v41
    v_cvt_pk_bf16_f32 v93, v42, v43
    v_cvt_pk_bf16_f32 v94, v44, v45
    v_cvt_pk_bf16_f32 v95, v46, v47
    buffer_store_dwordx4 v[92:95], v53, s[72:75], 0 offen offset:3072 sc1
    v_lshlrev_b32 v32, 16, v96
    v_and_b32 v33, 0xffff0000, v96
    v_lshlrev_b32 v34, 16, v97
    v_and_b32 v35, 0xffff0000, v97
    v_lshlrev_b32 v36, 16, v98
    v_and_b32 v37, 0xffff0000, v98
    v_lshlrev_b32 v38, 16, v99
    v_and_b32 v39, 0xffff0000, v99
    v_pk_mul_f32 v[32:33], v[32:33], v[192:193]
    v_pk_mul_f32 v[34:35], v[34:35], v[194:195]
    v_pk_mul_f32 v[36:37], v[36:37], v[196:197]
    v_pk_mul_f32 v[38:39], v[38:39], v[198:199]
    v_cvt_pk_bf16_f32 v96, v32, v33
    v_cvt_pk_bf16_f32 v97, v34, v35
    v_cvt_pk_bf16_f32 v98, v36, v37
    v_cvt_pk_bf16_f32 v99, v38, v39
    buffer_store_dwordx4 v[96:99], v54, s[72:75], 0 offen offset:0 sc1
    v_lshlrev_b32 v40, 16, v100
    v_and_b32 v41, 0xffff0000, v100
    v_lshlrev_b32 v42, 16, v101
    v_and_b32 v43, 0xffff0000, v101
    v_lshlrev_b32 v44, 16, v102
    v_and_b32 v45, 0xffff0000, v102
    v_lshlrev_b32 v46, 16, v103
    v_and_b32 v47, 0xffff0000, v103
    v_pk_mul_f32 v[40:41], v[40:41], v[200:201]
    v_pk_mul_f32 v[42:43], v[42:43], v[202:203]
    v_pk_mul_f32 v[44:45], v[44:45], v[204:205]
    v_pk_mul_f32 v[46:47], v[46:47], v[206:207]
    v_cvt_pk_bf16_f32 v100, v40, v41
    v_cvt_pk_bf16_f32 v101, v42, v43
    v_cvt_pk_bf16_f32 v102, v44, v45
    v_cvt_pk_bf16_f32 v103, v46, v47
    buffer_store_dwordx4 v[100:103], v54, s[72:75], 0 offen offset:1024 sc1
    v_lshlrev_b32 v32, 16, v104
    v_and_b32 v33, 0xffff0000, v104
    v_lshlrev_b32 v34, 16, v105
    v_and_b32 v35, 0xffff0000, v105
    v_lshlrev_b32 v36, 16, v106
    v_and_b32 v37, 0xffff0000, v106
    v_lshlrev_b32 v38, 16, v107
    v_and_b32 v39, 0xffff0000, v107
    v_pk_mul_f32 v[32:33], v[32:33], v[208:209]
    v_pk_mul_f32 v[34:35], v[34:35], v[210:211]
    v_pk_mul_f32 v[36:37], v[36:37], v[212:213]
    v_pk_mul_f32 v[38:39], v[38:39], v[214:215]
    v_cvt_pk_bf16_f32 v104, v32, v33
    v_cvt_pk_bf16_f32 v105, v34, v35
    v_cvt_pk_bf16_f32 v106, v36, v37
    v_cvt_pk_bf16_f32 v107, v38, v39
    buffer_store_dwordx4 v[104:107], v54, s[72:75], 0 offen offset:2048 sc1
    v_lshlrev_b32 v40, 16, v108
    v_and_b32 v41, 0xffff0000, v108
    v_lshlrev_b32 v42, 16, v109
    v_and_b32 v43, 0xffff0000, v109
    v_lshlrev_b32 v44, 16, v110
    v_and_b32 v45, 0xffff0000, v110
    v_lshlrev_b32 v46, 16, v111
    v_and_b32 v47, 0xffff0000, v111
    v_pk_mul_f32 v[40:41], v[40:41], v[216:217]
    v_pk_mul_f32 v[42:43], v[42:43], v[218:219]
    v_pk_mul_f32 v[44:45], v[44:45], v[220:221]
    v_pk_mul_f32 v[46:47], v[46:47], v[222:223]
    v_cvt_pk_bf16_f32 v108, v40, v41
    v_cvt_pk_bf16_f32 v109, v42, v43
    v_cvt_pk_bf16_f32 v110, v44, v45
    v_cvt_pk_bf16_f32 v111, v46, v47
    buffer_store_dwordx4 v[108:111], v54, s[72:75], 0 offen offset:3072 sc1
    v_lshlrev_b32 v32, 16, v112
    v_and_b32 v33, 0xffff0000, v112
    v_lshlrev_b32 v34, 16, v113
    v_and_b32 v35, 0xffff0000, v113
    v_lshlrev_b32 v36, 16, v114
    v_and_b32 v37, 0xffff0000, v114
    v_lshlrev_b32 v38, 16, v115
    v_and_b32 v39, 0xffff0000, v115
    v_pk_mul_f32 v[32:33], v[32:33], v[224:225]
    v_pk_mul_f32 v[34:35], v[34:35], v[226:227]
    v_pk_mul_f32 v[36:37], v[36:37], v[228:229]
    v_pk_mul_f32 v[38:39], v[38:39], v[230:231]
    v_cvt_pk_bf16_f32 v112, v32, v33
    v_cvt_pk_bf16_f32 v113, v34, v35
    v_cvt_pk_bf16_f32 v114, v36, v37
    v_cvt_pk_bf16_f32 v115, v38, v39
    buffer_store_dwordx4 v[112:115], v55, s[72:75], 0 offen offset:0 sc1
    v_lshlrev_b32 v40, 16, v116
    v_and_b32 v41, 0xffff0000, v116
    v_lshlrev_b32 v42, 16, v117
    v_and_b32 v43, 0xffff0000, v117
    v_lshlrev_b32 v44, 16, v118
    v_and_b32 v45, 0xffff0000, v118
    v_lshlrev_b32 v46, 16, v119
    v_and_b32 v47, 0xffff0000, v119
    v_pk_mul_f32 v[40:41], v[40:41], v[232:233]
    v_pk_mul_f32 v[42:43], v[42:43], v[234:235]
    v_pk_mul_f32 v[44:45], v[44:45], v[236:237]
    v_pk_mul_f32 v[46:47], v[46:47], v[238:239]
    v_cvt_pk_bf16_f32 v116, v40, v41
    v_cvt_pk_bf16_f32 v117, v42, v43
    v_cvt_pk_bf16_f32 v118, v44, v45
    v_cvt_pk_bf16_f32 v119, v46, v47
    buffer_store_dwordx4 v[116:119], v55, s[72:75], 0 offen offset:1024 sc1
    v_lshlrev_b32 v32, 16, v120
    v_and_b32 v33, 0xffff0000, v120
    v_lshlrev_b32 v34, 16, v121
    v_and_b32 v35, 0xffff0000, v121
    v_lshlrev_b32 v36, 16, v122
    v_and_b32 v37, 0xffff0000, v122
    v_lshlrev_b32 v38, 16, v123
    v_and_b32 v39, 0xffff0000, v123
    v_pk_mul_f32 v[32:33], v[32:33], v[240:241]
    v_pk_mul_f32 v[34:35], v[34:35], v[242:243]
    v_pk_mul_f32 v[36:37], v[36:37], v[244:245]
    v_pk_mul_f32 v[38:39], v[38:39], v[246:247]
    v_cvt_pk_bf16_f32 v120, v32, v33
    v_cvt_pk_bf16_f32 v121, v34, v35
    v_cvt_pk_bf16_f32 v122, v36, v37
    v_cvt_pk_bf16_f32 v123, v38, v39
    buffer_store_dwordx4 v[120:123], v55, s[72:75], 0 offen offset:2048 sc1
    v_lshlrev_b32 v40, 16, v124
    v_and_b32 v41, 0xffff0000, v124
    v_lshlrev_b32 v42, 16, v125
    v_and_b32 v43, 0xffff0000, v125
    v_lshlrev_b32 v44, 16, v126
    v_and_b32 v45, 0xffff0000, v126
    v_lshlrev_b32 v46, 16, v127
    v_and_b32 v47, 0xffff0000, v127
    v_pk_mul_f32 v[40:41], v[40:41], v[248:249]
    v_pk_mul_f32 v[42:43], v[42:43], v[250:251]
    v_pk_mul_f32 v[44:45], v[44:45], v[252:253]
    v_pk_mul_f32 v[46:47], v[46:47], v[254:255]
    v_cvt_pk_bf16_f32 v124, v40, v41
    v_cvt_pk_bf16_f32 v125, v42, v43
    v_cvt_pk_bf16_f32 v126, v44, v45
    v_cvt_pk_bf16_f32 v127, v46, v47
    buffer_store_dwordx4 v[124:127], v55, s[72:75], 0 offen offset:3072 sc1
    s_cmp_eq_u32 s5, 0
    s_cbranch_scc1 R6_back
    v_mov_b32 v8, s48
    s_waitcnt vmcnt(12)
    global_store_dword v8, v9, s[30:31] sc1
    v_mov_b32 v8, s49
    s_waitcnt vmcnt(9)
    global_store_dword v8, v9, s[30:31] sc1
    v_mov_b32 v8, s50
    s_waitcnt vmcnt(6)
    global_store_dword v8, v9, s[30:31] sc1
    v_mov_b32 v8, s51
    s_waitcnt vmcnt(3)
    global_store_dword v8, v9, s[30:31] sc1
    s_mov_b32 s62, 0
    s_branch R7_any
K_r4:
    s_load_dwordx2 s[24:25], s[0:1], 0
    v_lshrrev_b32 v16, 4, v0
    v_bfe_u32 v17, v16, 0, 2
    v_lshlrev_b32 v3, 10, v17
    v_bfe_u32 v17, v16, 2, 4
    v_lshl_add_u32 v3, v17, 4, v3
    v_bfe_u32 v17, v16, 0, 2
    v_lshlrev_b32 v5, 5, v17
    s_lshl_b32 s6, s3, 3
    v_add_u32 v4, s6, v5
    s_waitcnt lgkmcnt(0)
    s_mov_b32 s7, 155189248
    s_mul_i32 s6, s4, 65536
    s_add_u32 s7, s7, s6
    s_mul_i32 s6, s3, 1024
    s_add_u32 s7, s7, s6
    s_add_u32 s16, s10, s7
    s_addc_u32 s17, s11, 0
    s_lshr_b32 s42, s4, 1
    s_mov_b32 s7, 84410368
    s_mul_i32 s6, s4, 4096
    s_add_u32 s7, s7, s6
    s_mul_i32 s6, s42, 8192
    s_add_u32 s7, s7, s6
    s_mul_i32 s6, s3, 1024
    s_add_u32 s7, s7, s6
    s_add_u32 s18, s10, s7
    s_addc_u32 s19, s11, 0
    s_mov_b32 s7, 0
    s_mul_i32 s6, s4, 4096
    s_add_u32 s7, s7, s6
    s_mul_i32 s6, s3, 256
    s_add_u32 s7, s7, s6
    s_add_u32 s26, s24, s7
    s_addc_u32 s27, s25, 0
    s_mov_b32 s7, 84755456
    s_add_u32 s20, s10, s7
    s_addc_u32 s21, s11, 0
    s_mov_b32 s7, 84755584
    s_mul_i32 s6, s4, 4
    s_add_u32 s7, s7, s6
    s_add_u32 s30, s10, s7
    s_addc_u32 s31, s11, 0
    s_mov_b64 s[22:23], -1
    s_load_dwordx2 s[12:13], s[0:1], 104
    v_mov_b32 v8, 32
    s_mov_b32 s8, 800000
    s_waitcnt lgkmcnt(0)
I_w_82:
    global_load_dword v9, v8, s[12:13] sc1
    s_waitcnt vmcnt(0)
    v_cmp_le_u32 vcc, 128, v9
    s_cbranch_vccnz I_d_83
    s_sleep 4
    s_sub_u32 s8, s8, 1
    s_cbranch_scc0 I_w_82
I_d_83:
    s_load_dwordx2 s[12:13], s[0:1], 104
    v_mov_b32 v8, 36
    s_mov_b32 s8, 800000
    s_waitcnt lgkmcnt(0)
I_w_84:
    global_load_dword v9, v8, s[12:13] sc1
    s_waitcnt vmcnt(0)
    v_cmp_le_u32 vcc, 1, v9
    s_cbranch_vccnz I_d_85
    s_sleep 4
    s_sub_u32 s8, s8, 1
    s_cbranch_scc0 I_w_84
I_d_85:
    v_readfirstlane_b32 s97, v9
    s_nop 3
    s_lshl_b32 s97, s97, 13
    s_and_b32 s97, s97, 0x2000
    s_xor_b32 s96, s97, 0x2000
    s_mov_b32 s98, s96
    s_lshl_b32 s7, s5, 12
    s_xor_b32 s7, s7, s98
    s_and_b32 s7, s7, 0x2000
    s_lshl_b32 s6, s5, 20
    s_add_u32 s6, s6, s7
    s_add_u32 s14, s20, s6
    s_addc_u32 s15, s21, 0
    global_load_dword v7, v1, s[14:15] sc1
    s_waitcnt vmcnt(0)
R4_loop:
    s_mul_i32 s6, s5, 32768
    s_add_u32 s12, s26, s6
    s_addc_u32 s13, s27, 0
    global_load_dwordx4 v[16:19], v3, s[12:13]
    s_mov_b32 s8, 800000
P_w_86:
    v_cmp_ne_u32 s[28:29], 0, v7
    s_nop 3
    s_andn2_b64 s[28:29], s[22:23], s[28:29]
    s_cbranch_scc0 P_d_87
    s_sleep 1
    global_load_dword v7, v1, s[14:15] sc1
    s_sub_u32 s8, s8, 1
    s_waitcnt vmcnt(0)
    s_cbranch_scc0 P_w_86
P_d_87:
    s_lshl_b32 s7, s5, 12
    s_xor_b32 s7, s7, s97
    s_and_b32 s7, s7, 0x2000
    s_lshl_b32 s6, s5, 20
    s_add_u32 s6, s6, s7
    s_add_u32 s12, s16, s6
    s_addc_u32 s13, s17, 0
    global_load_dwordx4 v[20:23], v0, s[12:13] sc1
    s_add_u32 s12, s12, 4096
    s_addc_u32 s13, s13, 0
    global_load_dwordx4 v[24:27], v0, s[12:13] sc1
    s_add_u32 s12, s12, 12288
    s_addc_u32 s13, s13, 0
    global_load_dwordx4 v[28:31], v0, s[12:13] sc1
    s_add_u32 s12, s12, 4096
    s_addc_u32 s13, s13, 0
    global_load_dwordx4 v[32:35], v0, s[12:13] sc1
    s_add_u32 s12, s12, 12288
    s_addc_u32 s13, s13, 0
    global_load_dwordx4 v[36:39], v0, s[12:13] sc1
    s_add_u32 s12, s12, 4096
    s_addc_u32 s13, s13, 0
    global_load_dwordx4 v[40:43], v0, s[12:13] sc1
    s_add_u32 s12, s12, 12288
    s_addc_u32 s13, s13, 0
    global_load_dwordx4 v[44:47], v0, s[12:13] sc1
    s_add_u32 s12, s12, 4096
    s_addc_u32 s13, s13, 0
    global_load_dwordx4 v[48:51], v0, s[12:13] sc1
    s_lshl_b32 s7, s5, 12
    s_xor_b32 s7, s7, s96
    s_and_b32 s7, s7, 0x2000
    s_lshl_b32 s6, s5, 20
    s_add_u32 s6, s6, s7
    s_add_u32 s12, s18, s6
    s_addc_u32 s13, s19, 0
    s_add_u32 s12, s12, 360448
    s_addc_u32 s13, s13, 0
    s_waitcnt vmcnt(7)
    v_lshlrev_b32 v52, 16, v20
    v_and_b32 v53, 0xffff0000, v20
    v_lshlrev_b32 v54, 16, v21
    v_and_b32 v55, 0xffff0000, v21
    v_lshlrev_b32 v56, 16, v22
    v_and_b32 v57, 0xffff0000, v22
    v_lshlrev_b32 v58, 16, v23
    v_and_b32 v59, 0xffff0000, v23
    s_waitcnt vmcnt(6)
    v_lshlrev_b32 v60, 16, v24
    v_and_b32 v61, 0xffff0000, v24
    v_lshlrev_b32 v62, 16, v25
    v_and_b32 v63, 0xffff0000, v25
    v_lshlrev_b32 v64, 16, v26
    v_and_b32 v65, 0xffff0000, v26
    v_lshlrev_b32 v66, 16, v27
    v_and_b32 v67, 0xffff0000, v27
    v_pk_add_f32 v[52:53], v[52:53], v[60:61]
    v_pk_add_f32 v[54:55], v[54:55], v[62:63]
    v_pk_add_f32 v[56:57], v[56:57], v[64:65]
    v_pk_add_f32 v[58:59], v[58:59], v[66:67]
    s_waitcnt vmcnt(5)
    v_lshlrev_b32 v60, 16, v28
    v_and_b32 v61, 0xffff0000, v28
    v_lshlrev_b32 v62, 16, v29
    v_and_b32 v63, 0xffff0000, v29
    v_lshlrev_b32 v64, 16, v30
    v_and_b32 v65, 0xffff0000, v30
    v_lshlrev_b32 v66, 16, v31
    v_and_b32 v67, 0xffff0000, v31
    v_pk_add_f32 v[52:53], v[52:53], v[60:61]
    v_pk_add_f32 v[54:55], v[54:55], v[62:63]
    v_pk_add_f32 v[56:57], v[56:57], v[64:65]
    v_pk_add_f32 v[58:59], v[58:59], v[66:67]
    s_waitcnt vmcnt(4)
    v_lshlrev_b32 v60, 16, v32
    v_and_b32 v61, 0xffff0000, v32
    v_lshlrev_b32 v62, 16, v33
    v_and_b32 v63, 0xffff0000, v33
    v_lshlrev_b32 v64, 16, v34
    v_and_b32 v65, 0xffff0000, v34
    v_lshlrev_b32 v66, 16, v35
    v_and_b32 v67, 0xffff0000, v35
    v_pk_add_f32 v[52:53], v[52:53], v[60:61]
    v_pk_add_f32 v[54:55], v[54:55], v[62:63]
    v_pk_add_f32 v[56:57], v[56:57], v[64:65]
    v_pk_add_f32 v[58:59], v[58:59], v[66:67]
    s_waitcnt vmcnt(3)
    v_lshlrev_b32 v60, 16, v36
    v_and_b32 v61, 0xffff0000, v36
    v_lshlrev_b32 v62, 16, v37
    v_and_b32 v63, 0xffff0000, v37
    v_lshlrev_b32 v64, 16, v38
    v_and_b32 v65, 0xffff0000, v38
    v_lshlrev_b32 v66, 16, v39
    v_and_b32 v67, 0xffff0000, v39
    v_pk_add_f32 v[52:53], v[52:53], v[60:61]
    v_pk_add_f32 v[54:55], v[54:55], v[62:63]
    v_pk_add_f32 v[56:57], v[56:57], v[64:65]
    v_pk_add_f32 v[58:59], v[58:59], v[66:67]
    s_waitcnt vmcnt(2)
    v_lshlrev_b32 v60, 16, v40
    v_and_b32 v61, 0xffff0000, v40
    v_lshlrev_b32 v62, 16, v41
    v_and_b32 v63, 0xffff0000, v41
    v_lshlrev_b32 v64, 16, v42
    v_and_b32 v65, 0xffff0000, v42
    v_lshlrev_b32 v66, 16, v43
    v_and_b32 v67, 0xffff0000, v43
    v_pk_add_f32 v[52:53], v[52:53], v[60:61]
    v_pk_add_f32 v[54:55], v[54:55], v[62:63]
    v_pk_add_f32 v[56:57], v[56:57], v[64:65]
    v_pk_add_f32 v[58:59], v[58:59], v[66:67]
    s_waitcnt vmcnt(1)
    v_lshlrev_b32 v60, 16, v44
    v_and_b32 v61, 0xffff0000, v44
    v_lshlrev_b32 v62, 16, v45
    v_and_b32 v63, 0xffff0000, v45
    v_lshlrev_b32 v64, 16, v46
    v_and_b32 v65, 0xffff0000, v46
    v_lshlrev_b32 v66, 16, v47
    v_and_b32 v67, 0xffff0000, v47
    v_pk_add_f32 v[52:53], v[52:53], v[60:61]
    v_pk_add_f32 v[54:55], v[54:55], v[62:63]
    v_pk_add_f32 v[56:57], v[56:57], v[64:65]
    v_pk_add_f32 v[58:59], v[58:59], v[66:67]
    s_waitcnt vmcnt(0)
    v_lshlrev_b32 v60, 16, v48
    v_and_b32 v61, 0xffff0000, v48
    v_lshlrev_b32 v62, 16, v49
    v_and_b32 v63, 0xffff0000, v49
    v_lshlrev_b32 v64, 16, v50
    v_and_b32 v65, 0xffff0000, v50
    v_lshlrev_b32 v66, 16, v51
    v_and_b32 v67, 0xffff0000, v51
    v_pk_add_f32 v[52:53], v[52:53], v[60:61]
    v_pk_add_f32 v[54:55], v[54:55], v[62:63]
    v_pk_add_f32 v[56:57], v[56:57], v[64:65]
    v_pk_add_f32 v[58:59], v[58:59], v[66:67]
    v_cvt_pk_bf16_f32 v20, v52, v53
    v_cvt_pk_bf16_f32 v21, v54, v55
    v_cvt_pk_bf16_f32 v22, v56, v57
    v_cvt_pk_bf16_f32 v23, v58, v59
    v_lshlrev_b32 v52, 16, v20
    v_and_b32 v53, 0xffff0000, v20
    v_lshlrev_b32 v54, 16, v21
    v_and_b32 v55, 0xffff0000, v21
    v_lshlrev_b32 v56, 16, v22
    v_and_b32 v57, 0xffff0000, v22
    v_lshlrev_b32 v58, 16, v23
    v_and_b32 v59, 0xffff0000, v23
    v_lshlrev_b32 v60, 16, v16
    v_and_b32 v61, 0xffff0000, v16
    v_lshlrev_b32 v62, 16, v17
    v_and_b32 v63, 0xffff0000, v17
    v_lshlrev_b32 v64, 16, v18
    v_and_b32 v65, 0xffff0000, v18
    v_lshlrev_b32 v66, 16, v19
    v_and_b32 v67, 0xffff0000, v19
    v_pk_add_f32 v[52:53], v[52:53], v[60:61]
    v_pk_add_f32 v[54:55], v[54:55], v[62:63]
    v_pk_add_f32 v[56:57], v[56:57], v[64:65]
    v_pk_add_f32 v[58:59], v[58:59], v[66:67]
    v_cvt_pk_bf16_f32 v24, v52, v53
    v_cvt_pk_bf16_f32 v25, v54, v55
    v_cvt_pk_bf16_f32 v26, v56, v57
    v_cvt_pk_bf16_f32 v27, v58, v59
    global_store_dwordx4 v0, v[24:27], s[12:13] sc1
    v_lshlrev_b32 v52, 16, v24
    v_and_b32 v53, 0xffff0000, v24
    v_lshlrev_b32 v54, 16, v25
    v_and_b32 v55, 0xffff0000, v25
    v_lshlrev_b32 v56, 16, v26
    v_and_b32 v57, 0xffff0000, v26
    v_lshlrev_b32 v58, 16, v27
    v_and_b32 v59, 0xffff0000, v27
    v_pk_add_f32 v[60:61], v[52:53], v[54:55]
    v_pk_mul_f32 v[62:63], v[52:53], v[52:53]
    v_pk_fma_f32 v[62:63], v[54:55], v[54:55], v[62:63]
    v_pk_fma_f32 v[62:63], v[56:57], v[56:57], v[62:63]
    v_pk_fma_f32 v[62:63], v[58:59], v[58:59], v[62:63]
    v_pk_add_f32 v[60:61], v[60:61], v[56:57]
    v_pk_add_f32 v[60:61], v[60:61], v[58:59]
    v_add_f32 v69, v62, v63
    v_add_f32 v68, v60, v61
    s_nop 0
    v_add_f32_dpp v69, v69, v69 row_ror:4 row_mask:0xf bank_mask:0xf
    v_add_f32_dpp v68, v68, v68 row_ror:4 row_mask:0xf bank_mask:0xf
    s_nop 0
    v_add_f32_dpp v69, v69, v69 row_ror:8 row_mask:0xf bank_mask:0xf
    v_add_f32_dpp v68, v68, v68 row_ror:8 row_mask:0xf bank_mask:0xf
    v_mov_b64 v[60:61], v[68:69]
    s_nop 1
    v_permlane16_swap_b32 v68, v60
    v_permlane16_swap_b32 v69, v61
    v_pk_add_f32 v[68:69], v[68:69], v[60:61]
    v_mov_b64 v[60:61], v[68:69]
    s_nop 1
    v_permlane32_swap_b32 v68, v60
    v_permlane32_swap_b32 v69, v61
    v_pk_add_f32 v[68:69], v[68:69], v[60:61]
    ds_write_b64 v4, v[68:69]
    s_lshl_b32 s7, s5, 12
    s_xor_b32 s7, s7, s96
    s_and_b32 s7, s7, 0x2000
    s_lshl_b32 s6, s5, 20
    s_add_u32 s6, s6, s7
    s_add_u32 s12, s18, s6
    s_addc_u32 s13, s19, 0
    s_waitcnt lgkmcnt(0)
    s_barrier
    ds_read_b128 v[60:63], v5
    ds_read_b128 v[64:67], v5 offset:16
    s_waitcnt lgkmcnt(0)
    v_pk_add_f32 v[60:61], v[60:61], v[62:63]
    v_pk_add_f32 v[64:65], v[64:65], v[66:67]
    v_pk_add_f32 v[68:69], v[60:61], v[64:65]
    v_mul_f32 v78, 0x3b000000, v68
    v_mul_f32 v80, 0x3b000000, v69
    v_fma_f32 v80, -v78, v78, v80
    v_max_f32 v80, 0, v80
    v_cvt_pk_bf16_f32 v68, v78, v80
    v_lshlrev_b32 v78, 16, v68
    v_and_b32 v80, 0xffff0000, v68
    v_add_f32 v80, 0x3727c5ac, v80
    v_cvt_pk_bf16_f32 v80, v80, v80
    v_and_b32 v80, 0xffff0000, v80
    v_sqrt_f32 v80, v80
    s_nop 0
    v_cvt_pk_bf16_f32 v80, v80, v80
    v_and_b32 v80, 0xffff0000, v80
    v_rcp_f32 v80, v80
    v_pk_add_f32 v[52:53], v[52:53], v[78:79] op_sel_hi:[1,0] neg_lo:[0,1] neg_hi:[0,1]
    v_pk_add_f32 v[54:55], v[54:55], v[78:79] op_sel_hi:[1,0] neg_lo:[0,1] neg_hi:[0,1]
    v_pk_add_f32 v[56:57], v[56:57], v[78:79] op_sel_hi:[1,0] neg_lo:[0,1] neg_hi:[0,1]
    v_pk_add_f32 v[58:59], v[58:59], v[78:79] op_sel_hi:[1,0] neg_lo:[0,1] neg_hi:[0,1]
    v_cvt_pk_bf16_f32 v28, v52, v53
    v_cvt_pk_bf16_f32 v29, v54, v55
    v_cvt_pk_bf16_f32 v30, v56, v57
    v_cvt_pk_bf16_f32 v31, v58, v59
    v_lshlrev_b32 v52, 16, v28
    v_and_b32 v53, 0xffff0000, v28
    v_lshlrev_b32 v54, 16, v29
    v_and_b32 v55, 0xffff0000, v29
    v_lshlrev_b32 v56, 16, v30
    v_and_b32 v57, 0xffff0000, v30
    v_lshlrev_b32 v58, 16, v31
    v_and_b32 v59, 0xffff0000, v31
    v_pk_mul_f32 v[52:53], v[52:53], v[80:81] op_sel_hi:[1,0]
    v_pk_mul_f32 v[54:55], v[54:55], v[80:81] op_sel_hi:[1,0]
    v_pk_mul_f32 v[56:57], v[56:57], v[80:81] op_sel_hi:[1,0]
    v_pk_mul_f32 v[58:59], v[58:59], v[80:81] op_sel_hi:[1,0]
    v_cvt_pk_bf16_f32 v28, v52, v53
    v_cvt_pk_bf16_f32 v29, v54, v55
    v_cvt_pk_bf16_f32 v30, v56, v57
    v_cvt_pk_bf16_f32 v31, v58, v59
    global_store_dwordx4 v0, v[28:31], s[12:13] sc1
    s_add_u32 s41, s5, 2
    s_lshl_b32 s7, s5, 12
    s_xor_b32 s7, s7, s96
    s_and_b32 s7, s7, 0x2000
    s_lshl_b32 s6, s5, 20
    s_add_u32 s6, s6, s7
    v_mov_b32 v8, s6
    v_mov_b32 v9, 1
    s_lshl_b32 s7, s41, 12
    s_xor_b32 s7, s7, s98
    s_and_b32 s7, s7, 0x2000
    s_lshl_b32 s6, s41, 20
    s_add_u32 s6, s6, s7
    s_add_u32 s14, s20, s6
    s_addc_u32 s15, s21, 0
    global_load_dword v7, v1, s[14:15] sc1
    s_waitcnt vmcnt(1)
    s_barrier
    s_cmp_lg_u32 s3, 3
    s_cbranch_scc1 P_nf_88
    global_store_dword v8, v9, s[30:31] sc1
    s_waitcnt vmcnt(1)
    s_branch P_nf_88j
P_nf_88:
    s_waitcnt vmcnt(0)
P_nf_88j:
    s_mov_b32 s5, s41
    s_cmp_lt_u32 s5, 64
    s_cbranch_scc1 R4_loop
    s_branch R7_run
K_r5:
    s_load_dwordx2 s[24:25], s[0:1], 64
    v_lshrrev_b32 v16, 4, v0
    v_bfe_u32 v17, v16, 0, 5
    v_lshlrev_b32 v2, 3, v17
    v_bfe_u32 v17, v16, 5, 1
    v_lshl_add_u32 v2, v17, 2, v2
    v_bfe_u32 v17, v16, 2, 1
    v_lshlrev_b32 v3, 12, v17
    v_bfe_u32 v17, v16, 3, 2
    v_lshl_add_u32 v3, v17, 14, v3
    v_bfe_u32 v17, v16, 5, 1
    v_lshl_add_u32 v3, v17, 6, v3
    v_bfe_u32 v17, v16, 0, 2
    v_lshl_add_u32 v3, v17, 4, v3
    s_lshl_b32 s44, s4, 2
    s_add_u32 s44, s44, s3
    s_lshl_b32 s38, s44, 6
    s_cmp_ge_u32 s44, 22
    s_cselect_b32 s6, 32, 0
    s_sub_u32 s38, s38, s6
    s_cmp_ge_u32 s44, 22
    s_cselect_b32 s47, -1, 0
    s_cmp_eq_u32 s44, 43
    s_cselect_b32 s46, 0, s47
    s_lshl_b32 s6, s3, 2
    s_add_u32 s6, s6, 65536
    v_add_u32 v14, s6, v0
    s_waitcnt lgkmcnt(0)
    s_mov_b32 s32, s24
    s_and_b32 s33, s25, 0xffff
    s_mov_b32 s34, 1409024
    s_mov_b32 s35, 0x20000
    s_mov_b32 s7, 84410368
    s_mul_i32 s6, s3, 128
    s_add_u32 s7, s7, s6
    s_add_u32 s16, s10, s7
    s_addc_u32 s17, s11, 0
    s_mov_b32 s7, 84475904
    s_mul_i32 s6, s4, 16384
    s_add_u32 s7, s7, s6
    s_mul_i32 s6, s3, 2048
    s_add_u32 s7, s7, s6
    s_add_u32 s18, s10, s7
    s_addc_u32 s19, s11, 0
    s_mov_b32 s7, 84755584
    s_add_u32 s20, s10, s7
    s_addc_u32 s21, s11, 0
    s_mov_b32 s7, 84755712
    s_mul_i32 s6, s4, 4
    s_add_u32 s7, s7, s6
    s_add_u32 s30, s10, s7
    s_addc_u32 s31, s11, 0
    s_mov_b32 s7, 84755200
    s_mul_i32 s6, s4, 256
    s_add_u32 s7, s7, s6
    s_add_u32 s48, s10, s7
    s_addc_u32 s49, s11, 0
    s_mov_b64 s[22:23], 0xff
    s_mov_b32 s39, 2752
    v_lshrrev_b32 v20, 2, v16
    v_mul_lo_u32 v18, v20, s39
    v_bfe_u32 v17, v16, 0, 2
    v_lshl_add_u32 v18, v17, 4, v18
    v_bfe_u32 v17, v16, 5, 1
    v_lshlrev_b32 v19, 9, v17
    v_bfe_u32 v17, v16, 2, 2
    v_lshl_add_u32 v19, v17, 6, v19
    v_bfe_u32 v17, v16, 4, 1
    v_lshl_add_u32 v19, v17, 5, v19
    v_bfe_u32 v17, v16, 0, 1
    v_lshl_add_u32 v19, v17, 4, v19
    v_bfe_u32 v17, v16, 1, 1
    v_lshl_add_u32 v19, v17, 3, v19
    v_add_u32 v19, s36, v19
    s_add_u32 m0, s36, 0
    s_add_u32 s37, s38, 0
    buffer_load_dwordx4 v18, s[32:35], s37 offen lds
    s_add_u32 m0, s36, 1024
    s_add_u32 s37, s38, 44032
    buffer_load_dwordx4 v18, s[32:35], s37 offen lds
    s_add_u32 m0, s36, 2048
    s_add_u32 s37, s38, 88064
    buffer_load_dwordx4 v18, s[32:35], s37 offen lds
    s_add_u32 m0, s36, 3072
    s_add_u32 s37, s38, 132096
    buffer_load_dwordx4 v18, s[32:35], s37 offen lds
    s_add_u32 m0, s36, 4096
    s_add_u32 s37, s38, 176128
    buffer_load_dwordx4 v18, s[32:35], s37 offen lds
    s_add_u32 m0, s36, 5120
    s_add_u32 s37, s38, 220160
    buffer_load_dwordx4 v18, s[32:35], s37 offen lds
    s_add_u32 m0, s36, 6144
    s_add_u32 s37, s38, 264192
    buffer_load_dwordx4 v18, s[32:35], s37 offen lds
    s_add_u32 m0, s36, 7168
    s_add_u32 s37, s38, 308224
    buffer_load_dwordx4 v18, s[32:35], s37 offen lds
    s_add_u32 m0, s36, 8192
    s_add_u32 s37, s38, 352256
    buffer_load_dwordx4 v18, s[32:35], s37 offen lds
    s_add_u32 m0, s36, 9216
    s_add_u32 s37, s38, 396288
    buffer_load_dwordx4 v18, s[32:35], s37 offen lds
    s_add_u32 m0, s36, 10240
    s_add_u32 s37, s38, 440320
    buffer_load_dwordx4 v18, s[32:35], s37 offen lds
    s_add_u32 m0, s36, 11264
    s_add_u32 s37, s38, 484352
    buffer_load_dwordx4 v18, s[32:35], s37 offen lds
    s_add_u32 m0, s36, 12288
    s_add_u32 s37, s38, 528384
    buffer_load_dwordx4 v18, s[32:35], s37 offen lds
    s_add_u32 m0, s36, 13312
    s_add_u32 s37, s38, 572416
    buffer_load_dwordx4 v18, s[32:35], s37 offen lds
    s_add_u32 m0, s36, 14336
    s_add_u32 s37, s38, 616448
    buffer_load_dwordx4 v18, s[32:35], s37 offen lds
    s_add_u32 m0, s36, 15360
    s_add_u32 s37, s38, 660480
    buffer_load_dwordx4 v18, s[32:35], s37 offen lds
    s_add_u32 m0, s36, 16384
    s_add_u32 s37, s38, 704512
    buffer_load_dwordx4 v18, s[32:35], s37 offen lds
    s_add_u32 m0, s36, 17408
    s_add_u32 s37, s38, 748544
    buffer_load_dwordx4 v18, s[32:35], s37 offen lds
    s_add_u32 m0, s36, 18432
    s_add_u32 s37, s38, 792576
    buffer_load_dwordx4 v18, s[32:35], s37 offen lds
    s_add_u32 m0, s36, 19456
    s_add_u32 s37, s38, 836608
    buffer_load_dwordx4 v18, s[32:35], s37 offen lds
    s_add_u32 m0, s36, 20480
    s_add_u32 s37, s38, 880640
    buffer_load_dwordx4 v18, s[32:35], s37 offen lds
    s_add_u32 m0, s36, 21504
    s_add_u32 s37, s38, 924672
    buffer_load_dwordx4 v18, s[32:35], s37 offen lds
    s_add_u32 m0, s36, 22528
    s_add_u32 s37, s38, 968704
    buffer_load_dwordx4 v18, s[32:35], s37 offen lds
    s_add_u32 m0, s36, 23552
    s_add_u32 s37, s38, 1012736
    buffer_load_dwordx4 v18, s[32:35], s37 offen lds
    s_add_u32 m0, s36, 24576
    s_add_u32 s37, s38, 1056768
    buffer_load_dwordx4 v18, s[32:35], s37 offen lds
    s_add_u32 m0, s36, 25600
    s_add_u32 s37, s38, 1100800
    buffer_load_dwordx4 v18, s[32:35], s37 offen lds
    s_add_u32 m0, s36, 26624
    s_add_u32 s37, s38, 1144832
    buffer_load_dwordx4 v18, s[32:35], s37 offen lds
    s_add_u32 m0, s36, 27648
    s_add_u32 s37, s38, 1188864
    buffer_load_dwordx4 v18, s[32:35], s37 offen lds
    s_add_u32 m0, s36, 28672
    s_add_u32 s37, s38, 1232896
    buffer_load_dwordx4 v18, s[32:35], s37 offen lds
    s_add_u32 m0, s36, 29696
    s_add_u32 s37, s38, 1276928
    buffer_load_dwordx4 v18, s[32:35], s37 offen lds
    s_add_u32 m0, s36, 30720
    s_add_u32 s37, s38, 1320960
    buffer_load_dwordx4 v18, s[32:35], s37 offen lds
    s_add_u32 m0, s36, 31744
    s_add_u32 s37, s38, 1364992
    buffer_load_dwordx4 v18, s[32:35], s37 offen lds
    s_waitcnt vmcnt(28)
    ds_read_b64_tr_b16 v[128:129], v19 offset:0
    ds_read_b64_tr_b16 v[130:131], v19 offset:256
    ds_read_b64_tr_b16 v[132:133], v19 offset:1024
    ds_read_b64_tr_b16 v[134:135], v19 offset:1280
    ds_read_b64_tr_b16 v[136:137], v19 offset:2048
    ds_read_b64_tr_b16 v[138:139], v19 offset:2304
    ds_read_b64_tr_b16 v[140:141], v19 offset:3072
    ds_read_b64_tr_b16 v[142:143], v19 offset:3328
    s_waitcnt lgkmcnt(0)
    s_waitcnt vmcnt(24)
    ds_read_b64_tr_b16 v[144:145], v19 offset:4096
    ds_read_b64_tr_b16 v[146:147], v19 offset:4352
    ds_read_b64_tr_b16 v[148:149], v19 offset:5120
    ds_read_b64_tr_b16 v[150:151], v19 offset:5376
    ds_read_b64_tr_b16 v[152:153], v19 offset:6144
    ds_read_b64_tr_b16 v[154:155], v19 offset:6400
    ds_read_b64_tr_b16 v[156:157], v19 offset:7168
    ds_read_b64_tr_b16 v[158:159], v19 offset:7424
    s_waitcnt lgkmcnt(0)
    s_waitcnt vmcnt(20)
    ds_read_b64_tr_b16 v[160:161], v19 offset:8192
    ds_read_b64_tr_b16 v[162:163], v19 offset:8448
    ds_read_b64_tr_b16 v[164:165], v19 offset:9216
    ds_read_b64_tr_b16 v[166:167], v19 offset:9472
    ds_read_b64_tr_b16 v[168:169], v19 offset:10240
    ds_read_b64_tr_b16 v[170:171], v19 offset:10496
    ds_read_b64_tr_b16 v[172:173], v19 offset:11264
    ds_read_b64_tr_b16 v[174:175], v19 offset:11520
    s_waitcnt lgkmcnt(0)
    s_waitcnt vmcnt(16)
    ds_read_b64_tr_b16 v[176:177], v19 offset:12288
    ds_read_b64_tr_b16 v[178:179], v19 offset:12544
    ds_read_b64_tr_b16 v[180:181], v19 offset:13312
    ds_read_b64_tr_b16 v[182:183], v19 offset:13568
    ds_read_b64_tr_b16 v[184:185], v19 offset:14336
    ds_read_b64_tr_b16 v[186:187], v19 offset:14592
    ds_read_b64_tr_b16 v[188:189], v19 offset:15360
    ds_read_b64_tr_b16 v[190:191], v19 offset:15616
    s_waitcnt lgkmcnt(0)
    s_waitcnt vmcnt(12)
    ds_read_b64_tr_b16 v[192:193], v19 offset:16384
    ds_read_b64_tr_b16 v[194:195], v19 offset:16640
    ds_read_b64_tr_b16 v[196:197], v19 offset:17408
    ds_read_b64_tr_b16 v[198:199], v19 offset:17664
    ds_read_b64_tr_b16 v[200:201], v19 offset:18432
    ds_read_b64_tr_b16 v[202:203], v19 offset:18688
    ds_read_b64_tr_b16 v[204:205], v19 offset:19456
    ds_read_b64_tr_b16 v[206:207], v19 offset:19712
    s_waitcnt lgkmcnt(0)
    s_waitcnt vmcnt(8)
    ds_read_b64_tr_b16 v[208:209], v19 offset:20480
    ds_read_b64_tr_b16 v[210:211], v19 offset:20736
    ds_read_b64_tr_b16 v[212:213], v19 offset:21504
    ds_read_b64_tr_b16 v[214:215], v19 offset:21760
    ds_read_b64_tr_b16 v[216:217], v19 offset:22528
    ds_read_b64_tr_b16 v[218:219], v19 offset:22784
    ds_read_b64_tr_b16 v[220:221], v19 offset:23552
    ds_read_b64_tr_b16 v[222:223], v19 offset:23808
    s_waitcnt lgkmcnt(0)
    s_waitcnt vmcnt(4)
    ds_read_b64_tr_b16 v[224:225], v19 offset:24576
    ds_read_b64_tr_b16 v[226:227], v19 offset:24832
    ds_read_b64_tr_b16 v[228:229], v19 offset:25600
    ds_read_b64_tr_b16 v[230:231], v19 offset:25856
    ds_read_b64_tr_b16 v[232:233], v19 offset:26624
    ds_read_b64_tr_b16 v[234:235], v19 offset:26880
    ds_read_b64_tr_b16 v[236:237], v19 offset:27648
    ds_read_b64_tr_b16 v[238:239], v19 offset:27904
    s_waitcnt lgkmcnt(0)
    s_waitcnt vmcnt(0)
    ds_read_b64_tr_b16 v[240:241], v19 offset:28672
    ds_read_b64_tr_b16 v[242:243], v19 offset:28928
    ds_read_b64_tr_b16 v[244:245], v19 offset:29696
    ds_read_b64_tr_b16 v[246:247], v19 offset:29952
    ds_read_b64_tr_b16 v[248:249], v19 offset:30720
    ds_read_b64_tr_b16 v[250:251], v19 offset:30976
    ds_read_b64_tr_b16 v[252:253], v19 offset:31744
    ds_read_b64_tr_b16 v[254:255], v19 offset:32000
    s_waitcnt lgkmcnt(0)
    s_barrier
    v_mov_b32 v4, 0xc0135761
    v_mov_b32 v5, 0xbdd2d3e8
    s_load_dwordx2 s[12:13], s[0:1], 104
    v_mov_b32 v8, 32
    s_mov_b32 s8, 800000
    s_waitcnt lgkmcnt(0)
I_w_89:
    global_load_dword v9, v8, s[12:13] sc1
    s_waitcnt vmcnt(0)
    v_cmp_le_u32 vcc, 128, v9
    s_cbranch_vccnz I_d_90
    s_sleep 4
    s_sub_u32 s8, s8, 1
    s_cbranch_scc0 I_w_89
I_d_90:
    s_load_dwordx2 s[12:13], s[0:1], 104
    v_mov_b32 v8, 36
    s_mov_b32 s8, 800000
    s_waitcnt lgkmcnt(0)
I_w_91:
    global_load_dword v9, v8, s[12:13] sc1
    s_waitcnt vmcnt(0)
    v_cmp_le_u32 vcc, 1, v9
    s_cbranch_vccnz I_d_92
    s_sleep 4
    s_sub_u32 s8, s8, 1
    s_cbranch_scc0 I_w_91
I_d_92:
    v_readfirstlane_b32 s97, v9
    s_nop 3
    s_lshl_b32 s97, s97, 13
    s_and_b32 s97, s97, 0x2000
    s_xor_b32 s96, s97, 0x2000
    s_mov_b32 s98, s96
    s_lshl_b32 s7, s5, 12
    s_xor_b32 s7, s7, s98
    s_and_b32 s7, s7, 0x2000
    s_lshl_b32 s6, s5, 20
    s_add_u32 s6, s6, s7
    s_add_u32 s14, s20, s6
    s_addc_u32 s15, s21, 0
    global_load_dword v7, v1, s[14:15] sc1
    s_waitcnt vmcnt(0)
    s_mov_b32 s40, 0
    s_mov_b32 s43, 0
R5_loop:
    s_cmp_lg_u32 s43, 0
    s_cbranch_scc1 P_have_93
    s_mov_b32 s8, 800000
P_w_94:
    v_cmp_ne_u32 s[28:29], 0, v7
    s_nop 3
    s_andn2_b64 s[28:29], s[22:23], s[28:29]
    s_cbranch_scc0 P_d_95
    s_sleep 1
    global_load_dword v7, v1, s[14:15] sc1
    s_sub_u32 s8, s8, 1
    s_waitcnt vmcnt(0)
    s_cbranch_scc0 P_w_94
P_d_95:
    s_lshl_b32 s7, s5, 12
    s_xor_b32 s7, s7, s98
    s_and_b32 s7, s7, 0x2000
    s_lshl_b32 s6, s5, 20
    s_add_u32 s6, s6, s7
    s_add_u32 s12, s16, s6
    s_addc_u32 s13, s17, 0
    s_lshl_b32 s7, s3, 10
    s_add_u32 s7, s7, s40
    s_add_u32 m0, s7, 0
    s_nop 0
    global_load_lds_dwordx4 v3, s[12:13] sc1
    s_add_u32 m0, s7, 4096
    s_add_u32 s12, s12, 512
    s_addc_u32 s13, s13, 0
    global_load_lds_dwordx4 v3, s[12:13] sc1
    s_add_u32 m0, s7, 8192
    s_add_u32 s12, s12, 512
    s_addc_u32 s13, s13, 0
    global_load_lds_dwordx4 v3, s[12:13] sc1
    s_add_u32 m0, s7, 12288
    s_add_u32 s12, s12, 512
    s_addc_u32 s13, s13, 0
    global_load_lds_dwordx4 v3, s[12:13] sc1
    s_add_u32 m0, s7, 16384
    s_add_u32 s12, s12, 512
    s_addc_u32 s13, s13, 0
    global_load_lds_dwordx4 v3, s[12:13] sc1
    s_add_u32 m0, s7, 20480
    s_add_u32 s12, s12, 512
    s_addc_u32 s13, s13, 0
    global_load_lds_dwordx4 v3, s[12:13] sc1
    s_add_u32 m0, s7, 24576
    s_add_u32 s12, s12, 512
    s_addc_u32 s13, s13, 0
    global_load_lds_dwordx4 v3, s[12:13] sc1
    s_add_u32 m0, s7, 28672
    s_add_u32 s12, s12, 512
    s_addc_u32 s13, s13, 0
    global_load_lds_dwordx4 v3, s[12:13] sc1
P_have_93:
    v_add_u32 v6, s40, v0
    s_add_u32 s41, s5, 2
    v_mov_b32 v7, 0
    s_waitcnt vmcnt(5)
    s_barrier
    ds_read_b128 v[16:19], v6 offset:0
    ds_read_b128 v[20:23], v6 offset:1024
    ds_read_b128 v[24:27], v6 offset:2048
    ds_read_b128 v[28:31], v6 offset:3072
    ds_read_b128 v[32:35], v6 offset:4096
    ds_read_b128 v[36:39], v6 offset:5120
    s_waitcnt lgkmcnt(5)
    v_mfma_f32_32x32x16_bf16 v[48:63], v[128:131], v[16:19], 0
    ds_read_b128 v[40:43], v6 offset:6144
    s_waitcnt lgkmcnt(5)
    v_mfma_f32_32x32x16_bf16 v[48:63], v[132:135], v[20:23], v[48:63]
    ds_read_b128 v[44:47], v6 offset:7168
    s_waitcnt lgkmcnt(5)
    v_mfma_f32_32x32x16_bf16 v[48:63], v[136:139], v[24:27], v[48:63]
    ds_read_b128 v[16:19], v6 offset:8192
    s_waitcnt lgkmcnt(5)
    v_mfma_f32_32x32x16_bf16 v[48:63], v[140:143], v[28:31], v[48:63]
    ds_read_b128 v[20:23], v6 offset:9216
    s_waitcnt lgkmcnt(5)
    v_mfma_f32_32x32x16_bf16 v[48:63], v[144:147], v[32:35], v[48:63]
    ds_read_b128 v[24:27], v6 offset:10240
    s_waitcnt lgkmcnt(5)
    v_mfma_f32_32x32x16_bf16 v[48:63], v[148:151], v[36:39], v[48:63]
    ds_read_b128 v[28:31], v6 offset:11264
    s_waitcnt lgkmcnt(5)
    v_mfma_f32_32x32x16_bf16 v[48:63], v[152:155], v[40:43], v[48:63]
    s_waitcnt vmcnt(3)
    s_barrier
    ds_read_b128 v[32:35], v6 offset:12288
    s_waitcnt lgkmcnt(5)
    v_mfma_f32_32x32x16_bf16 v[48:63], v[156:159], v[44:47], v[48:63]
    ds_read_b128 v[36:39], v6 offset:13312
    s_waitcnt lgkmcnt(5)
    v_mfma_f32_32x32x16_bf16 v[48:63], v[160:163], v[16:19], v[48:63]
    ds_read_b128 v[40:43], v6 offset:14336
    s_waitcnt lgkmcnt(5)
    v_mfma_f32_32x32x16_bf16 v[48:63], v[164:167], v[20:23], v[48:63]
    ds_read_b128 v[44:47], v6 offset:15360
    s_waitcnt lgkmcnt(5)
    v_mfma_f32_32x32x16_bf16 v[48:63], v[168:171], v[24:27], v[48:63]
    ds_read_b128 v[16:19], v6 offset:16384
    s_waitcnt lgkmcnt(5)
    v_mfma_f32_32x32x16_bf16 v[48:63], v[172:175], v[28:31], v[48:63]
    ds_read_b128 v[20:23], v6 offset:17408
    s_waitcnt lgkmcnt(5)
    v_mfma_f32_32x32x16_bf16 v[48:63], v[176:179], v[32:35], v[48:63]
    ds_read_b128 v[24:27], v6 offset:18432
    s_waitcnt lgkmcnt(5)
    v_mfma_f32_32x32x16_bf16 v[48:63], v[180:183], v[36:39], v[48:63]
    ds_read_b128 v[28:31], v6 offset:19456
    s_waitcnt lgkmcnt(5)
    v_mfma_f32_32x32x16_bf16 v[48:63], v[184:187], v[40:43], v[48:63]
    s_waitcnt vmcnt(0)
    s_barrier
    s_lshl_b32 s7, s41, 12
    s_xor_b32 s7, s7, s98
    s_and_b32 s7, s7, 0x2000
    s_lshl_b32 s6, s41, 20
    s_add_u32 s6, s6, s7
    s_add_u32 s14, s20, s6
    s_addc_u32 s15, s21, 0
    global_load_dword v7, v1, s[14:15] sc1
    ds_read_b128 v[32:35], v6 offset:20480
    s_waitcnt lgkmcnt(5)
    v_mfma_f32_32x32x16_bf16 v[48:63], v[188:191], v[44:47], v[48:63]
    ds_read_b128 v[36:39], v6 offset:21504
    s_waitcnt lgkmcnt(5)
    v_mfma_f32_32x32x16_bf16 v[48:63], v[192:195], v[16:19], v[48:63]
    ds_read_b128 v[40:43], v6 offset:22528
    s_waitcnt lgkmcnt(5)
    v_mfma_f32_32x32x16_bf16 v[48:63], v[196:199], v[20:23], v[48:63]
    ds_read_b128 v[44:47], v6 offset:23552
    s_waitcnt lgkmcnt(5)
    v_mfma_f32_32x32x16_bf16 v[48:63], v[200:203], v[24:27], v[48:63]
    ds_read_b128 v[16:19], v6 offset:24576
    s_waitcnt lgkmcnt(5)
    v_mfma_f32_32x32x16_bf16 v[48:63], v[204:207], v[28:31], v[48:63]
    ds_read_b128 v[20:23], v6 offset:25600
    s_waitcnt lgkmcnt(5)
    v_mfma_f32_32x32x16_bf16 v[48:63], v[208:211], v[32:35], v[48:63]
    ds_read_b128 v[24:27], v6 offset:26624
    s_waitcnt lgkmcnt(5)
    v_mfma_f32_32x32x16_bf16 v[48:63], v[212:215], v[36:39], v[48:63]
    ds_read_b128 v[28:31], v6 offset:27648
    s_waitcnt lgkmcnt(5)
    v_mfma_f32_32x32x16_bf16 v[48:63], v[216:219], v[40:43], v[48:63]
    ds_read_b128 v[32:35], v6 offset:28672
    s_waitcnt lgkmcnt(5)
    v_mfma_f32_32x32x16_bf16 v[48:63], v[220:223], v[44:47], v[48:63]
    ds_read_b128 v[36:39], v6 offset:29696
    s_waitcnt lgkmcnt(5)
    v_mfma_f32_32x32x16_bf16 v[48:63], v[224:227], v[16:19], v[48:63]
    ds_read_b128 v[40:43], v6 offset:30720
    s_waitcnt lgkmcnt(5)
    v_mfma_f32_32x32x16_bf16 v[48:63], v[228:231], v[20:23], v[48:63]
    ds_read_b128 v[44:47], v6 offset:31744
    s_waitcnt lgkmcnt(5)
    v_mfma_f32_32x32x16_bf16 v[48:63], v[232:235], v[24:27], v[48:63]
    s_waitcnt lgkmcnt(4)
    v_mfma_f32_32x32x16_bf16 v[48:63], v[236:239], v[28:31], v[48:63]
    s_waitcnt lgkmcnt(3)
    v_mfma_f32_32x32x16_bf16 v[48:63], v[240:243], v[32:35], v[48:63]
    s_waitcnt lgkmcnt(2)
    v_mfma_f32_32x32x16_bf16 v[48:63], v[244:247], v[36:39], v[48:63]
    s_waitcnt lgkmcnt(1)
    v_mfma_f32_32x32x16_bf16 v[48:63], v[248:251], v[40:43], v[48:63]
    s_waitcnt lgkmcnt(0)
    v_mfma_f32_32x32x16_bf16 v[48:63], v[252:255], v[44:47], v[48:63]
    s_xor_b32 s40, s40, 32768
    s_lshl_b32 s7, s5, 12
    s_xor_b32 s7, s7, s96
    s_and_b32 s7, s7, 0x2000
    s_lshl_b32 s6, s5, 20
    s_add_u32 s6, s6, s7
    s_add_u32 s12, s18, s6
    s_addc_u32 s13, s19, 0
    s_nop 7
    v_cvt_pk_bf16_f32 v80, v48, v49
    v_cvt_pk_bf16_f32 v81, v50, v51
    v_cvt_pk_bf16_f32 v82, v52, v53
    v_cvt_pk_bf16_f32 v83, v54, v55
    v_cvt_pk_bf16_f32 v84, v56, v57
    v_cvt_pk_bf16_f32 v85, v58, v59
    v_cvt_pk_bf16_f32 v86, v60, v61
    v_cvt_pk_bf16_f32 v87, v62, v63
    v_lshlrev_b32 v48, 16, v80
    v_and_b32 v49, 0xffff0000, v80
    v_lshlrev_b32 v50, 16, v81
    v_and_b32 v51, 0xffff0000, v81
    v_lshlrev_b32 v52, 16, v82
    v_and_b32 v53, 0xffff0000, v82
    v_lshlrev_b32 v54, 16, v83
    v_and_b32 v55, 0xffff0000, v83
    v_lshlrev_b32 v56, 16, v84
    v_and_b32 v57, 0xffff0000, v84
    v_lshlrev_b32 v58, 16, v85
    v_and_b32 v59, 0xffff0000, v85
    v_lshlrev_b32 v60, 16, v86
    v_and_b32 v61, 0xffff0000, v86
    v_lshlrev_b32 v62, 16, v87
    v_and_b32 v63, 0xffff0000, v87
    v_pk_mul_f32 v[64:65], v[48:49], v[48:49]
    v_pk_mul_f32 v[66:67], v[50:51], v[50:51]
    v_pk_mul_f32 v[68:69], v[52:53], v[52:53]
    v_pk_mul_f32 v[70:71], v[54:55], v[54:55]
    v_pk_mul_f32 v[72:73], v[56:57], v[56:57]
    v_pk_mul_f32 v[74:75], v[58:59], v[58:59]
    v_pk_mul_f32 v[76:77], v[60:61], v[60:61]
    v_pk_mul_f32 v[78:79], v[62:63], v[62:63]
    v_pk_fma_f32 v[64:65], v[64:65], v[4:5], v[4:5] op_sel:[0,1,0] op_sel_hi:[1,1,0]
    v_pk_fma_f32 v[66:67], v[66:67], v[4:5], v[4:5] op_sel:[0,1,0] op_sel_hi:[1,1,0]
    v_pk_fma_f32 v[68:69], v[68:69], v[4:5], v[4:5] op_sel:[0,1,0] op_sel_hi:[1,1,0]
    v_pk_fma_f32 v[70:71], v[70:71], v[4:5], v[4:5] op_sel:[0,1,0] op_sel_hi:[1,1,0]
    v_pk_fma_f32 v[72:73], v[72:73], v[4:5], v[4:5] op_sel:[0,1,0] op_sel_hi:[1,1,0]
    v_pk_fma_f32 v[74:75], v[74:75], v[4:5], v[4:5] op_sel:[0,1,0] op_sel_hi:[1,1,0]
    v_pk_fma_f32 v[76:77], v[76:77], v[4:5], v[4:5] op_sel:[0,1,0] op_sel_hi:[1,1,0]
    v_pk_fma_f32 v[78:79], v[78:79], v[4:5], v[4:5] op_sel:[0,1,0] op_sel_hi:[1,1,0]
    v_pk_mul_f32 v[64:65], v[64:65], v[48:49]
    v_pk_mul_f32 v[66:67], v[66:67], v[50:51]
    v_pk_mul_f32 v[68:69], v[68:69], v[52:53]
    v_pk_mul_f32 v[70:71], v[70:71], v[54:55]
    v_pk_mul_f32 v[72:73], v[72:73], v[56:57]
    v_pk_mul_f32 v[74:75], v[74:75], v[58:59]
    v_pk_mul_f32 v[76:77], v[76:77], v[60:61]
    v_pk_mul_f32 v[78:79], v[78:79], v[62:63]
    v_exp_f32 v64, v64
    v_exp_f32 v65, v65
    v_exp_f32 v66, v66
    v_exp_f32 v67, v67
    v_exp_f32 v68, v68
    v_exp_f32 v69, v69
    v_exp_f32 v70, v70
    v_exp_f32 v71, v71
    v_exp_f32 v72, v72
    v_exp_f32 v73, v73
    v_exp_f32 v74, v74
    v_exp_f32 v75, v75
    v_exp_f32 v76, v76
    v_exp_f32 v77, v77
    v_exp_f32 v78, v78
    v_exp_f32 v79, v79
    v_pk_add_f32 v[64:65], v[64:65], 1.0 op_sel_hi:[1,0]
    v_pk_add_f32 v[66:67], v[66:67], 1.0 op_sel_hi:[1,0]
    v_pk_add_f32 v[68:69], v[68:69], 1.0 op_sel_hi:[1,0]
    v_pk_add_f32 v[70:71], v[70:71], 1.0 op_sel_hi:[1,0]
    v_pk_add_f32 v[72:73], v[72:73], 1.0 op_sel_hi:[1,0]
    v_pk_add_f32 v[74:75], v[74:75], 1.0 op_sel_hi:[1,0]
    v_pk_add_f32 v[76:77], v[76:77], 1.0 op_sel_hi:[1,0]
    v_pk_add_f32 v[78:79], v[78:79], 1.0 op_sel_hi:[1,0]
    v_rcp_f32 v64, v64
    v_rcp_f32 v65, v65
    v_rcp_f32 v66, v66
    v_rcp_f32 v67, v67
    v_rcp_f32 v68, v68
    v_rcp_f32 v69, v69
    v_rcp_f32 v70, v70
    v_rcp_f32 v71, v71
    v_rcp_f32 v72, v72
    v_rcp_f32 v73, v73
    v_rcp_f32 v74, v74
    v_rcp_f32 v75, v75
    v_rcp_f32 v76, v76
    v_rcp_f32 v77, v77
    v_rcp_f32 v78, v78
    v_rcp_f32 v79, v79
    v_pk_mul_f32 v[64:65], v[64:65], v[48:49]
    v_pk_mul_f32 v[66:67], v[66:67], v[50:51]
    v_pk_mul_f32 v[68:69], v[68:69], v[52:53]
    v_pk_mul_f32 v[70:71], v[70:71], v[54:55]
    v_pk_mul_f32 v[72:73], v[72:73], v[56:57]
    v_pk_mul_f32 v[74:75], v[74:75], v[58:59]
    v_pk_mul_f32 v[76:77], v[76:77], v[60:61]
    v_pk_mul_f32 v[78:79], v[78:79], v[62:63]
    v_cvt_pk_bf16_f32 v80, v64, v65
    v_cvt_pk_bf16_f32 v81, v66, v67
    v_cvt_pk_bf16_f32 v82, v68, v69
    v_cvt_pk_bf16_f32 v83, v70, v71
    v_cvt_pk_bf16_f32 v84, v72, v73
    v_cvt_pk_bf16_f32 v85, v74, v75
    v_cvt_pk_bf16_f32 v86, v76, v77
    v_cvt_pk_bf16_f32 v87, v78, v79
    global_store_dwordx4 v0, v[80:83], s[12:13] sc1
    global_store_dwordx4 v0, v[84:87], s[12:13] offset:1024 sc1
    s_cmp_lt_u32 s4, 5
    s_cbranch_scc1 R5_nost
    v_and_b32 v56, s47, v80
    v_and_b32 v57, s47, v81
    v_and_b32 v58, s47, v82
    v_and_b32 v59, s47, v83
    v_and_b32 v48, s46, v84
    v_and_b32 v49, s46, v85
    v_and_b32 v50, s46, v86
    v_and_b32 v51, s46, v87
    v_lshlrev_b32 v64, 16, v56
    v_and_b32 v65, 0xffff0000, v56
    v_lshlrev_b32 v66, 16, v57
    v_and_b32 v67, 0xffff0000, v57
    v_lshlrev_b32 v68, 16, v58
    v_and_b32 v69, 0xffff0000, v58
    v_lshlrev_b32 v70, 16, v59
    v_and_b32 v71, 0xffff0000, v59
    v_lshlrev_b32 v72, 16, v48
    v_and_b32 v73, 0xffff0000, v48
    v_lshlrev_b32 v74, 16, v49
    v_and_b32 v75, 0xffff0000, v49
    v_lshlrev_b32 v76, 16, v50
    v_and_b32 v77, 0xffff0000, v50
    v_lshlrev_b32 v78, 16, v51
    v_and_b32 v79, 0xffff0000, v51
    v_pk_add_f32 v[52:53], v[64:65], v[66:67]
    v_pk_mul_f32 v[54:55], v[64:65], v[64:65]
    v_pk_fma_f32 v[54:55], v[66:67], v[66:67], v[54:55]
    v_pk_fma_f32 v[54:55], v[68:69], v[68:69], v[54:55]
    v_pk_add_f32 v[52:53], v[52:53], v[68:69]
    v_pk_fma_f32 v[54:55], v[70:71], v[70:71], v[54:55]
    v_pk_add_f32 v[52:53], v[52:53], v[70:71]
    v_pk_fma_f32 v[54:55], v[72:73], v[72:73], v[54:55]
    v_pk_add_f32 v[52:53], v[52:53], v[72:73]
    v_pk_fma_f32 v[54:55], v[74:75], v[74:75], v[54:55]
    v_pk_add_f32 v[52:53], v[52:53], v[74:75]
    v_pk_fma_f32 v[54:55], v[76:77], v[76:77], v[54:55]
    v_pk_add_f32 v[52:53], v[52:53], v[76:77]
    v_pk_fma_f32 v[54:55], v[78:79], v[78:79], v[54:55]
    v_pk_add_f32 v[52:53], v[52:53], v[78:79]
    v_add_f32 v52, v52, v53
    v_add_f32 v54, v54, v55
    s_lshl_b32 s7, s5, 12
    s_xor_b32 s7, s7, s96
    s_and_b32 s7, s7, 0x2000
    s_lshl_b32 s6, s5, 20
    s_add_u32 s6, s6, s7
    s_add_u32 s12, s48, s6
    s_addc_u32 s13, s49, 0
    v_permlane32_swap_b32 v52, v54
    v_add_f32 v52, v52, v54
    ds_write_b32 v14, v52
    s_waitcnt lgkmcnt(0)
    s_barrier
    s_cmp_lg_u32 s3, 0
    s_cbranch_scc1 R5_nost
    ds_read_b128 v[64:67], v14
    s_waitcnt lgkmcnt(0)
    v_pk_add_f32 v[64:65], v[64:65], v[66:67]
    v_add_f32 v64, v64, v65
    global_store_dword v2, v64, s[12:13] sc1
R5_nost:
    s_add_u32 s41, s5, 2
    s_lshl_b32 s7, s5, 12
    s_xor_b32 s7, s7, s96
    s_and_b32 s7, s7, 0x2000
    s_lshl_b32 s6, s5, 20
    s_add_u32 s6, s6, s7
    v_mov_b32 v8, s6
    v_mov_b32 v9, 1
    v_cmp_ne_u32 s[28:29], 0, v7
    s_mov_b32 s43, 0
    s_cmp_ge_u32 s41, 64
    s_cbranch_scc1 P_nopre_97
    s_andn2_b64 s[28:29], s[22:23], s[28:29]
    s_cbranch_scc1 P_nopre_97
    s_mov_b32 s43, 1
    s_lshl_b32 s7, s41, 12
    s_xor_b32 s7, s7, s98
    s_and_b32 s7, s7, 0x2000
    s_lshl_b32 s6, s41, 20
    s_add_u32 s6, s6, s7
    s_add_u32 s12, s16, s6
    s_addc_u32 s13, s17, 0
    s_lshl_b32 s7, s3, 10
    s_add_u32 s7, s7, s40
    s_add_u32 m0, s7, 0
    s_nop 0
    global_load_lds_dwordx4 v3, s[12:13] sc1
    s_add_u32 m0, s7, 4096
    s_add_u32 s12, s12, 512
    s_addc_u32 s13, s13, 0
    global_load_lds_dwordx4 v3, s[12:13] sc1
    s_add_u32 m0, s7, 8192
    s_add_u32 s12, s12, 512
    s_addc_u32 s13, s13, 0
    global_load_lds_dwordx4 v3, s[12:13] sc1
    s_add_u32 m0, s7, 12288
    s_add_u32 s12, s12, 512
    s_addc_u32 s13, s13, 0
    global_load_lds_dwordx4 v3, s[12:13] sc1
    s_add_u32 m0, s7, 16384
    s_add_u32 s12, s12, 512
    s_addc_u32 s13, s13, 0
    global_load_lds_dwordx4 v3, s[12:13] sc1
    s_add_u32 m0, s7, 20480
    s_add_u32 s12, s12, 512
    s_addc_u32 s13, s13, 0
    global_load_lds_dwordx4 v3, s[12:13] sc1
    s_add_u32 m0, s7, 24576
    s_add_u32 s12, s12, 512
    s_addc_u32 s13, s13, 0
    global_load_lds_dwordx4 v3, s[12:13] sc1
    s_add_u32 m0, s7, 28672
    s_add_u32 s12, s12, 512
    s_addc_u32 s13, s13, 0
    global_load_lds_dwordx4 v3, s[12:13] sc1
    s_waitcnt vmcnt(8)
    s_barrier
    s_cmp_lg_u32 s3, 3
    s_cbranch_scc1 P_nf_96j
    global_store_dword v8, v9, s[30:31] sc1
    s_branch P_nf_96j
P_nopre_97:
    s_lshl_b32 s7, s41, 12
    s_xor_b32 s7, s7, s98
    s_and_b32 s7, s7, 0x2000
    s_lshl_b32 s6, s41, 20
    s_add_u32 s6, s6, s7
    s_add_u32 s14, s20, s6
    s_addc_u32 s15, s21, 0
    global_load_dword v7, v1, s[14:15] sc1
    s_waitcnt vmcnt(1)
    s_barrier
    s_cmp_lg_u32 s3, 3
    s_cbranch_scc1 P_nf_96
    global_store_dword v8, v9, s[30:31] sc1
    s_waitcnt vmcnt(1)
    s_branch P_nf_96j
P_nf_96:
    s_waitcnt vmcnt(0)
P_nf_96j:
    s_mov_b32 s5, s41
    s_cmp_lt_u32 s5, 64
    s_cbranch_scc1 R5_loop
    s_branch R7_run
K_sp:
    s_load_dwordx2 s[12:13], s[0:1], 104
    v_mov_b32 v8, 32
    s_mov_b32 s8, 800000
    s_waitcnt lgkmcnt(0)
I_w_98:
    global_load_dword v9, v8, s[12:13] sc1
    s_waitcnt vmcnt(0)
    v_cmp_le_u32 vcc, 128, v9
    s_cbranch_vccnz I_d_99
    s_sleep 4
    s_sub_u32 s8, s8, 1
    s_cbranch_scc0 I_w_98
I_d_99:
    s_load_dwordx2 s[12:13], s[0:1], 104
    v_mov_b32 v8, 36
    s_mov_b32 s8, 800000
    s_waitcnt lgkmcnt(0)
I_w_100:
    global_load_dword v9, v8, s[12:13] sc1
    s_waitcnt vmcnt(0)
    v_cmp_le_u32 vcc, 1, v9
    s_cbranch_vccnz I_d_101
    s_sleep 4
    s_sub_u32 s8, s8, 1
    s_cbranch_scc0 I_w_100
I_d_101:
    v_readfirstlane_b32 s97, v9
    s_nop 3
    s_lshl_b32 s97, s97, 13
    s_and_b32 s97, s97, 0x2000
    s_xor_b32 s96, s97, 0x2000
    s_add_u32 s14, s10, 149848064
    s_addc_u32 s15, s11, 0
    s_add_u32 s14, s14, s97
    s_addc_u32 s15, s15, 0
    s_mov_b64 s[22:23], 1
    global_load_dword v7, v1, s[14:15] sc1
    s_mov_b32 s8, 800000
    s_waitcnt vmcnt(0)
P_w_102:
    v_cmp_ne_u32 s[28:29], 0, v7
    s_nop 3
    s_andn2_b64 s[28:29], s[22:23], s[28:29]
    s_cbranch_scc0 P_d_103
    s_sleep 8
    global_load_dword v7, v1, s[14:15] sc1
    s_sub_u32 s8, s8, 1
    s_waitcnt vmcnt(0)
    s_cbranch_scc0 P_w_102
P_d_103:
    s_load_dwordx2 s[24:25], s[0:1], 72
    s_lshl_b32 s37, s4, 2
    s_add_u32 s37, s37, s3
    s_lshl_b32 s37, s37, 14
    s_waitcnt lgkmcnt(0)
    s_mov_b32 s32, s24
    s_and_b32 s33, s25, 0xffff
    s_mov_b32 s34, 8388608
    s_mov_b32 s35, 0x20000
SP_loop:
    buffer_load_dwordx4 v[16:19], v0, s[32:35], s37 offen offset:0
    buffer_load_dwordx4 v[16:19], v0, s[32:35], s37 offen offset:1024
    buffer_load_dwordx4 v[16:19], v0, s[32:35], s37 offen offset:2048
    buffer_load_dwordx4 v[16:19], v0, s[32:35], s37 offen offset:3072
    s_add_u32 s37, s37, 4096
    buffer_load_dwordx4 v[16:19], v0, s[32:35], s37 offen offset:0
    buffer_load_dwordx4 v[16:19], v0, s[32:35], s37 offen offset:1024
    buffer_load_dwordx4 v[16:19], v0, s[32:35], s37 offen offset:2048
    buffer_load_dwordx4 v[16:19], v0, s[32:35], s37 offen offset:3072
    s_add_u32 s37, s37, 4096
    buffer_load_dwordx4 v[16:19], v0, s[32:35], s37 offen offset:0
    buffer_load_dwordx4 v[16:19], v0, s[32:35], s37 offen offset:1024
    buffer_load_dwordx4 v[16:19], v0, s[32:35], s37 offen offset:2048
    buffer_load_dwordx4 v[16:19], v0, s[32:35], s37 offen offset:3072
    s_add_u32 s37, s37, 4096
    buffer_load_dwordx4 v[16:19], v0, s[32:35], s37 offen offset:0
    buffer_load_dwordx4 v[16:19], v0, s[32:35], s37 offen offset:1024
    buffer_load_dwordx4 v[16:19], v0, s[32:35], s37 offen offset:2048
    buffer_load_dwordx4 v[16:19], v0, s[32:35], s37 offen offset:3072
    s_waitcnt vmcnt(16)
    s_add_u32 s37, s37, 905216
    s_cmp_lt_u32 s37, 0x800000
    s_cbranch_scc1 SP_loop
    s_waitcnt vmcnt(0)
R7_run:
    s_mov_b32 s62, 0
R7_any:
    s_load_dwordx2 s[26:27], s[0:1], 96
    v_lshrrev_b32 v16, 4, v0
    v_bfe_u32 v17, v16, 0, 5
    v_lshlrev_b32 v2, 10, v17
    v_bfe_u32 v17, v16, 5, 1
    v_lshl_add_u32 v2, v17, 4, v2
    v_bfe_u32 v17, v16, 2, 1
    v_lshlrev_b32 v3, 12, v17
    v_bfe_u32 v17, v16, 3, 2
    v_lshl_add_u32 v3, v17, 14, v3
    v_bfe_u32 v17, v16, 5, 1
    v_lshl_add_u32 v3, v17, 6, v3
    v_bfe_u32 v17, v16, 0, 2
    v_lshl_add_u32 v3, v17, 4, v3
    s_bfe_u32 s4, s2, 0x20003
    s_add_u32 s5, s2, 2
    s_and_b32 s5, s5, 7
    s_lshl_b32 s5, s5, 3
    s_lshr_b32 s6, s2, 5
    s_add_u32 s5, s5, s6
    s_mov_b32 s7, 84755840
    s_add_u32 s20, s10, s7
    s_addc_u32 s21, s11, 0
    s_mov_b64 s[22:23], 0x7ff
    s_mov_b32 s7, 83886080
    s_mul_i32 s6, s5, 1048576
    s_add_u32 s7, s7, s6
    s_add_u32 s16, s10, s7
    s_addc_u32 s17, s11, 0
    s_mov_b32 s64, s16
    s_and_b32 s65, s17, 0xffff
    s_mov_b32 s67, 0x20000
    s_lshl_b32 s44, s3, 10
    s_lshl_b32 s6, s5, 12
    s_xor_b32 s6, s6, s96
    s_and_b32 s45, s6, 0x2000
    s_lshl_b32 s6, s4, 2
    s_add_u32 s6, s6, s3
    s_lshl_b32 s7, s6, 8
    s_add_u32 s45, s45, s7
    s_add_u32 s45, s45, 884736
    s_lshl_b32 s46, s6, 6
    s_lshl_b32 s6, s5, 15
    s_add_u32 s46, s46, s6
    s_waitcnt lgkmcnt(0)
    s_mov_b32 s68, s26
    s_and_b32 s69, s27, 0xffff
    s_mov_b32 s71, 0x20000
R7_pass:
    s_cmp_eq_u32 s62, 0
    s_cselect_b32 s66, 1048576, 0
    s_cselect_b32 s70, 2097152, 0
    s_barrier
    s_cbranch_scc0 R7_body
    s_lshl_b32 s7, s5, 12
    s_xor_b32 s7, s7, s96
    s_and_b32 s7, s7, 0x2000
    s_lshl_b32 s6, s5, 20
    s_add_u32 s6, s6, s7
    s_add_u32 s14, s20, s6
    s_addc_u32 s15, s21, 0
    global_load_dword v7, v1, s[14:15] sc1
    s_mov_b32 s8, 800000
    s_waitcnt vmcnt(0)
P_w_104:
    v_cmp_ne_u32 s[28:29], 0, v7
    s_nop 3
    s_andn2_b64 s[28:29], s[22:23], s[28:29]
    s_cbranch_scc0 P_d_105
    s_sleep 2
    global_load_dword v7, v1, s[14:15] sc1
    s_sub_u32 s8, s8, 1
    s_waitcnt vmcnt(0)
    s_cbranch_scc0 P_w_104
P_d_105:
R7_body:
    buffer_load_dwordx4 v[64:67], v3, s[64:67], s45 offen sc1
    buffer_load_dwordx4 v[68:71], v3, s[64:67], s45 offen offset:128 sc1
    s_add_u32 m0, s44, 0
    s_add_u32 s37, s44, 770048
    buffer_load_dwordx4 v0, s[64:67], s37 offen sc1 lds
    s_add_u32 m0, s44, 4096
    s_add_u32 s37, s44, 774144
    buffer_load_dwordx4 v0, s[64:67], s37 offen sc1 lds
    s_add_u32 m0, s44, 8192
    s_add_u32 s37, s44, 778240
    buffer_load_dwordx4 v0, s[64:67], s37 offen sc1 lds
    s_add_u32 m0, s44, 12288
    s_add_u32 s37, s44, 782336
    buffer_load_dwordx4 v0, s[64:67], s37 offen sc1 lds
    s_add_u32 m0, s44, 16384
    s_add_u32 s37, s44, 786432
    buffer_load_dwordx4 v0, s[64:67], s37 offen sc1 lds
    s_add_u32 m0, s44, 20480
    s_add_u32 s37, s44, 790528
    buffer_load_dwordx4 v0, s[64:67], s37 offen sc1 lds
    s_add_u32 m0, s44, 24576
    s_add_u32 s37, s44, 794624
    buffer_load_dwordx4 v0, s[64:67], s37 offen sc1 lds
    s_add_u32 m0, s44, 28672
    s_add_u32 s37, s44, 798720
    buffer_load_dwordx4 v0, s[64:67], s37 offen sc1 lds
    s_add_u32 m0, s44, 32768
    s_add_u32 s37, s44, 802816
    buffer_load_dwordx4 v0, s[64:67], s37 offen sc1 lds
    s_add_u32 m0, s44, 36864
    s_add_u32 s37, s44, 806912
    buffer_load_dwordx4 v0, s[64:67], s37 offen sc1 lds
    s_cmp_ge_u32 s3, 3
    s_cbranch_scc1 R7_sk
    s_add_u32 m0, s44, 40960
    s_add_u32 s37, s44, 811008
    buffer_load_dwordx4 v0, s[64:67], s37 offen sc1 lds
R7_sk:
    s_waitcnt vmcnt(7)
    s_barrier
    ds_read_b128 v[16:19], v0 offset:0
    ds_read_b128 v[20:23], v0 offset:1024
    ds_read_b128 v[24:27], v0 offset:2048
    ds_read_b128 v[28:31], v0 offset:3072
    ds_read_b128 v[32:35], v0 offset:4096
    ds_read_b128 v[36:39], v0 offset:5120
    s_waitcnt lgkmcnt(5)
    v_mfma_f32_32x32x16_bf16 v[48:63], a[0:3], v[16:19], 0
    ds_read_b128 v[40:43], v0 offset:6144
    s_waitcnt lgkmcnt(5)
    v_mfma_f32_32x32x16_bf16 v[48:63], a[4:7], v[20:23], v[48:63]
    ds_read_b128 v[44:47], v0 offset:7168
    s_waitcnt lgkmcnt(5)
    v_mfma_f32_32x32x16_bf16 v[48:63], a[8:11], v[24:27], v[48:63]
    ds_read_b128 v[16:19], v0 offset:8192
    s_waitcnt lgkmcnt(5)
    v_mfma_f32_32x32x16_bf16 v[48:63], a[12:15], v[28:31], v[48:63]
    ds_read_b128 v[20:23], v0 offset:9216
    s_waitcnt lgkmcnt(5)
    v_mfma_f32_32x32x16_bf16 v[48:63], a[16:19], v[32:35], v[48:63]
    ds_read_b128 v[24:27], v0 offset:10240
    s_waitcnt lgkmcnt(5)
    v_mfma_f32_32x32x16_bf16 v[48:63], a[20:23], v[36:39], v[48:63]
    ds_read_b128 v[28:31], v0 offset:11264
    s_waitcnt lgkmcnt(5)
    v_mfma_f32_32x32x16_bf16 v[48:63], a[24:27], v[40:43], v[48:63]
    s_waitcnt vmcnt(5)
    s_barrier
    ds_read_b128 v[32:35], v0 offset:12288
    s_waitcnt lgkmcnt(5)
    v_mfma_f32_32x32x16_bf16 v[48:63], a[28:31], v[44:47], v[48:63]
    ds_read_b128 v[36:39], v0 offset:13312
    s_waitcnt lgkmcnt(5)
    v_mfma_f32_32x32x16_bf16 v[48:63], a[32:35], v[16:19], v[48:63]
    ds_read_b128 v[40:43], v0 offset:14336
    s_waitcnt lgkmcnt(5)
    v_mfma_f32_32x32x16_bf16 v[48:63], a[36:39], v[20:23], v[48:63]
    ds_read_b128 v[44:47], v0 offset:15360
    s_waitcnt lgkmcnt(5)
    v_mfma_f32_32x32x16_bf16 v[48:63], a[40:43], v[24:27], v[48:63]
    ds_read_b128 v[16:19], v0 offset:16384
    s_waitcnt lgkmcnt(5)
    v_mfma_f32_32x32x16_bf16 v[48:63], a[44:47], v[28:31], v[48:63]
    ds_read_b128 v[20:23], v0 offset:17408
    s_waitcnt lgkmcnt(5)
    v_mfma_f32_32x32x16_bf16 v[48:63], a[48:51], v[32:35], v[48:63]
    ds_read_b128 v[24:27], v0 offset:18432
    s_waitcnt lgkmcnt(5)
    v_mfma_f32_32x32x16_bf16 v[48:63], a[52:55], v[36:39], v[48:63]
    ds_read_b128 v[28:31], v0 offset:19456
    s_waitcnt lgkmcnt(5)
    v_mfma_f32_32x32x16_bf16 v[48:63], a[56:59], v[40:43], v[48:63]
    s_waitcnt vmcnt(2)
    s_barrier
    ds_read_b128 v[32:35], v0 offset:20480
    s_waitcnt lgkmcnt(5)
    v_mfma_f32_32x32x16_bf16 v[48:63], a[60:63], v[44:47], v[48:63]
    ds_read_b128 v[36:39], v0 offset:21504
    s_waitcnt lgkmcnt(5)
    v_mfma_f32_32x32x16_bf16 v[48:63], a[64:67], v[16:19], v[48:63]
    ds_read_b128 v[40:43], v0 offset:22528
    s_waitcnt lgkmcnt(5)
    v_mfma_f32_32x32x16_bf16 v[48:63], a[68:71], v[20:23], v[48:63]
    ds_read_b128 v[44:47], v0 offset:23552
    s_waitcnt lgkmcnt(5)
    v_mfma_f32_32x32x16_bf16 v[48:63], a[72:75], v[24:27], v[48:63]
    ds_read_b128 v[16:19], v0 offset:24576
    s_waitcnt lgkmcnt(5)
    v_mfma_f32_32x32x16_bf16 v[48:63], a[76:79], v[28:31], v[48:63]
    ds_read_b128 v[20:23], v0 offset:25600
    s_waitcnt lgkmcnt(5)
    v_mfma_f32_32x32x16_bf16 v[48:63], a[80:83], v[32:35], v[48:63]
    ds_read_b128 v[24:27], v0 offset:26624
    s_waitcnt lgkmcnt(5)
    v_mfma_f32_32x32x16_bf16 v[48:63], a[84:87], v[36:39], v[48:63]
    ds_read_b128 v[28:31], v0 offset:27648
    s_waitcnt lgkmcnt(5)
    v_mfma_f32_32x32x16_bf16 v[48:63], a[88:91], v[40:43], v[48:63]
    ds_read_b128 v[32:35], v0 offset:28672
    s_waitcnt lgkmcnt(5)
    v_mfma_f32_32x32x16_bf16 v[48:63], a[92:95], v[44:47], v[48:63]
    ds_read_b128 v[36:39], v0 offset:29696
    s_waitcnt lgkmcnt(5)
    v_mfma_f32_32x32x16_bf16 v[48:63], a[96:99], v[16:19], v[48:63]
    ds_read_b128 v[40:43], v0 offset:30720
    s_waitcnt lgkmcnt(5)
    v_mfma_f32_32x32x16_bf16 v[48:63], a[100:103], v[20:23], v[48:63]
    ds_read_b128 v[44:47], v0 offset:31744
    s_waitcnt lgkmcnt(5)
    v_mfma_f32_32x32x16_bf16 v[48:63], a[104:107], v[24:27], v[48:63]
    s_waitcnt vmcnt(0)
    s_barrier
    ds_read_b128 v[16:19], v0 offset:32768
    s_waitcnt lgkmcnt(5)
    v_mfma_f32_32x32x16_bf16 v[48:63], a[108:111], v[28:31], v[48:63]
    ds_read_b128 v[20:23], v0 offset:33792
    s_waitcnt lgkmcnt(5)
    v_mfma_f32_32x32x16_bf16 v[48:63], a[112:115], v[32:35], v[48:63]
    ds_read_b128 v[24:27], v0 offset:34816
    s_waitcnt lgkmcnt(5)
    v_mfma_f32_32x32x16_bf16 v[48:63], a[116:119], v[36:39], v[48:63]
    ds_read_b128 v[28:31], v0 offset:35840
    s_waitcnt lgkmcnt(5)
    v_mfma_f32_32x32x16_bf16 v[48:63], a[120:123], v[40:43], v[48:63]
    ds_read_b128 v[32:35], v0 offset:36864
    s_waitcnt lgkmcnt(5)
    v_mfma_f32_32x32x16_bf16 v[48:63], a[124:127], v[44:47], v[48:63]
    ds_read_b128 v[36:39], v0 offset:37888
    s_waitcnt lgkmcnt(5)
    v_mfma_f32_32x32x16_bf16 v[48:63], a[128:131], v[16:19], v[48:63]
    ds_read_b128 v[40:43], v0 offset:38912
    s_waitcnt lgkmcnt(5)
    v_mfma_f32_32x32x16_bf16 v[48:63], a[132:135], v[20:23], v[48:63]
    ds_read_b128 v[44:47], v0 offset:39936
    s_waitcnt lgkmcnt(5)
    v_mfma_f32_32x32x16_bf16 v[48:63], a[136:139], v[24:27], v[48:63]
    ds_read_b128 v[16:19], v0 offset:40960
    s_waitcnt lgkmcnt(5)
    v_mfma_f32_32x32x16_bf16 v[48:63], a[140:143], v[28:31], v[48:63]
    ds_read_b128 v[20:23], v0 offset:41984
    s_waitcnt lgkmcnt(5)
    v_mfma_f32_32x32x16_bf16 v[48:63], a[144:147], v[32:35], v[48:63]
    ds_read_b128 v[24:27], v0 offset:43008
    s_waitcnt lgkmcnt(5)
    v_mfma_f32_32x32x16_bf16 v[48:63], a[148:151], v[36:39], v[48:63]
    s_waitcnt lgkmcnt(4)
    v_mfma_f32_32x32x16_bf16 v[48:63], a[152:155], v[40:43], v[48:63]
    s_waitcnt lgkmcnt(3)
    v_mfma_f32_32x32x16_bf16 v[48:63], a[156:159], v[44:47], v[48:63]
    s_waitcnt lgkmcnt(2)
    v_mfma_f32_32x32x16_bf16 v[48:63], a[160:163], v[16:19], v[48:63]
    s_waitcnt lgkmcnt(1)
    v_mfma_f32_32x32x16_bf16 v[48:63], a[164:167], v[20:23], v[48:63]
    s_waitcnt lgkmcnt(0)
    v_mfma_f32_32x32x16_bf16 v[48:63], a[168:171], v[24:27], v[48:63]
    v_lshlrev_b32 v80, 16, v64
    v_and_b32 v81, 0xffff0000, v64
    v_lshlrev_b32 v82, 16, v65
    v_and_b32 v83, 0xffff0000, v65
    v_lshlrev_b32 v84, 16, v66
    v_and_b32 v85, 0xffff0000, v66
    v_lshlrev_b32 v86, 16, v67
    v_and_b32 v87, 0xffff0000, v67
    v_lshlrev_b32 v88, 16, v68
    v_and_b32 v89, 0xffff0000, v68
    v_lshlrev_b32 v90, 16, v69
    v_and_b32 v91, 0xffff0000, v69
    v_lshlrev_b32 v92, 16, v70
    v_and_b32 v93, 0xffff0000, v70
    v_lshlrev_b32 v94, 16, v71
    v_and_b32 v95, 0xffff0000, v71
    v_cvt_pk_bf16_f32 v64, v48, v49
    v_cvt_pk_bf16_f32 v65, v50, v51
    v_cvt_pk_bf16_f32 v66, v52, v53
    v_cvt_pk_bf16_f32 v67, v54, v55
    v_cvt_pk_bf16_f32 v68, v56, v57
    v_cvt_pk_bf16_f32 v69, v58, v59
    v_cvt_pk_bf16_f32 v70, v60, v61
    v_cvt_pk_bf16_f32 v71, v62, v63
    v_lshlrev_b32 v48, 16, v64
    v_and_b32 v49, 0xffff0000, v64
    v_lshlrev_b32 v50, 16, v65
    v_and_b32 v51, 0xffff0000, v65
    v_lshlrev_b32 v52, 16, v66
    v_and_b32 v53, 0xffff0000, v66
    v_lshlrev_b32 v54, 16, v67
    v_and_b32 v55, 0xffff0000, v67
    v_lshlrev_b32 v56, 16, v68
    v_and_b32 v57, 0xffff0000, v68
    v_lshlrev_b32 v58, 16, v69
    v_and_b32 v59, 0xffff0000, v69
    v_lshlrev_b32 v60, 16, v70
    v_and_b32 v61, 0xffff0000, v70
    v_lshlrev_b32 v62, 16, v71
    v_and_b32 v63, 0xffff0000, v71
    v_pk_add_f32 v[48:49], v[48:49], v[80:81]
    v_pk_add_f32 v[50:51], v[50:51], v[82:83]
    v_pk_add_f32 v[52:53], v[52:53], v[84:85]
    v_pk_add_f32 v[54:55], v[54:55], v[86:87]
    v_pk_add_f32 v[56:57], v[56:57], v[88:89]
    v_pk_add_f32 v[58:59], v[58:59], v[90:91]
    v_pk_add_f32 v[60:61], v[60:61], v[92:93]
    v_pk_add_f32 v[62:63], v[62:63], v[94:95]
    v_cvt_pk_bf16_f32 v96, v48, v49
    v_cvt_pk_bf16_f32 v97, v50, v51
    v_cvt_pk_bf16_f32 v98, v52, v53
    v_cvt_pk_bf16_f32 v99, v54, v55
    v_cvt_pk_bf16_f32 v100, v56, v57
    v_cvt_pk_bf16_f32 v101, v58, v59
    v_cvt_pk_bf16_f32 v102, v60, v61
    v_cvt_pk_bf16_f32 v103, v62, v63
    buffer_store_dwordx4 v[96:99], v2, s[68:71], s46 offen
    buffer_store_dwordx4 v[100:103], v2, s[68:71], s46 offen offset:32
    s_endpgm
.section .rodata,"a"
.p2align 6
.amdhsa_kernel sequential_preLN__memory_aug_recurrent_mem_tr__mixer_gmlp__prompt_kernel
  .amdhsa_next_free_vgpr 512
  .amdhsa_next_free_sgpr 100
  .amdhsa_accum_offset 256
  .amdhsa_group_segment_fixed_size 0
  .amdhsa_kernarg_size 120
  .amdhsa_user_sgpr_count 2
  .amdhsa_user_sgpr_kernarg_segment_ptr 1
  .amdhsa_system_sgpr_workgroup_id_x 1
  .amdhsa_float_denorm_mode_32 3
.end_amdhsa_kernel
```
